```python
import torch

def _softmax(x, axis=-1):
    return torch.softmax(x, dim=axis)
def _gelu(x):
    return torch.nn.functional.gelu(x, approximate="tanh")
def _silu(x):
    return torch.nn.functional.silu(x)
def _sigmoid(x):
    return torch.sigmoid(x)
def _layernorm(x, axis=-1, eps=1e-5):
    m = x.mean(dim=axis, keepdim=True)
    v = x.var(dim=axis, keepdim=True, unbiased=False)
    return (x - m) / torch.sqrt(v + eps)
def _scatter_add(tgt, idx, src, axis=0):
    return tgt.clone().index_add_(axis, idx, src)
def _segment_sum(src, seg, n):
    out = torch.zeros((n,) + src.shape[1:], dtype=src.dtype)
    return out.index_add_(0, seg, src)
def _pad(x, pw):
    flat = tuple(v for pair in reversed(pw) for v in pair)
    return torch.nn.functional.pad(x, flat)

kernel_name = 'gated_mix__softmax_full_mha__glu_gated_geglu__prompt'

def setup_inputs():

    _w = (lambda a: (lambda t: t.to(torch.bfloat16) if t.is_floating_point() else t)(torch.as_tensor(a)))
    def _A_setup():
        B, S, D = 1, 2048, 640
        return {
            "x": _w((lambda *s: torch.randn(*s, dtype=torch.bfloat16) * 0.05)(B, S, D)),
            "wqkv": _w((lambda *s: torch.randn(*s, dtype=torch.bfloat16) * 0.8)(D, 3 * D)),
            "wo": _w((lambda *s: torch.randn(*s, dtype=torch.bfloat16) * 0.05)(D, D)),
        }
    _A_in = _A_setup()

    def _B_setup():
        B, S, Dm, Df = 1, 2048, 640, 1536
        return {
            "x": _w((lambda *s: torch.randn(*s, dtype=torch.bfloat16) * 0.05)(B, S, Dm)),
            "w_gate": _w((lambda *s: torch.randn(*s, dtype=torch.bfloat16) * 3.2)(Dm, Df) * (Dm ** -0.5)),
            "w_up": _w((lambda *s: torch.randn(*s, dtype=torch.bfloat16) * 3.2)(Dm, Df) * (Dm ** -0.5)),
            "w_down": _w((lambda *s: torch.randn(*s, dtype=torch.bfloat16) * 3.2)(Df, Dm) * (Df ** -0.5)),
        }
    _B_in = _B_setup()

    return {
        "A_x": _A_in["x"],
        "A_wqkv": _A_in["wqkv"],
        "A_wo": _A_in["wo"],
        "B_x": _B_in["x"],
        "B_w_gate": _B_in["w_gate"],
        "B_w_up": _B_in["w_up"],
        "B_w_down": _B_in["w_down"],
        "gate_w": _w((lambda *s: torch.randn(*s, dtype=torch.bfloat16) * 0.05)(640) * 16.0),
    }

def reference(A_x, A_wqkv, A_wo, B_x, B_w_gate, B_w_up, B_w_down, gate_w):
    def _A_ref(x, wqkv, wo):
        B, S, D = x.shape
        H = 32; Dh = D // H
        qkv = (lambda x, *d: x.permute(*d))((x @ wqkv).reshape(B, S, 3, H, Dh), 2, 0, 3, 1, 4)
        q, k, v = qkv[0], qkv[1], qkv[2]
        scale = Dh ** -0.5
        scores = torch.einsum("bhqd,bhkd->bhqk", q, k) * scale
        p = _softmax(scores, axis=-1)
        o = torch.einsum("bhqk,bhkd->bhqd", p, v)
        return (lambda x, *d: x.permute(*d))(o, 0, 2, 1, 3).reshape(B, S, D) @ wo

    def _B_ref(x, w_gate, w_up, w_down):
        g = torch.einsum("bsd,df->bsf", x, w_gate)
        u = torch.einsum("bsd,df->bsf", x, w_up)
        h = _gelu(g) * u
        return torch.einsum("bsf,fd->bsd", h, w_down)

    x = A_x
    g = _sigmoid((x * gate_w).sum(-1, keepdims=True))
    a = _A_ref(x, A_wqkv, A_wo)
    b = _B_ref(x, B_w_gate, B_w_up, B_w_down)
    return g * a + (1 - g) * b
```

```asm
; @launch grid=(256,1,1) block=(512,1,1) lds=163840
.amdgcn_target "amdgcn-amd-amdhsa--gfx950"
.text
.globl gated_mix__softmax_full_mha__glu_gated_geglu__prompt_kernel
.p2align 12
.p2align 8
.type gated_mix__softmax_full_mha__glu_gated_geglu__prompt_kernel,@function
gated_mix__softmax_full_mha__glu_gated_geglu__prompt_kernel:
    s_cmp_ge_u32 s2, 256
    s_cbranch_scc1 gated_mix__softmax_full_mha__glu_gated_geglu__prompt_kernel_end
    s_load_dwordx4 s[4:7], s[0:1], 0
    s_load_dwordx2 s[8:9], s[0:1], 16
    s_load_dwordx4 s[12:15], s[0:1], 32
    s_load_dwordx2 s[10:11], s[0:1], 48
    s_load_dwordx2 s[16:17], s[0:1], 80
    s_load_dwordx2 s[78:79], s[0:1], 56
    v_lshrrev_b32 v1, 6, v0
    v_and_b32 v0, 63, v0
    v_readfirstlane_b32 s3, v1
    s_and_b32 s40, s2, 7
    s_mov_b32 s55, s3
    s_lshl_b32 s40, s40, 5
    s_lshr_b32 s41, s2, 3
    s_add_u32 s38, s40, s41
    s_cmp_eq_u32 s38, 255
    s_cbranch_scc1 gated_mix__softmax_full_mha__glu_gated_geglu__prompt_kernel_idle
    s_mul_i32 s42, s38, 1009
    s_lshr_b32 s42, s42, 16
    s_mul_i32 s43, s42, 65
    s_sub_u32 s43, s38, s43
    s_mul_i32 s18, s43, 205
    s_lshr_b32 s18, s18, 10
    s_mul_i32 s39, s18, 5
    s_sub_u32 s39, s43, s39
    s_cmp_lt_u32 s38, 235
    s_cbranch_scc1 gated_mix__softmax_full_mha__glu_gated_geglu__prompt_kernel_dec
    s_sub_u32 s43, s38, 235
    s_lshr_b32 s18, s43, 2
    s_add_u32 s18, s18, 8
    s_and_b32 s39, s43, 3
gated_mix__softmax_full_mha__glu_gated_geglu__prompt_kernel_dec:
    s_mul_i32 s19, s42, 3
    s_lshl_b32 s43, s42, 1
    s_add_u32 s43, s43, 9
    s_cmp_lt_u32 s39, 3
    s_cselect_b32 s19, s19, s43
    s_add_u32 s19, s19, s39
    s_cmp_ge_u32 s3, 4
    s_cbranch_scc0 gated_mix__softmax_full_mha__glu_gated_geglu__prompt_kernel_compute
gated_mix__softmax_full_mha__glu_gated_geglu__prompt_kernel_loader:
    s_setprio 3
    s_sub_u32 s3, s3, 4
    v_lshrrev_b32 v10, 3, v0
    v_mul_u32_u24 v10, 1280, v10
    v_and_b32 v11, 7, v0
    v_lshrrev_b32 v12, 4, v0
    s_and_b32 s59, s2, 1
    s_mul_i32 s59, s59, 5
    s_mov_b32 s36, 0
    s_cmp_eq_u32 s19, 19
    s_cbranch_scc1 gated_mix__softmax_full_mha__glu_gated_geglu__prompt_kernel_ldspec
    s_and_b32 s60, s3, 2
    s_lshl_b32 s60, s60, 1
    v_add_u32 v15, s60, v12
    v_xor_b32 v15, v15, v11
    v_lshl_add_u32 v15, v15, 4, v10
    v_add_u32 v1, 0, v15
    s_mul_i32 s61, s18, 20
    s_add_u32 s61, s61, s3
    s_mul_i32 s61, s61, 10240
    s_lshl_b32 s65, s3, 10
    s_lshl_b32 s62, s59, 7
    s_add_u32 s62, s62, s61
    s_mov_b32 m0, s65
    s_waitcnt lgkmcnt(0)
    s_mov_b32 s20, s4
    s_and_b32 s21, s5, 0xffff
    s_mov_b32 s22, 2621440
    s_mov_b32 s23, 0x20000
    buffer_load_dwordx4 v1, s[20:23], s62 offen  lds
    s_add_u32 m0, m0, 4096
    s_add_u32 s62, s62, 40960
    buffer_load_dwordx4 v1, s[20:23], s62 offen  lds
    s_add_u32 m0, m0, 4096
    s_add_u32 s62, s62, 40960
    buffer_load_dwordx4 v1, s[20:23], s62 offen  lds
    s_add_u32 m0, m0, 4096
    s_add_u32 s62, s62, 40960
    buffer_load_dwordx4 v1, s[20:23], s62 offen  lds
    s_add_u32 m0, m0, 4096
    s_add_u32 s62, s62, 40960
    buffer_load_dwordx4 v1, s[20:23], s62 offen  lds
    s_lshr_b32 s54, s3, 1
    s_movk_i32 s56, 3072
    s_lshl_b32 s57, s19, 7
    s_cmp_ge_u32 s19, 12
    s_cmovk_i32 s56, 3840
    s_sub_u32 s58, s19, 12
    s_lshl_b32 s58, s58, 9
    s_lshl_b32 s60, s54, 8
    s_add_u32 s58, s58, s60
    s_cmp_ge_u32 s19, 12
    s_cselect_b32 s57, s58, s57
    s_cmp_eq_u32 s19, 19
    s_cmovk_i32 s57, 3584
    v_and_b32 v13, 15, v0
    v_mul_u32_u24 v14, s56, v12
    v_add_u32 v14, s57, v14
    s_lshl_b32 s63, s56, 6
    s_lshl_b32 s60, s56, 2
    s_sub_u32 s60, s60, 1024
    s_cmp_lt_u32 s19, 12
    s_cselect_b32 s69, 1408, 0
    s_cselect_b32 s68, 3, 0
    v_lshlrev_b32 v15, 1, v12
    v_xor_b32 v15, v15, v13
    v_lshrrev_b32 v16, 1, v15
    v_xor_b32 v16, v16, v15
    v_and_b32 v16, 1, v16
    v_mul_u32_u24 v16, s68, v16
    v_xor_b32 v15, v15, v16
    v_lshl_add_u32 v6, v15, 4, v14
    v_lshrrev_b32 v15, 3, v15
    v_mad_u32_u24 v6, v15, s69, v6
    v_add_u32 v7, s60, v6
    v_lshlrev_b32 v15, 1, v12
    v_xor_b32 v15, v15, v13
    v_xor_b32 v15, 8, v15
    v_lshrrev_b32 v16, 1, v15
    v_xor_b32 v16, v16, v15
    v_and_b32 v16, 1, v16
    v_mul_u32_u24 v16, s68, v16
    v_xor_b32 v15, v15, v16
    v_lshl_add_u32 v8, v15, 4, v14
    v_lshrrev_b32 v15, 3, v15
    v_mad_u32_u24 v8, v15, s69, v8
    v_add_u32 v8, s60, v8
    v_add_u32 v8, s60, v8
    v_add_u32 v9, s60, v8
    s_and_b32 s60, s3, 1
    s_lshl_b32 s67, s60, 4
    s_mul_i32 s67, s67, s56
    s_lshl_b32 s66, s54, 14
    s_lshl_b32 s60, s60, 12
    s_add_u32 s66, s66, s60
    s_add_u32 s66, s66, 20480
    s_lshl_b32 s68, s56, 5
    s_cmp_eq_u32 s54, 0
    s_cselect_b32 s24, s12, s14
    s_cselect_b32 s25, s13, s15
    s_mov_b32 s26, 1966080
    s_cmp_ge_u32 s19, 12
    s_cselect_b32 s24, s6, s24
    s_cselect_b32 s25, s7, s25
    s_cmov_b32 s26, 2457600
    s_and_b32 s25, s25, 0xffff
    s_mov_b32 s27, 0x20000
    s_add_u32 s73, s66, 8192
    s_mul_i32 s64, s59, s63
    s_add_u32 s64, s64, s67
    s_add_u32 s69, s64, s68
    s_add_u32 m0, s36, s66
    s_nop 0
    buffer_load_dwordx4 v6, s[24:27], s64 offen  lds
    buffer_load_dwordx4 v7, s[24:27], s64 offen offset:1024  lds
    buffer_load_dwordx4 v8, s[24:27], s64 offen offset:2048  lds
    buffer_load_dwordx4 v9, s[24:27], s64 offen offset:3072  lds
    s_add_u32 m0, s36, s73
    s_nop 0
    buffer_load_dwordx4 v6, s[24:27], s69 offen  lds
    buffer_load_dwordx4 v7, s[24:27], s69 offen offset:1024  lds
    buffer_load_dwordx4 v8, s[24:27], s69 offen offset:2048  lds
    buffer_load_dwordx4 v9, s[24:27], s69 offen offset:3072  lds
    s_add_u32 s59, s59, 1
    s_cmp_eq_u32 s59, 10
    s_cselect_b32 s59, 0, s59
    s_add_u32 s36, s36, 53248
    s_cmp_eq_u32 s36, 159744
    s_cselect_b32 s36, 0, s36
    s_mul_i32 s60, s39, 1
    s_add_u32 s60, s60, s18
    s_mul_i32 s72, s60, 86
    s_lshr_b32 s72, s72, 8
    s_mul_i32 s72, s72, 3
    s_sub_u32 s60, s60, s72
    s_cmp_eq_u32 s60, 1
    s_cbranch_scc1 gated_mix__softmax_full_mha__glu_gated_geglu__prompt_kernel_var1
    s_cmp_eq_u32 s60, 2
    s_cbranch_scc1 gated_mix__softmax_full_mha__glu_gated_geglu__prompt_kernel_var2
    s_lshl_b32 s62, s59, 7
    s_add_u32 s62, s62, s61
    s_mul_i32 s64, s59, s63
    s_add_u32 s64, s64, s67
    s_add_u32 s69, s64, s68
    s_add_u32 m0, s36, s65
    s_nop 0
    buffer_load_dwordx4 v1, s[20:23], s62 offen  lds
    s_add_u32 m0, s36, s65
    s_add_u32 m0, m0, 4096
    s_add_u32 s74, s62, 40960
    buffer_load_dwordx4 v1, s[20:23], s74 offen  lds
    s_add_u32 m0, s36, s65
    s_add_u32 m0, m0, 8192
    s_add_u32 s74, s62, 81920
    buffer_load_dwordx4 v1, s[20:23], s74 offen  lds
    s_add_u32 m0, s36, s65
    s_add_u32 m0, m0, 12288
    s_add_u32 s74, s62, 122880
    buffer_load_dwordx4 v1, s[20:23], s74 offen  lds
    s_waitcnt vmcnt(8)
    s_barrier
    s_waitcnt vmcnt(4)
    s_barrier
    s_add_u32 m0, s36, s65
    s_add_u32 m0, m0, 16384
    s_add_u32 s74, s62, 163840
    buffer_load_dwordx4 v1, s[20:23], s74 offen  lds
    s_add_u32 m0, s36, s66
    s_nop 0
    buffer_load_dwordx4 v6, s[24:27], s64 offen offset:0  lds
    buffer_load_dwordx4 v7, s[24:27], s64 offen offset:1024  lds
    buffer_load_dwordx4 v8, s[24:27], s64 offen offset:2048  lds
    buffer_load_dwordx4 v9, s[24:27], s64 offen offset:3072  lds
    s_add_u32 m0, s36, s73
    s_nop 0
    buffer_load_dwordx4 v6, s[24:27], s69 offen offset:0  lds
    buffer_load_dwordx4 v7, s[24:27], s69 offen offset:1024  lds
    buffer_load_dwordx4 v8, s[24:27], s69 offen offset:2048  lds
    buffer_load_dwordx4 v9, s[24:27], s69 offen offset:3072  lds
    s_add_u32 s59, s59, 1
    s_cmp_eq_u32 s59, 10
    s_cselect_b32 s59, 0, s59
    s_add_u32 s36, s36, 53248
    s_cmp_eq_u32 s36, 159744
    s_cselect_b32 s36, 0, s36
    s_mov_b32 s37, 1
Lk1ld_5:
    s_lshl_b32 s62, s59, 7
    s_add_u32 s62, s62, s61
    s_mul_i32 s64, s59, s63
    s_add_u32 s64, s64, s67
    s_add_u32 s69, s64, s68
    s_add_u32 m0, s36, s65
    s_nop 0
    buffer_load_dwordx4 v1, s[20:23], s62 offen  lds
    s_add_u32 m0, s36, s65
    s_add_u32 m0, m0, 4096
    s_add_u32 s74, s62, 40960
    buffer_load_dwordx4 v1, s[20:23], s74 offen  lds
    s_add_u32 m0, s36, s65
    s_add_u32 m0, m0, 8192
    s_add_u32 s74, s62, 81920
    buffer_load_dwordx4 v1, s[20:23], s74 offen  lds
    s_add_u32 m0, s36, s65
    s_add_u32 m0, m0, 12288
    s_add_u32 s74, s62, 122880
    buffer_load_dwordx4 v1, s[20:23], s74 offen  lds
    s_add_u32 m0, s36, s65
    s_add_u32 m0, m0, 16384
    s_add_u32 s74, s62, 163840
    buffer_load_dwordx4 v1, s[20:23], s74 offen  lds
    s_add_u32 m0, s36, s66
    s_nop 0
    buffer_load_dwordx4 v6, s[24:27], s64 offen offset:0  lds
    buffer_load_dwordx4 v7, s[24:27], s64 offen offset:1024  lds
    buffer_load_dwordx4 v8, s[24:27], s64 offen offset:2048  lds
    buffer_load_dwordx4 v9, s[24:27], s64 offen offset:3072  lds
    s_add_u32 m0, s36, s73
    s_nop 0
    buffer_load_dwordx4 v6, s[24:27], s69 offen offset:0  lds
    buffer_load_dwordx4 v7, s[24:27], s69 offen offset:1024  lds
    buffer_load_dwordx4 v8, s[24:27], s69 offen offset:2048  lds
    buffer_load_dwordx4 v9, s[24:27], s69 offen offset:3072  lds
    s_add_u32 s59, s59, 1
    s_cmp_eq_u32 s59, 10
    s_cselect_b32 s59, 0, s59
    s_add_u32 s36, s36, 53248
    s_cmp_eq_u32 s36, 159744
    s_cselect_b32 s36, 0, s36
    s_waitcnt vmcnt(13)
    s_barrier
    s_add_u32 s37, s37, 1
    s_cmp_lt_u32 s37, 9
    s_cbranch_scc1 Lk1ld_5
    s_waitcnt lgkmcnt(0)
    s_branch gated_mix__softmax_full_mha__glu_gated_geglu__prompt_kernel_tjob
gated_mix__softmax_full_mha__glu_gated_geglu__prompt_kernel_var1:
    s_lshl_b32 s62, s59, 7
    s_add_u32 s62, s62, s61
    s_mul_i32 s64, s59, s63
    s_add_u32 s64, s64, s67
    s_add_u32 s69, s64, s68
    s_add_u32 m0, s36, s66
    s_nop 0
    buffer_load_dwordx4 v6, s[24:27], s64 offen offset:0  lds
    buffer_load_dwordx4 v7, s[24:27], s64 offen offset:1024  lds
    buffer_load_dwordx4 v8, s[24:27], s64 offen offset:2048  lds
    buffer_load_dwordx4 v9, s[24:27], s64 offen offset:3072  lds
    s_waitcnt vmcnt(8)
    s_barrier
    s_waitcnt vmcnt(4)
    s_barrier
    s_add_u32 m0, s36, s73
    s_nop 0
    buffer_load_dwordx4 v6, s[24:27], s69 offen offset:0  lds
    buffer_load_dwordx4 v7, s[24:27], s69 offen offset:1024  lds
    buffer_load_dwordx4 v8, s[24:27], s69 offen offset:2048  lds
    buffer_load_dwordx4 v9, s[24:27], s69 offen offset:3072  lds
    s_add_u32 m0, s36, s65
    s_nop 0
    buffer_load_dwordx4 v1, s[20:23], s62 offen  lds
    s_add_u32 m0, s36, s65
    s_add_u32 m0, m0, 4096
    s_add_u32 s74, s62, 40960
    buffer_load_dwordx4 v1, s[20:23], s74 offen  lds
    s_add_u32 m0, s36, s65
    s_add_u32 m0, m0, 8192
    s_add_u32 s74, s62, 81920
    buffer_load_dwordx4 v1, s[20:23], s74 offen  lds
    s_add_u32 m0, s36, s65
    s_add_u32 m0, m0, 12288
    s_add_u32 s74, s62, 122880
    buffer_load_dwordx4 v1, s[20:23], s74 offen  lds
    s_add_u32 m0, s36, s65
    s_add_u32 m0, m0, 16384
    s_add_u32 s74, s62, 163840
    buffer_load_dwordx4 v1, s[20:23], s74 offen  lds
    s_add_u32 s59, s59, 1
    s_cmp_eq_u32 s59, 10
    s_cselect_b32 s59, 0, s59
    s_add_u32 s36, s36, 53248
    s_cmp_eq_u32 s36, 159744
    s_cselect_b32 s36, 0, s36
    s_mov_b32 s37, 1
Lk1ld_7:
    s_lshl_b32 s62, s59, 7
    s_add_u32 s62, s62, s61
    s_mul_i32 s64, s59, s63
    s_add_u32 s64, s64, s67
    s_add_u32 s69, s64, s68
    s_add_u32 m0, s36, s66
    s_nop 0
    buffer_load_dwordx4 v6, s[24:27], s64 offen offset:0  lds
    buffer_load_dwordx4 v7, s[24:27], s64 offen offset:1024  lds
    buffer_load_dwordx4 v8, s[24:27], s64 offen offset:2048  lds
    buffer_load_dwordx4 v9, s[24:27], s64 offen offset:3072  lds
    s_add_u32 m0, s36, s73
    s_nop 0
    buffer_load_dwordx4 v6, s[24:27], s69 offen offset:0  lds
    buffer_load_dwordx4 v7, s[24:27], s69 offen offset:1024  lds
    buffer_load_dwordx4 v8, s[24:27], s69 offen offset:2048  lds
    buffer_load_dwordx4 v9, s[24:27], s69 offen offset:3072  lds
    s_add_u32 m0, s36, s65
    s_nop 0
    buffer_load_dwordx4 v1, s[20:23], s62 offen  lds
    s_add_u32 m0, s36, s65
    s_add_u32 m0, m0, 4096
    s_add_u32 s74, s62, 40960
    buffer_load_dwordx4 v1, s[20:23], s74 offen  lds
    s_add_u32 m0, s36, s65
    s_add_u32 m0, m0, 8192
    s_add_u32 s74, s62, 81920
    buffer_load_dwordx4 v1, s[20:23], s74 offen  lds
    s_add_u32 m0, s36, s65
    s_add_u32 m0, m0, 12288
    s_add_u32 s74, s62, 122880
    buffer_load_dwordx4 v1, s[20:23], s74 offen  lds
    s_add_u32 m0, s36, s65
    s_add_u32 m0, m0, 16384
    s_add_u32 s74, s62, 163840
    buffer_load_dwordx4 v1, s[20:23], s74 offen  lds
    s_add_u32 s59, s59, 1
    s_cmp_eq_u32 s59, 10
    s_cselect_b32 s59, 0, s59
    s_add_u32 s36, s36, 53248
    s_cmp_eq_u32 s36, 159744
    s_cselect_b32 s36, 0, s36
    s_waitcnt vmcnt(13)
    s_barrier
    s_add_u32 s37, s37, 1
    s_cmp_lt_u32 s37, 9
    s_cbranch_scc1 Lk1ld_7
    s_waitcnt lgkmcnt(0)
    s_branch gated_mix__softmax_full_mha__glu_gated_geglu__prompt_kernel_tjob
gated_mix__softmax_full_mha__glu_gated_geglu__prompt_kernel_var2:
    s_lshl_b32 s62, s59, 7
    s_add_u32 s62, s62, s61
    s_mul_i32 s64, s59, s63
    s_add_u32 s64, s64, s67
    s_add_u32 s69, s64, s68
    s_add_u32 m0, s36, s73
    s_nop 0
    buffer_load_dwordx4 v6, s[24:27], s69 offen offset:0  lds
    buffer_load_dwordx4 v7, s[24:27], s69 offen offset:1024  lds
    buffer_load_dwordx4 v8, s[24:27], s69 offen offset:2048  lds
    buffer_load_dwordx4 v9, s[24:27], s69 offen offset:3072  lds
    s_waitcnt vmcnt(8)
    s_barrier
    s_waitcnt vmcnt(4)
    s_barrier
    s_add_u32 m0, s36, s65
    s_nop 0
    buffer_load_dwordx4 v1, s[20:23], s62 offen  lds
    s_add_u32 m0, s36, s65
    s_add_u32 m0, m0, 4096
    s_add_u32 s74, s62, 40960
    buffer_load_dwordx4 v1, s[20:23], s74 offen  lds
    s_add_u32 m0, s36, s65
    s_add_u32 m0, m0, 8192
    s_add_u32 s74, s62, 81920
    buffer_load_dwordx4 v1, s[20:23], s74 offen  lds
    s_add_u32 m0, s36, s65
    s_add_u32 m0, m0, 12288
    s_add_u32 s74, s62, 122880
    buffer_load_dwordx4 v1, s[20:23], s74 offen  lds
    s_add_u32 m0, s36, s65
    s_add_u32 m0, m0, 16384
    s_add_u32 s74, s62, 163840
    buffer_load_dwordx4 v1, s[20:23], s74 offen  lds
    s_add_u32 m0, s36, s66
    s_nop 0
    buffer_load_dwordx4 v6, s[24:27], s64 offen offset:0  lds
    buffer_load_dwordx4 v7, s[24:27], s64 offen offset:1024  lds
    buffer_load_dwordx4 v8, s[24:27], s64 offen offset:2048  lds
    buffer_load_dwordx4 v9, s[24:27], s64 offen offset:3072  lds
    s_add_u32 s59, s59, 1
    s_cmp_eq_u32 s59, 10
    s_cselect_b32 s59, 0, s59
    s_add_u32 s36, s36, 53248
    s_cmp_eq_u32 s36, 159744
    s_cselect_b32 s36, 0, s36
    s_mov_b32 s37, 1
Lk1ld_9:
    s_lshl_b32 s62, s59, 7
    s_add_u32 s62, s62, s61
    s_mul_i32 s64, s59, s63
    s_add_u32 s64, s64, s67
    s_add_u32 s69, s64, s68
    s_add_u32 m0, s36, s73
    s_nop 0
    buffer_load_dwordx4 v6, s[24:27], s69 offen offset:0  lds
    buffer_load_dwordx4 v7, s[24:27], s69 offen offset:1024  lds
    buffer_load_dwordx4 v8, s[24:27], s69 offen offset:2048  lds
    buffer_load_dwordx4 v9, s[24:27], s69 offen offset:3072  lds
    s_add_u32 m0, s36, s65
    s_nop 0
    buffer_load_dwordx4 v1, s[20:23], s62 offen  lds
    s_add_u32 m0, s36, s65
    s_add_u32 m0, m0, 4096
    s_add_u32 s74, s62, 40960
    buffer_load_dwordx4 v1, s[20:23], s74 offen  lds
    s_add_u32 m0, s36, s65
    s_add_u32 m0, m0, 8192
    s_add_u32 s74, s62, 81920
    buffer_load_dwordx4 v1, s[20:23], s74 offen  lds
    s_add_u32 m0, s36, s65
    s_add_u32 m0, m0, 12288
    s_add_u32 s74, s62, 122880
    buffer_load_dwordx4 v1, s[20:23], s74 offen  lds
    s_add_u32 m0, s36, s65
    s_add_u32 m0, m0, 16384
    s_add_u32 s74, s62, 163840
    buffer_load_dwordx4 v1, s[20:23], s74 offen  lds
    s_add_u32 m0, s36, s66
    s_nop 0
    buffer_load_dwordx4 v6, s[24:27], s64 offen offset:0  lds
    buffer_load_dwordx4 v7, s[24:27], s64 offen offset:1024  lds
    buffer_load_dwordx4 v8, s[24:27], s64 offen offset:2048  lds
    buffer_load_dwordx4 v9, s[24:27], s64 offen offset:3072  lds
    s_add_u32 s59, s59, 1
    s_cmp_eq_u32 s59, 10
    s_cselect_b32 s59, 0, s59
    s_add_u32 s36, s36, 53248
    s_cmp_eq_u32 s36, 159744
    s_cselect_b32 s36, 0, s36
    s_waitcnt vmcnt(13)
    s_barrier
    s_add_u32 s37, s37, 1
    s_cmp_lt_u32 s37, 9
    s_cbranch_scc1 Lk1ld_9
    s_waitcnt lgkmcnt(0)
    s_branch gated_mix__softmax_full_mha__glu_gated_geglu__prompt_kernel_tjob
.p2align 12
gated_mix__softmax_full_mha__glu_gated_geglu__prompt_kernel_ldspec:
    v_add_u32 v15, 0, v12
    v_xor_b32 v15, v15, v11
    v_lshl_add_u32 v15, v15, 4, v10
    v_add_u32 v1, 0, v15
    v_add_u32 v15, 0, v12
    v_xor_b32 v15, v15, v11
    v_lshl_add_u32 v15, v15, 4, v10
    v_add_u32 v2, 9216, v15
    v_add_u32 v15, 4, v12
    v_xor_b32 v15, v15, v11
    v_lshl_add_u32 v15, v15, 4, v10
    v_add_u32 v3, 18432, v15
    v_add_u32 v15, 4, v12
    v_xor_b32 v15, v15, v11
    v_lshl_add_u32 v15, v15, 4, v10
    v_add_u32 v4, 27648, v15
    s_lshr_b32 s54, s3, 1
    s_movk_i32 s56, 3072
    s_lshl_b32 s57, s19, 7
    s_cmp_ge_u32 s19, 12
    s_cmovk_i32 s56, 3840
    s_sub_u32 s58, s19, 12
    s_lshl_b32 s58, s58, 9
    s_lshl_b32 s60, s54, 8
    s_add_u32 s58, s58, s60
    s_cmp_ge_u32 s19, 12
    s_cselect_b32 s57, s58, s57
    s_cmp_eq_u32 s19, 19
    s_cmovk_i32 s57, 3584
    v_and_b32 v13, 15, v0
    v_mul_u32_u24 v14, s56, v12
    v_add_u32 v14, s57, v14
    s_lshl_b32 s63, s56, 6
    s_lshl_b32 s60, s56, 2
    s_sub_u32 s60, s60, 1024
    v_lshlrev_b32 v15, 1, v12
    v_xor_b32 v15, v15, v13
    v_lshl_add_u32 v6, v15, 4, v14
    v_add_u32 v7, s60, v6
    v_lshlrev_b32 v15, 1, v12
    v_xor_b32 v15, v15, v13
    v_xor_b32 v15, 8, v15
    v_lshl_add_u32 v8, v15, 4, v14
    v_add_u32 v8, s60, v8
    v_add_u32 v8, s60, v8
    v_add_u32 v9, s60, v8
    s_lshl_b32 s61, s18, 8
    s_lshl_b32 s60, s3, 6
    s_add_u32 s61, s61, s60
    s_mul_i32 s61, s61, 1280
    s_lshl_b32 s65, s3, 13
    s_lshl_b32 s67, s3, 4
    s_mul_i32 s67, s67, s56
    s_lshl_b32 s66, s3, 12
    s_add_u32 s66, s66, 32768
    s_waitcnt lgkmcnt(0)
    s_mov_b32 s20, s4
    s_and_b32 s21, s5, 0xffff
    s_mov_b32 s22, 2621440
    s_mov_b32 s23, 0x20000
    s_cmp_eq_u32 s54, 0
    s_cselect_b32 s24, s12, s14
    s_cselect_b32 s25, s13, s15
    s_mov_b32 s26, 1966080
    s_cmp_ge_u32 s19, 12
    s_cselect_b32 s24, s6, s24
    s_cselect_b32 s25, s7, s25
    s_cmov_b32 s26, 2457600
    s_and_b32 s25, s25, 0xffff
    s_mov_b32 s27, 0x20000
    s_lshl_b32 s62, s59, 7
    s_add_u32 s62, s62, s61
    s_mul_i32 s64, s59, s63
    s_add_u32 m0, s36, s65
    s_add_u32 s64, s64, s67
    buffer_load_dwordx4 v1, s[20:23], s62 offen  lds
    buffer_load_dwordx4 v2, s[20:23], s62 offen offset:1024  lds
    buffer_load_dwordx4 v3, s[20:23], s62 offen offset:2048  lds
    buffer_load_dwordx4 v4, s[20:23], s62 offen offset:3072  lds
    s_add_u32 m0, m0, 4096
    s_add_u32 s69, s62, 40960
    buffer_load_dwordx4 v1, s[20:23], s69 offen  lds
    buffer_load_dwordx4 v2, s[20:23], s69 offen offset:1024  lds
    buffer_load_dwordx4 v3, s[20:23], s69 offen offset:2048  lds
    buffer_load_dwordx4 v4, s[20:23], s69 offen offset:3072  lds
    s_add_u32 m0, s36, s66
    s_nop 0
    buffer_load_dwordx4 v6, s[24:27], s64 offen  lds
    buffer_load_dwordx4 v7, s[24:27], s64 offen offset:1024  lds
    buffer_load_dwordx4 v8, s[24:27], s64 offen offset:2048  lds
    buffer_load_dwordx4 v9, s[24:27], s64 offen offset:3072  lds
    s_add_u32 s59, s59, 1
    s_cmp_eq_u32 s59, 10
    s_cselect_b32 s59, 0, s59
    s_add_u32 s36, s36, 53248
    s_cmp_eq_u32 s36, 159744
    s_cselect_b32 s36, 0, s36
    s_lshl_b32 s62, s59, 7
    s_add_u32 s62, s62, s61
    s_mul_i32 s64, s59, s63
    s_add_u32 m0, s36, s65
    s_add_u32 s64, s64, s67
    buffer_load_dwordx4 v1, s[20:23], s62 offen  lds
    buffer_load_dwordx4 v2, s[20:23], s62 offen offset:1024  lds
    buffer_load_dwordx4 v3, s[20:23], s62 offen offset:2048  lds
    buffer_load_dwordx4 v4, s[20:23], s62 offen offset:3072  lds
    s_waitcnt vmcnt(4)
    s_barrier
    s_waitcnt vmcnt(4)
    s_barrier
    s_add_u32 m0, m0, 4096
    s_add_u32 s69, s62, 40960
    buffer_load_dwordx4 v1, s[20:23], s69 offen  lds
    buffer_load_dwordx4 v2, s[20:23], s69 offen offset:1024  lds
    buffer_load_dwordx4 v3, s[20:23], s69 offen offset:2048  lds
    buffer_load_dwordx4 v4, s[20:23], s69 offen offset:3072  lds
    s_add_u32 m0, s36, s66
    s_nop 0
    buffer_load_dwordx4 v6, s[24:27], s64 offen  lds
    buffer_load_dwordx4 v7, s[24:27], s64 offen offset:1024  lds
    buffer_load_dwordx4 v8, s[24:27], s64 offen offset:2048  lds
    buffer_load_dwordx4 v9, s[24:27], s64 offen offset:3072  lds
    s_add_u32 s59, s59, 1
    s_cmp_eq_u32 s59, 10
    s_cselect_b32 s59, 0, s59
    s_add_u32 s36, s36, 53248
    s_cmp_eq_u32 s36, 159744
    s_cselect_b32 s36, 0, s36
    s_mov_b32 s37, 1
Lk1ld_11:
    s_lshl_b32 s62, s59, 7
    s_add_u32 s62, s62, s61
    s_mul_i32 s64, s59, s63
    s_add_u32 m0, s36, s65
    s_add_u32 s64, s64, s67
    buffer_load_dwordx4 v1, s[20:23], s62 offen  lds
    buffer_load_dwordx4 v2, s[20:23], s62 offen offset:1024  lds
    buffer_load_dwordx4 v3, s[20:23], s62 offen offset:2048  lds
    buffer_load_dwordx4 v4, s[20:23], s62 offen offset:3072  lds
    s_add_u32 m0, m0, 4096
    s_add_u32 s69, s62, 40960
    buffer_load_dwordx4 v1, s[20:23], s69 offen  lds
    buffer_load_dwordx4 v2, s[20:23], s69 offen offset:1024  lds
    buffer_load_dwordx4 v3, s[20:23], s69 offen offset:2048  lds
    buffer_load_dwordx4 v4, s[20:23], s69 offen offset:3072  lds
    s_add_u32 m0, s36, s66
    s_nop 0
    buffer_load_dwordx4 v6, s[24:27], s64 offen  lds
    buffer_load_dwordx4 v7, s[24:27], s64 offen offset:1024  lds
    buffer_load_dwordx4 v8, s[24:27], s64 offen offset:2048  lds
    buffer_load_dwordx4 v9, s[24:27], s64 offen offset:3072  lds
    s_add_u32 s59, s59, 1
    s_cmp_eq_u32 s59, 10
    s_cselect_b32 s59, 0, s59
    s_add_u32 s36, s36, 53248
    s_cmp_eq_u32 s36, 159744
    s_cselect_b32 s36, 0, s36
    s_waitcnt vmcnt(12)
    s_barrier
    s_add_u32 s37, s37, 1
    s_cmp_lt_u32 s37, 9
    s_cbranch_scc1 Lk1ld_11
    s_waitcnt lgkmcnt(0)
    s_branch gated_mix__softmax_full_mha__glu_gated_geglu__prompt_kernel_tjob
gated_mix__softmax_full_mha__glu_gated_geglu__prompt_kernel_tjob:
    s_mul_i32 s70, s3, 255
    s_add_u32 s70, s70, s38
    s_cmp_lt_u32 s70, 544
    s_cselect_b32 s71, s70, 0
    s_lshr_b32 s72, s71, 2
    s_and_b32 s73, s71, 3
    s_mul_i32 s76, s72, 20
    s_sub_u32 s74, s72, 32
    s_mul_i32 s74, s74, 80
    s_add_u32 s74, s74, 16
    s_cmp_ge_u32 s72, 32
    s_cselect_b32 s76, s74, s76
    s_cselect_b32 s77, 16, 0
    s_sub_u32 s74, s72, 40
    s_lshl_b32 s74, s74, 4
    s_cmp_lt_u32 s72, 40
    s_cselect_b32 s28, s8, s10
    s_cselect_b32 s29, s9, s11
    s_mov_b32 s30, 1966080
    s_cmov_b32 s30, 819200
    s_cselect_b32 s74, s76, s74
    s_cselect_b32 s77, s77, 0
    s_and_b32 s29, s29, 0xffff
    s_mov_b32 s31, 0x20000
    s_mul_i32 s74, s74, 1280
    s_mul_i32 s75, s73, 320
    s_add_u32 s74, s74, s75
    s_mul_i32 s75, s3, 5120
    s_add_u32 s75, s75, 53248
    v_add_u32 v8, 0, v0
    v_mul_u32_u24 v9, 205, v8
    v_lshrrev_b32 v9, 12, v9
    v_mul_u32_u24 v10, 20, v9
    v_sub_u32 v8, v8, v10
    v_lshrrev_b32 v10, 2, v9
    v_mad_u32_u24 v9, v10, s77, v9
    v_mul_u32_u24 v9, 1280, v9
    v_lshl_add_u32 v11, v8, 4, v9
    s_add_u32 m0, s75, 0
    s_nop 0
    buffer_load_dwordx4 v11, s[28:31], s74 offen lds
    v_add_u32 v8, 64, v0
    v_mul_u32_u24 v9, 205, v8
    v_lshrrev_b32 v9, 12, v9
    v_mul_u32_u24 v10, 20, v9
    v_sub_u32 v8, v8, v10
    v_lshrrev_b32 v10, 2, v9
    v_mad_u32_u24 v9, v10, s77, v9
    v_mul_u32_u24 v9, 1280, v9
    v_lshl_add_u32 v11, v8, 4, v9
    s_add_u32 m0, s75, 1024
    s_nop 0
    buffer_load_dwordx4 v11, s[28:31], s74 offen lds
    v_add_u32 v8, 128, v0
    v_mul_u32_u24 v9, 205, v8
    v_lshrrev_b32 v9, 12, v9
    v_mul_u32_u24 v10, 20, v9
    v_sub_u32 v8, v8, v10
    v_lshrrev_b32 v10, 2, v9
    v_mad_u32_u24 v9, v10, s77, v9
    v_mul_u32_u24 v9, 1280, v9
    v_lshl_add_u32 v11, v8, 4, v9
    s_add_u32 m0, s75, 2048
    s_nop 0
    buffer_load_dwordx4 v11, s[28:31], s74 offen lds
    v_add_u32 v8, 192, v0
    v_mul_u32_u24 v9, 205, v8
    v_lshrrev_b32 v9, 12, v9
    v_mul_u32_u24 v10, 20, v9
    v_sub_u32 v8, v8, v10
    v_lshrrev_b32 v10, 2, v9
    v_mad_u32_u24 v9, v10, s77, v9
    v_mul_u32_u24 v9, 1280, v9
    v_lshl_add_u32 v11, v8, 4, v9
    s_add_u32 m0, s75, 3072
    s_nop 0
    buffer_load_dwordx4 v11, s[28:31], s74 offen lds
    v_add_u32 v8, 256, v0
    v_mul_u32_u24 v9, 205, v8
    v_lshrrev_b32 v9, 12, v9
    v_mul_u32_u24 v10, 20, v9
    v_sub_u32 v8, v8, v10
    v_lshrrev_b32 v10, 2, v9
    v_mad_u32_u24 v9, v10, s77, v9
    v_mul_u32_u24 v9, 1280, v9
    v_lshl_add_u32 v11, v8, 4, v9
    s_add_u32 m0, s75, 4096
    s_nop 0
    buffer_load_dwordx4 v11, s[28:31], s74 offen lds
    s_mov_b32 s32, s16
    s_and_b32 s33, s17, 0xffff
    s_mov_b32 s34, 22261760
    s_mov_b32 s35, 0x20000
    s_waitcnt vmcnt(5)
    s_barrier
    s_cmp_ge_u32 s70, 544
    s_cbranch_scc1 gated_mix__softmax_full_mha__glu_gated_geglu__prompt_kernel_gate
    v_lshrrev_b32 v1, 5, v0
    v_bfe_u32 v2, v0, 2, 2
    v_lshl_add_u32 v1, v1, 2, v2
    v_mul_u32_u24 v1, 320, v1
    v_bfe_u32 v2, v0, 4, 1
    v_lshl_add_u32 v1, v2, 5, v1
    v_and_b32 v2, 3, v0
    v_lshl_add_u32 v1, v2, 3, v1
    v_add_u32 v1, s75, v1
    v_bfe_u32 v2, v0, 4, 1
    v_mul_u32_u24 v2, 69632, v2
    v_and_b32 v3, 15, v0
    v_lshrrev_b32 v4, 5, v0
    v_lshl_add_u32 v3, v4, 4, v3
    v_lshl_add_u32 v4, v3, 3, v2
    v_lshl_add_u32 v2, v3, 4, v2
    s_mul_i32 s76, s73, 696320
    s_add_u32 s76, s76, 19398656
    s_lshl_b32 s74, s72, 9
    s_add_u32 s76, s76, s74
    s_waitcnt vmcnt(0)
    ds_read_b64_tr_b16 v[16:17], v1 offset:0
    ds_read_b64_tr_b16 v[18:19], v1 offset:2560
    ds_read_b64_tr_b16 v[20:21], v1 offset:64
    ds_read_b64_tr_b16 v[22:23], v1 offset:2624
    ds_read_b64_tr_b16 v[24:25], v1 offset:128
    ds_read_b64_tr_b16 v[26:27], v1 offset:2688
    ds_read_b64_tr_b16 v[28:29], v1 offset:192
    ds_read_b64_tr_b16 v[30:31], v1 offset:2752
    ds_read_b64_tr_b16 v[32:33], v1 offset:256
    ds_read_b64_tr_b16 v[34:35], v1 offset:2816
    s_cmp_eq_u32 s77, 16
    s_cbranch_scc1 gated_mix__softmax_full_mha__glu_gated_geglu__prompt_kernel_tx
    s_waitcnt lgkmcnt(8)
    buffer_store_dwordx4 v[16:19], v2, s[32:35], s76 offen sc1
    s_add_u32 s76, s76, 139264
    s_waitcnt lgkmcnt(6)
    buffer_store_dwordx4 v[20:23], v2, s[32:35], s76 offen sc1
    s_add_u32 s76, s76, 139264
    s_waitcnt lgkmcnt(4)
    buffer_store_dwordx4 v[24:27], v2, s[32:35], s76 offen sc1
    s_add_u32 s76, s76, 139264
    s_waitcnt lgkmcnt(2)
    buffer_store_dwordx4 v[28:31], v2, s[32:35], s76 offen sc1
    s_add_u32 s76, s76, 139264
    s_waitcnt lgkmcnt(0)
    buffer_store_dwordx4 v[32:35], v2, s[32:35], s76 offen sc1
    s_branch gated_mix__softmax_full_mha__glu_gated_geglu__prompt_kernel_gate
gated_mix__softmax_full_mha__glu_gated_geglu__prompt_kernel_tx:
    s_waitcnt lgkmcnt(8)
    buffer_store_dwordx2 v[16:17], v4, s[32:35], s76 offen sc1
    buffer_store_dwordx2 v[18:19], v4, s[32:35], s76 offen offset:256 sc1
    s_add_u32 s76, s76, 139264
    s_waitcnt lgkmcnt(6)
    buffer_store_dwordx2 v[20:21], v4, s[32:35], s76 offen sc1
    buffer_store_dwordx2 v[22:23], v4, s[32:35], s76 offen offset:256 sc1
    s_add_u32 s76, s76, 139264
    s_waitcnt lgkmcnt(4)
    buffer_store_dwordx2 v[24:25], v4, s[32:35], s76 offen sc1
    buffer_store_dwordx2 v[26:27], v4, s[32:35], s76 offen offset:256 sc1
    s_add_u32 s76, s76, 139264
    s_waitcnt lgkmcnt(2)
    buffer_store_dwordx2 v[28:29], v4, s[32:35], s76 offen sc1
    buffer_store_dwordx2 v[30:31], v4, s[32:35], s76 offen offset:256 sc1
    s_add_u32 s76, s76, 139264
    s_waitcnt lgkmcnt(0)
    buffer_store_dwordx2 v[32:33], v4, s[32:35], s76 offen sc1
    buffer_store_dwordx2 v[34:35], v4, s[32:35], s76 offen offset:256 sc1
    s_branch gated_mix__softmax_full_mha__glu_gated_geglu__prompt_kernel_gate
gated_mix__softmax_full_mha__glu_gated_geglu__prompt_kernel_idle:
    s_mov_b32 s19, 0
    s_waitcnt lgkmcnt(0)
    s_cmp_lt_u32 s3, 4
    s_cbranch_scc1 gated_mix__softmax_full_mha__glu_gated_geglu__prompt_kernel_join
    s_sub_u32 s3, s3, 4
    s_waitcnt lgkmcnt(0)
    s_mov_b32 s20, s4
    s_and_b32 s21, s5, 0xffff
    s_mov_b32 s22, 2621440
    s_mov_b32 s23, 0x20000
    s_mov_b32 s32, s16
    s_and_b32 s33, s17, 0xffff
    s_mov_b32 s34, 22261760
    s_mov_b32 s35, 0x20000
gated_mix__softmax_full_mha__glu_gated_geglu__prompt_kernel_gate:
    s_mov_b32 s24, s78
    s_and_b32 s25, s79, 0xffff
    s_mov_b32 s26, 1280
    s_mov_b32 s27, 0x20000
    v_mul_u32_u24 v1, 20, v0
    s_lshl_b32 s47, s2, 3
    s_lshl_b32 s48, s3, 1
    s_add_u32 s47, s47, s48
    s_mul_i32 s48, s47, 1280
    buffer_load_dwordx4 v[40:43], v1, s[24:27], 0 offen
    buffer_load_dword v44, v1, s[24:27], 0 offen offset:16
    buffer_load_dwordx4 v[48:51], v1, s[20:23], s48 offen
    buffer_load_dword v52, v1, s[20:23], s48 offen offset:16
    buffer_load_dwordx4 v[56:59], v1, s[20:23], s48 offen offset:1280
    buffer_load_dword v60, v1, s[20:23], s48 offen offset:1296
    v_mov_b32 v2, 0
    v_mov_b32 v3, 0
    v_lshlrev_b32 v4, 2, v0
    s_cmp_lg_u32 s3, 99
    s_cbranch_scc1 gated_mix__softmax_full_mha__glu_gated_geglu__prompt_kernel_nofl
    s_cmp_ge_u32 s2, 8
    s_cbranch_scc1 gated_mix__softmax_full_mha__glu_gated_geglu__prompt_kernel_nofl
    s_lshl_b32 s49, s2, 12
    s_add_u32 s49, s49, 22192128
    s_mov_b32 exec_hi, 0
    buffer_store_dword v2, v4, s[32:35], s49 offen sc1
    s_mov_b32 exec_hi, -1
gated_mix__softmax_full_mha__glu_gated_geglu__prompt_kernel_nofl:
    s_waitcnt vmcnt(0)
    v_dot2_f32_bf16 v2, v48, v40, v2
    v_dot2_f32_bf16 v3, v56, v40, v3
    v_dot2_f32_bf16 v2, v49, v41, v2
    v_dot2_f32_bf16 v3, v57, v41, v3
    v_dot2_f32_bf16 v2, v50, v42, v2
    v_dot2_f32_bf16 v3, v58, v42, v3
    v_dot2_f32_bf16 v2, v51, v43, v2
    v_dot2_f32_bf16 v3, v59, v43, v3
    v_dot2_f32_bf16 v2, v52, v44, v2
    v_dot2_f32_bf16 v3, v60, v44, v3
    s_nop 3
    v_add_f32_dpp v2, v2, v2 row_shr:1 row_mask:0xf bank_mask:0xf bound_ctrl:0
    v_add_f32_dpp v3, v3, v3 row_shr:1 row_mask:0xf bank_mask:0xf bound_ctrl:0
    s_nop 0
    v_add_f32_dpp v2, v2, v2 row_shr:2 row_mask:0xf bank_mask:0xf bound_ctrl:0
    v_add_f32_dpp v3, v3, v3 row_shr:2 row_mask:0xf bank_mask:0xf bound_ctrl:0
    s_nop 0
    v_add_f32_dpp v2, v2, v2 row_shr:4 row_mask:0xf bank_mask:0xf bound_ctrl:0
    v_add_f32_dpp v3, v3, v3 row_shr:4 row_mask:0xf bank_mask:0xf bound_ctrl:0
    s_nop 0
    v_add_f32_dpp v2, v2, v2 row_shr:8 row_mask:0xf bank_mask:0xf bound_ctrl:0
    v_add_f32_dpp v3, v3, v3 row_shr:8 row_mask:0xf bank_mask:0xf bound_ctrl:0
    s_nop 0
    v_add_f32_dpp v2, v2, v2 row_bcast:15 row_mask:0xa bank_mask:0xf
    v_add_f32_dpp v3, v3, v3 row_bcast:15 row_mask:0xa bank_mask:0xf
    s_nop 0
    v_add_f32_dpp v2, v2, v2 row_bcast:31 row_mask:0xc bank_mask:0xf
    v_add_f32_dpp v3, v3, v3 row_bcast:31 row_mask:0xc bank_mask:0xf
    s_nop 0
    v_mul_f32 v2, 0xbfb8aa3b, v2
    v_mul_f32 v3, 0xbfb8aa3b, v3
    v_exp_f32 v2, v2
    v_exp_f32 v3, v3
    s_nop 0
    v_add_f32 v2, 1.0, v2
    v_add_f32 v3, 1.0, v3
    v_rcp_f32 v2, v2
    v_rcp_f32 v3, v3
    s_lshl_b32 s49, s47, 2
    s_add_u32 s49, s49, 22183936
    v_mov_b32 v4, 0
    s_mov_b32 exec_lo, 0
    s_mov_b32 exec_hi, 0x80000000
    buffer_store_dwordx2 v[2:3], v4, s[32:35], s49 offen sc1
    s_branch gated_mix__softmax_full_mha__glu_gated_geglu__prompt_kernel_join
.p2align 12
.fill 137, 4, 0xbf800000
gated_mix__softmax_full_mha__glu_gated_geglu__prompt_kernel_compute:
    s_cmp_lg_u32 s3, 0
    s_cbranch_scc1 gated_mix__softmax_full_mha__glu_gated_geglu__prompt_kernel_nocp
    s_getpc_b64 s[56:57]
gated_mix__softmax_full_mha__glu_gated_geglu__prompt_kernel_pc:
    s_sub_u32 s56, s56, gated_mix__softmax_full_mha__glu_gated_geglu__prompt_kernel_pc-gated_mix__softmax_full_mha__glu_gated_geglu__prompt_kernel
    s_subb_u32 s57, s57, 0
    s_lshl_b32 s58, s41, 11
    v_lshlrev_b32 v1, 7, v0
    v_add_u32 v1, s58, v1
    s_mov_b32 s59, code_end-gated_mix__softmax_full_mha__glu_gated_geglu__prompt_kernel
    v_cmp_gt_u32 vcc, s59, v1
    s_and_b64 exec, vcc, 0xffff
    s_cbranch_execz gated_mix__softmax_full_mha__glu_gated_geglu__prompt_kernel_cpx
    global_load_dword v255, v1, s[56:57]
gated_mix__softmax_full_mha__glu_gated_geglu__prompt_kernel_cpx:
    s_mov_b64 exec, -1
gated_mix__softmax_full_mha__glu_gated_geglu__prompt_kernel_nocp:
    s_lshl_b32 s56, s2, 3
    s_add_u32 s56, s56, s3
    s_cmp_lg_u32 s56, 1
    s_cbranch_scc1 gated_mix__softmax_full_mha__glu_gated_geglu__prompt_kernel_notag
    s_load_dwordx2 s[56:57], s[0:1], 72
    s_memrealtime s[58:59]
    v_mov_b32 v1, 0
    s_waitcnt lgkmcnt(0)
    s_or_b32 s58, s58, 1
    v_mov_b32 v2, s58
    s_mov_b64 exec, 1
    global_store_dword v1, v2, s[56:57] sc1
    s_mov_b64 exec, -1
gated_mix__softmax_full_mha__glu_gated_geglu__prompt_kernel_notag:
    v_and_b32 v1, 15, v0
    v_lshrrev_b32 v2, 4, v0
    v_bfe_u32 v3, v0, 2, 2
    v_lshl_add_u32 v6, v2, 3, v3
    v_lshlrev_b32 v6, 8, v6
    v_and_b32 v4, 3, v0
    v_lshl_add_u32 v6, v4, 3, v6
    v_and_b32 v5, 1, v2
    v_lshl_add_u32 v5, v5, 2, v3
    v_lshrrev_b32 v3, 1, v1
    v_xor_b32 v3, v3, v2
    v_lshlrev_b32 v3, 4, v3
    v_and_b32 v4, 8, v1
    v_lshl_add_u32 v3, v1, 7, v3
    v_lshl_add_u32 v240, v4, 7, v3
    s_mul_i32 s46, s18, 5
    s_mov_b32 s47, 5
    s_cmp_eq_u32 s18, 12
    s_cmov_b32 s47, 4
    s_cmp_eq_u32 s19, 19
    s_cbranch_scc1 gated_mix__softmax_full_mha__glu_gated_geglu__prompt_kernel_spec
    s_lshl_b32 s45, s3, 1
    v_xor_b32 v5, s45, v5
    v_lshl_add_u32 v6, v5, 5, v6
    v_add_u32 v243, 20480, v6
    v_xor_b32 v244, 32, v243
    v_add_u32 v245, 16384, v243
    v_add_u32 v246, 16384, v244
    s_sub_u32 s48, s19, 17
    s_lshl_b32 s48, s48, 8
    s_lshl_b32 s49, s3, 5
    s_add_u32 s48, s48, s49
    s_movk_i32 s49, 128
    s_branch gated_mix__softmax_full_mha__glu_gated_geglu__prompt_kernel_cont
gated_mix__softmax_full_mha__glu_gated_geglu__prompt_kernel_spec:
    s_and_b32 s45, s3, 1
    s_lshl_b32 s48, s45, 6
    s_add_u32 s48, s48, 512
    s_lshl_b32 s45, s45, 2
    v_xor_b32 v5, s45, v5
    v_lshl_add_u32 v6, v5, 5, v6
    v_add_u32 v243, 32768, v6
    v_xor_b32 v244, 32, v243
    v_xor_b32 v245, 64, v243
    v_xor_b32 v246, 96, v243
    s_lshr_b32 s45, s3, 1
    s_lshl_b32 s46, s18, 3
    s_lshl_b32 s49, s45, 2
    s_add_u32 s46, s46, s49
    s_lshl_b32 s45, s45, 14
    v_add_u32 v240, s45, v240
    s_mov_b32 s47, 4
    s_mov_b32 s49, 32
gated_mix__softmax_full_mha__glu_gated_geglu__prompt_kernel_cont:
    v_mov_b32 v251, 0
    v_mov_b32 v252, 0
    v_mov_b32 v253, 0
    v_mov_b32 v254, 0
    v_mov_b32 v80, 0
    v_mov_b32 v81, 0
    v_mov_b32 v82, 0
    v_mov_b32 v83, 0
    v_mov_b32 v84, 0
    v_mov_b32 v85, 0
    v_mov_b32 v86, 0
    v_mov_b32 v87, 0
    v_mov_b32 v88, 0
    v_mov_b32 v89, 0
    v_mov_b32 v90, 0
    v_mov_b32 v91, 0
    v_mov_b32 v92, 0
    v_mov_b32 v93, 0
    v_mov_b32 v94, 0
    v_mov_b32 v95, 0
    v_mov_b32 v96, 0
    v_mov_b32 v97, 0
    v_mov_b32 v98, 0
    v_mov_b32 v99, 0
    v_mov_b32 v100, 0
    v_mov_b32 v101, 0
    v_mov_b32 v102, 0
    v_mov_b32 v103, 0
    v_mov_b32 v104, 0
    v_mov_b32 v105, 0
    v_mov_b32 v106, 0
    v_mov_b32 v107, 0
    v_mov_b32 v108, 0
    v_mov_b32 v109, 0
    v_mov_b32 v110, 0
    v_mov_b32 v111, 0
    v_mov_b32 v112, 0
    v_mov_b32 v113, 0
    v_mov_b32 v114, 0
    v_mov_b32 v115, 0
    v_mov_b32 v116, 0
    v_mov_b32 v117, 0
    v_mov_b32 v118, 0
    v_mov_b32 v119, 0
    v_mov_b32 v120, 0
    v_mov_b32 v121, 0
    v_mov_b32 v122, 0
    v_mov_b32 v123, 0
    v_mov_b32 v124, 0
    v_mov_b32 v125, 0
    v_mov_b32 v126, 0
    v_mov_b32 v127, 0
    v_mov_b32 v128, 0
    v_mov_b32 v129, 0
    v_mov_b32 v130, 0
    v_mov_b32 v131, 0
    v_mov_b32 v132, 0
    v_mov_b32 v133, 0
    v_mov_b32 v134, 0
    v_mov_b32 v135, 0
    v_mov_b32 v136, 0
    v_mov_b32 v137, 0
    v_mov_b32 v138, 0
    v_mov_b32 v139, 0
    v_mov_b32 v140, 0
    v_mov_b32 v141, 0
    v_mov_b32 v142, 0
    v_mov_b32 v143, 0
    v_mov_b32 v144, 0
    v_mov_b32 v145, 0
    v_mov_b32 v146, 0
    v_mov_b32 v147, 0
    v_mov_b32 v148, 0
    v_mov_b32 v149, 0
    v_mov_b32 v150, 0
    v_mov_b32 v151, 0
    v_mov_b32 v152, 0
    v_mov_b32 v153, 0
    v_mov_b32 v154, 0
    v_mov_b32 v155, 0
    v_mov_b32 v156, 0
    v_mov_b32 v157, 0
    v_mov_b32 v158, 0
    v_mov_b32 v159, 0
    v_mov_b32 v160, 0
    v_mov_b32 v161, 0
    v_mov_b32 v162, 0
    v_mov_b32 v163, 0
    v_mov_b32 v164, 0
    v_mov_b32 v165, 0
    v_mov_b32 v166, 0
    v_mov_b32 v167, 0
    v_mov_b32 v168, 0
    v_mov_b32 v169, 0
    v_mov_b32 v170, 0
    v_mov_b32 v171, 0
    v_mov_b32 v172, 0
    v_mov_b32 v173, 0
    v_mov_b32 v174, 0
    v_mov_b32 v175, 0
    v_mov_b32 v176, 0
    v_mov_b32 v177, 0
    v_mov_b32 v178, 0
    v_mov_b32 v179, 0
    v_mov_b32 v180, 0
    v_mov_b32 v181, 0
    v_mov_b32 v182, 0
    v_mov_b32 v183, 0
    v_mov_b32 v184, 0
    v_mov_b32 v185, 0
    v_mov_b32 v186, 0
    v_mov_b32 v187, 0
    v_mov_b32 v188, 0
    v_mov_b32 v189, 0
    v_mov_b32 v190, 0
    v_mov_b32 v191, 0
    v_mov_b32 v192, 0
    v_mov_b32 v193, 0
    v_mov_b32 v194, 0
    v_mov_b32 v195, 0
    v_mov_b32 v196, 0
    v_mov_b32 v197, 0
    v_mov_b32 v198, 0
    v_mov_b32 v199, 0
    v_mov_b32 v200, 0
    v_mov_b32 v201, 0
    v_mov_b32 v202, 0
    v_mov_b32 v203, 0
    v_mov_b32 v204, 0
    v_mov_b32 v205, 0
    v_mov_b32 v206, 0
    v_mov_b32 v207, 0
    v_mov_b32 v208, 0
    v_mov_b32 v209, 0
    v_mov_b32 v210, 0
    v_mov_b32 v211, 0
    v_mov_b32 v212, 0
    v_mov_b32 v213, 0
    v_mov_b32 v214, 0
    v_mov_b32 v215, 0
    v_mov_b32 v216, 0
    v_mov_b32 v217, 0
    v_mov_b32 v218, 0
    v_mov_b32 v219, 0
    v_mov_b32 v220, 0
    v_mov_b32 v221, 0
    v_mov_b32 v222, 0
    v_mov_b32 v223, 0
    v_mov_b32 v224, 0
    v_mov_b32 v225, 0
    v_mov_b32 v226, 0
    v_mov_b32 v227, 0
    v_mov_b32 v228, 0
    v_mov_b32 v229, 0
    v_mov_b32 v230, 0
    v_mov_b32 v231, 0
    v_mov_b32 v232, 0
    v_mov_b32 v233, 0
    v_mov_b32 v234, 0
    v_mov_b32 v235, 0
    v_mov_b32 v236, 0
    v_mov_b32 v237, 0
    v_mov_b32 v238, 0
    v_mov_b32 v239, 0
    s_waitcnt lgkmcnt(0)
    s_mov_b32 s20, s16
    s_and_b32 s21, s17, 0xffff
    s_mov_b32 s22, 22261760
    s_mov_b32 s23, 0x20000
    s_cmp_ge_u32 s19, 17
    s_cbranch_scc1 gated_mix__softmax_full_mha__glu_gated_geglu__prompt_kernel_v
    s_cmp_lt_u32 s19, 12
    s_cbranch_scc1 gated_mix__softmax_full_mha__glu_gated_geglu__prompt_kernel_loop
gated_mix__softmax_full_mha__glu_gated_geglu__prompt_kernel_qk:
    s_sub_u32 s48, s19, 12
    s_lshl_b32 s48, s48, 6
    s_lshl_b32 s49, s3, 3
    s_add_u32 s48, s48, s49
    s_add_u32 s49, s48, 32
    s_cmp_lt_u32 s48, 160
    s_cselect_b32 s52, 0x3ea52b5c, 1.0
    s_cselect_b32 s50, 0, 5242880
    s_cselect_b32 s54, 0, 160
    s_sub_u32 s48, s48, s54
    s_cmp_lt_u32 s49, 160
    s_cselect_b32 s53, 0x3ea52b5c, 1.0
    s_cselect_b32 s51, 0, 5242880
    s_cselect_b32 s54, 0, 160
    s_sub_u32 s49, s49, s54
    v_lshlrev_b32 v11, 4, v1
    s_mov_b32 s54, 163840
    v_add_u32 v8, s48, v2
    v_add_u32 v8, 0, v8
    v_mul_u32_u24 v9, 205, v8
    v_lshrrev_b32 v9, 10, v9
    v_mul_u32_u24 v12, 5, v9
    v_sub_u32 v8, v8, v12
    v_lshrrev_b32 v12, 1, v8
    v_and_b32 v13, 1, v8
    v_lshl_add_u32 v13, v13, 1, v12
    v_cmp_eq_u32 vcc, 4, v8
    v_mad_u32_u24 v9, v9, s54, v11
    v_add_u32 v9, s50, v9
    v_cndmask_b32 v12, v13, v8, vcc
    v_lshlrev_b32 v12, 8, v12
    v_add_u32 v251, v9, v12
    v_add_u32 v8, s48, v2
    v_add_u32 v8, 4, v8
    v_mul_u32_u24 v9, 205, v8
    v_lshrrev_b32 v9, 10, v9
    v_mul_u32_u24 v12, 5, v9
    v_sub_u32 v8, v8, v12
    v_lshrrev_b32 v12, 1, v8
    v_and_b32 v13, 1, v8
    v_lshl_add_u32 v13, v13, 1, v12
    v_cmp_eq_u32 vcc, 4, v8
    v_mad_u32_u24 v9, v9, s54, v11
    v_add_u32 v9, s50, v9
    v_cndmask_b32 v12, v13, v8, vcc
    v_lshlrev_b32 v12, 8, v12
    v_add_u32 v252, v9, v12
    v_add_u32 v8, s49, v2
    v_add_u32 v8, 0, v8
    v_mul_u32_u24 v9, 205, v8
    v_lshrrev_b32 v9, 10, v9
    v_mul_u32_u24 v12, 5, v9
    v_sub_u32 v8, v8, v12
    v_lshrrev_b32 v12, 1, v8
    v_and_b32 v13, 1, v8
    v_lshl_add_u32 v13, v13, 1, v12
    v_cmp_eq_u32 vcc, 4, v8
    v_mad_u32_u24 v9, v9, s54, v11
    v_add_u32 v9, s51, v9
    v_cndmask_b32 v12, v13, v8, vcc
    v_lshlrev_b32 v12, 8, v12
    v_add_u32 v253, v9, v12
    v_add_u32 v8, s49, v2
    v_add_u32 v8, 4, v8
    v_mul_u32_u24 v9, 205, v8
    v_lshrrev_b32 v9, 10, v9
    v_mul_u32_u24 v12, 5, v9
    v_sub_u32 v8, v8, v12
    v_lshrrev_b32 v12, 1, v8
    v_and_b32 v13, 1, v8
    v_lshl_add_u32 v13, v13, 1, v12
    v_cmp_eq_u32 vcc, 4, v8
    v_mad_u32_u24 v9, v9, s54, v11
    v_add_u32 v9, s51, v9
    v_cndmask_b32 v12, v13, v8, vcc
    v_lshlrev_b32 v12, 8, v12
    v_add_u32 v254, v9, v12
gated_mix__softmax_full_mha__glu_gated_geglu__prompt_kernel_loop:
    s_mov_b32 s36, 0
    s_mov_b32 s37, 0
    v_mov_b32 v241, v240
    v_mov_b32 v242, v240
    v_mov_b32 v247, v243
    v_mov_b32 v248, v244
    v_mov_b32 v249, v245
    v_mov_b32 v250, v246
    s_barrier
    ds_read_b128 v[8:11], v242 offset:0
    ds_read_b128 v[12:15], v242 offset:1024
    ds_read_b128 v[16:19], v242 offset:4096
    ds_read_b64_tr_b16 v[48:49], v247 offset:0
    ds_read_b128 v[20:23], v242 offset:5120
    ds_read_b64_tr_b16 v[50:51], v247 offset:1024
    ds_read_b128 v[24:27], v242 offset:8192
    ds_read_b64_tr_b16 v[52:53], v248 offset:0
    ds_read_b128 v[28:31], v242 offset:9216
    ds_read_b64_tr_b16 v[54:55], v248 offset:1024
    ds_read_b128 v[32:35], v242 offset:12288
    ds_read_b64_tr_b16 v[56:57], v249 offset:0
    ds_read_b128 v[36:39], v242 offset:13312
    ds_read_b64_tr_b16 v[58:59], v249 offset:1024
    ds_read_b128 v[40:43], v242 offset:16384
    ds_read_b64_tr_b16 v[60:61], v250 offset:0
    ds_read_b64_tr_b16 v[62:63], v250 offset:1024
    ds_read_b128 v[44:47], v242 offset:17408
    s_waitcnt lgkmcnt(12)
    v_mfma_f32_16x16x32_bf16 v[80:83], v[48:51], v[8:11], v[80:83]
    v_xor_b32 v242, 64, v241
    s_waitcnt lgkmcnt(8)
    v_mfma_f32_16x16x32_bf16 v[84:87], v[52:55], v[8:11], v[84:87]
    s_waitcnt lgkmcnt(4)
    v_mfma_f32_16x16x32_bf16 v[88:91], v[56:59], v[8:11], v[88:91]
    s_waitcnt lgkmcnt(1)
    v_mfma_f32_16x16x32_bf16 v[92:95], v[60:63], v[8:11], v[92:95]
    v_mfma_f32_16x16x32_bf16 v[96:99], v[48:51], v[12:15], v[96:99]
    v_mfma_f32_16x16x32_bf16 v[100:103], v[52:55], v[12:15], v[100:103]
    v_mfma_f32_16x16x32_bf16 v[104:107], v[56:59], v[12:15], v[104:107]
    v_mfma_f32_16x16x32_bf16 v[108:111], v[60:63], v[12:15], v[108:111]
    s_waitcnt lgkmcnt(0)
    s_barrier
    ds_read_b128 v[8:11], v242 offset:0
    v_mfma_f32_16x16x32_bf16 v[112:115], v[48:51], v[16:19], v[112:115]
    v_mfma_f32_16x16x32_bf16 v[116:119], v[52:55], v[16:19], v[116:119]
    ds_read_b128 v[12:15], v242 offset:1024
    v_mfma_f32_16x16x32_bf16 v[120:123], v[56:59], v[16:19], v[120:123]
    v_mfma_f32_16x16x32_bf16 v[124:127], v[60:63], v[16:19], v[124:127]
    ds_read_b128 v[16:19], v242 offset:4096
    v_mfma_f32_16x16x32_bf16 v[128:131], v[48:51], v[20:23], v[128:131]
    v_mfma_f32_16x16x32_bf16 v[132:135], v[52:55], v[20:23], v[132:135]
    ds_read_b64_tr_b16 v[64:65], v247 offset:8192
    v_mfma_f32_16x16x32_bf16 v[136:139], v[56:59], v[20:23], v[136:139]
    v_mfma_f32_16x16x32_bf16 v[140:143], v[60:63], v[20:23], v[140:143]
    ds_read_b128 v[20:23], v242 offset:5120
    v_mfma_f32_16x16x32_bf16 v[144:147], v[48:51], v[24:27], v[144:147]
    v_mfma_f32_16x16x32_bf16 v[148:151], v[52:55], v[24:27], v[148:151]
    ds_read_b64_tr_b16 v[66:67], v247 offset:9216
    v_mfma_f32_16x16x32_bf16 v[152:155], v[56:59], v[24:27], v[152:155]
    v_mfma_f32_16x16x32_bf16 v[156:159], v[60:63], v[24:27], v[156:159]
    ds_read_b128 v[24:27], v242 offset:8192
    v_mfma_f32_16x16x32_bf16 v[160:163], v[48:51], v[28:31], v[160:163]
    v_mfma_f32_16x16x32_bf16 v[164:167], v[52:55], v[28:31], v[164:167]
    ds_read_b64_tr_b16 v[68:69], v248 offset:8192
    v_mfma_f32_16x16x32_bf16 v[168:171], v[56:59], v[28:31], v[168:171]
    v_mfma_f32_16x16x32_bf16 v[172:175], v[60:63], v[28:31], v[172:175]
    ds_read_b128 v[28:31], v242 offset:9216
    v_mfma_f32_16x16x32_bf16 v[176:179], v[48:51], v[32:35], v[176:179]
    v_mfma_f32_16x16x32_bf16 v[180:183], v[52:55], v[32:35], v[180:183]
    ds_read_b64_tr_b16 v[70:71], v248 offset:9216
    v_mfma_f32_16x16x32_bf16 v[184:187], v[56:59], v[32:35], v[184:187]
    v_mfma_f32_16x16x32_bf16 v[188:191], v[60:63], v[32:35], v[188:191]
    ds_read_b128 v[32:35], v242 offset:12288
    v_mfma_f32_16x16x32_bf16 v[192:195], v[48:51], v[36:39], v[192:195]
    v_mfma_f32_16x16x32_bf16 v[196:199], v[52:55], v[36:39], v[196:199]
    ds_read_b64_tr_b16 v[72:73], v249 offset:8192
    v_mfma_f32_16x16x32_bf16 v[200:203], v[56:59], v[36:39], v[200:203]
    v_mfma_f32_16x16x32_bf16 v[204:207], v[60:63], v[36:39], v[204:207]
    ds_read_b128 v[36:39], v242 offset:13312
    v_mfma_f32_16x16x32_bf16 v[208:211], v[48:51], v[40:43], v[208:211]
    v_mfma_f32_16x16x32_bf16 v[212:215], v[52:55], v[40:43], v[212:215]
    ds_read_b64_tr_b16 v[74:75], v249 offset:9216
    v_mfma_f32_16x16x32_bf16 v[216:219], v[56:59], v[40:43], v[216:219]
    v_mfma_f32_16x16x32_bf16 v[220:223], v[60:63], v[40:43], v[220:223]
    ds_read_b128 v[40:43], v242 offset:16384
    v_mfma_f32_16x16x32_bf16 v[224:227], v[48:51], v[44:47], v[224:227]
    ds_read_b64_tr_b16 v[76:77], v250 offset:8192
    v_mfma_f32_16x16x32_bf16 v[228:231], v[52:55], v[44:47], v[228:231]
    ds_read_b64_tr_b16 v[78:79], v250 offset:9216
    v_mfma_f32_16x16x32_bf16 v[232:235], v[56:59], v[44:47], v[232:235]
    v_mfma_f32_16x16x32_bf16 v[236:239], v[60:63], v[44:47], v[236:239]
    ds_read_b128 v[44:47], v242 offset:17408
    s_waitcnt lgkmcnt(12)
    v_mfma_f32_16x16x32_bf16 v[80:83], v[64:67], v[8:11], v[80:83]
    s_add_u32 s36, s36, 53248
    s_cmp_eq_u32 s36, 159744
    s_waitcnt lgkmcnt(8)
    v_mfma_f32_16x16x32_bf16 v[84:87], v[68:71], v[8:11], v[84:87]
    s_cselect_b32 s36, 0, s36
    s_add_u32 s37, s37, 1
    s_waitcnt lgkmcnt(4)
    v_mfma_f32_16x16x32_bf16 v[88:91], v[72:75], v[8:11], v[88:91]
    v_add_u32 v241, s36, v240
    v_add_u32 v242, s36, v240
    s_waitcnt lgkmcnt(1)
    v_mfma_f32_16x16x32_bf16 v[92:95], v[76:79], v[8:11], v[92:95]
    v_add_u32 v247, s36, v243
    v_add_u32 v248, s36, v244
    v_mfma_f32_16x16x32_bf16 v[96:99], v[64:67], v[12:15], v[96:99]
    v_add_u32 v249, s36, v245
    v_add_u32 v250, s36, v246
    v_mfma_f32_16x16x32_bf16 v[100:103], v[68:71], v[12:15], v[100:103]
    s_cmp_eq_u32 s37, 10
    v_mfma_f32_16x16x32_bf16 v[104:107], v[72:75], v[12:15], v[104:107]
    v_mfma_f32_16x16x32_bf16 v[108:111], v[76:79], v[12:15], v[108:111]
    s_waitcnt lgkmcnt(0)
    s_barrier
    ds_read_b128 v[8:11], v242 offset:0
    v_mfma_f32_16x16x32_bf16 v[112:115], v[64:67], v[16:19], v[112:115]
    v_mfma_f32_16x16x32_bf16 v[116:119], v[68:71], v[16:19], v[116:119]
    ds_read_b128 v[12:15], v242 offset:1024
    v_mfma_f32_16x16x32_bf16 v[120:123], v[72:75], v[16:19], v[120:123]
    v_mfma_f32_16x16x32_bf16 v[124:127], v[76:79], v[16:19], v[124:127]
    ds_read_b128 v[16:19], v242 offset:4096
    v_mfma_f32_16x16x32_bf16 v[128:131], v[64:67], v[20:23], v[128:131]
    v_mfma_f32_16x16x32_bf16 v[132:135], v[68:71], v[20:23], v[132:135]
    ds_read_b64_tr_b16 v[48:49], v247 offset:0
    v_mfma_f32_16x16x32_bf16 v[136:139], v[72:75], v[20:23], v[136:139]
    v_mfma_f32_16x16x32_bf16 v[140:143], v[76:79], v[20:23], v[140:143]
    ds_read_b128 v[20:23], v242 offset:5120
    v_mfma_f32_16x16x32_bf16 v[144:147], v[64:67], v[24:27], v[144:147]
    v_mfma_f32_16x16x32_bf16 v[148:151], v[68:71], v[24:27], v[148:151]
    ds_read_b64_tr_b16 v[50:51], v247 offset:1024
    v_mfma_f32_16x16x32_bf16 v[152:155], v[72:75], v[24:27], v[152:155]
    v_mfma_f32_16x16x32_bf16 v[156:159], v[76:79], v[24:27], v[156:159]
    ds_read_b128 v[24:27], v242 offset:8192
    v_mfma_f32_16x16x32_bf16 v[160:163], v[64:67], v[28:31], v[160:163]
    v_mfma_f32_16x16x32_bf16 v[164:167], v[68:71], v[28:31], v[164:167]
    ds_read_b64_tr_b16 v[52:53], v248 offset:0
    v_mfma_f32_16x16x32_bf16 v[168:171], v[72:75], v[28:31], v[168:171]
    v_mfma_f32_16x16x32_bf16 v[172:175], v[76:79], v[28:31], v[172:175]
    ds_read_b128 v[28:31], v242 offset:9216
    v_mfma_f32_16x16x32_bf16 v[176:179], v[64:67], v[32:35], v[176:179]
    v_mfma_f32_16x16x32_bf16 v[180:183], v[68:71], v[32:35], v[180:183]
    ds_read_b64_tr_b16 v[54:55], v248 offset:1024
    v_mfma_f32_16x16x32_bf16 v[184:187], v[72:75], v[32:35], v[184:187]
    v_mfma_f32_16x16x32_bf16 v[188:191], v[76:79], v[32:35], v[188:191]
    ds_read_b128 v[32:35], v242 offset:12288
    v_mfma_f32_16x16x32_bf16 v[192:195], v[64:67], v[36:39], v[192:195]
    v_mfma_f32_16x16x32_bf16 v[196:199], v[68:71], v[36:39], v[196:199]
    ds_read_b64_tr_b16 v[56:57], v249 offset:0
    v_mfma_f32_16x16x32_bf16 v[200:203], v[72:75], v[36:39], v[200:203]
    v_mfma_f32_16x16x32_bf16 v[204:207], v[76:79], v[36:39], v[204:207]
    ds_read_b128 v[36:39], v242 offset:13312
    v_mfma_f32_16x16x32_bf16 v[208:211], v[64:67], v[40:43], v[208:211]
    v_mfma_f32_16x16x32_bf16 v[212:215], v[68:71], v[40:43], v[212:215]
    ds_read_b64_tr_b16 v[58:59], v249 offset:1024
    v_mfma_f32_16x16x32_bf16 v[216:219], v[72:75], v[40:43], v[216:219]
    v_mfma_f32_16x16x32_bf16 v[220:223], v[76:79], v[40:43], v[220:223]
    ds_read_b128 v[40:43], v242 offset:16384
    v_mfma_f32_16x16x32_bf16 v[224:227], v[64:67], v[44:47], v[224:227]
    ds_read_b64_tr_b16 v[60:61], v250 offset:0
    v_mfma_f32_16x16x32_bf16 v[228:231], v[68:71], v[44:47], v[228:231]
    ds_read_b64_tr_b16 v[62:63], v250 offset:1024
    v_mfma_f32_16x16x32_bf16 v[232:235], v[72:75], v[44:47], v[232:235]
    v_mfma_f32_16x16x32_bf16 v[236:239], v[76:79], v[44:47], v[236:239]
    ds_read_b128 v[44:47], v242 offset:17408
.p2align 5
Lk1loop_1:
    s_waitcnt lgkmcnt(12)
    v_mfma_f32_16x16x32_bf16 v[80:83], v[48:51], v[8:11], v[80:83]
    v_xor_b32 v242, 64, v241
    s_waitcnt lgkmcnt(8)
    v_mfma_f32_16x16x32_bf16 v[84:87], v[52:55], v[8:11], v[84:87]
    ds_read_b64_tr_b16 v[64:65], v247 offset:8192
    s_waitcnt lgkmcnt(5)
    v_mfma_f32_16x16x32_bf16 v[88:91], v[56:59], v[8:11], v[88:91]
    s_waitcnt lgkmcnt(2)
    v_mfma_f32_16x16x32_bf16 v[92:95], v[60:63], v[8:11], v[92:95]
    ds_read_b128 v[8:11], v242 offset:0
    v_mfma_f32_16x16x32_bf16 v[96:99], v[48:51], v[12:15], v[96:99]
    v_mfma_f32_16x16x32_bf16 v[100:103], v[52:55], v[12:15], v[100:103]
    ds_read_b64_tr_b16 v[66:67], v247 offset:9216
    v_mfma_f32_16x16x32_bf16 v[104:107], v[56:59], v[12:15], v[104:107]
    v_mfma_f32_16x16x32_bf16 v[108:111], v[60:63], v[12:15], v[108:111]
    ds_read_b128 v[12:15], v242 offset:1024
    v_mfma_f32_16x16x32_bf16 v[112:115], v[48:51], v[16:19], v[112:115]
    v_mfma_f32_16x16x32_bf16 v[116:119], v[52:55], v[16:19], v[116:119]
    ds_read_b64_tr_b16 v[68:69], v248 offset:8192
    v_mfma_f32_16x16x32_bf16 v[120:123], v[56:59], v[16:19], v[120:123]
    v_mfma_f32_16x16x32_bf16 v[124:127], v[60:63], v[16:19], v[124:127]
    ds_read_b128 v[16:19], v242 offset:4096
    v_mfma_f32_16x16x32_bf16 v[128:131], v[48:51], v[20:23], v[128:131]
    v_mfma_f32_16x16x32_bf16 v[132:135], v[52:55], v[20:23], v[132:135]
    ds_read_b64_tr_b16 v[70:71], v248 offset:9216
    v_mfma_f32_16x16x32_bf16 v[136:139], v[56:59], v[20:23], v[136:139]
    v_mfma_f32_16x16x32_bf16 v[140:143], v[60:63], v[20:23], v[140:143]
    ds_read_b128 v[20:23], v242 offset:5120
    v_mfma_f32_16x16x32_bf16 v[144:147], v[48:51], v[24:27], v[144:147]
    v_mfma_f32_16x16x32_bf16 v[148:151], v[52:55], v[24:27], v[148:151]
    ds_read_b64_tr_b16 v[72:73], v249 offset:8192
    v_mfma_f32_16x16x32_bf16 v[152:155], v[56:59], v[24:27], v[152:155]
    v_mfma_f32_16x16x32_bf16 v[156:159], v[60:63], v[24:27], v[156:159]
    ds_read_b128 v[24:27], v242 offset:8192
    v_mfma_f32_16x16x32_bf16 v[160:163], v[48:51], v[28:31], v[160:163]
    v_mfma_f32_16x16x32_bf16 v[164:167], v[52:55], v[28:31], v[164:167]
    ds_read_b64_tr_b16 v[74:75], v249 offset:9216
    v_mfma_f32_16x16x32_bf16 v[168:171], v[56:59], v[28:31], v[168:171]
    v_mfma_f32_16x16x32_bf16 v[172:175], v[60:63], v[28:31], v[172:175]
    ds_read_b128 v[28:31], v242 offset:9216
    v_mfma_f32_16x16x32_bf16 v[176:179], v[48:51], v[32:35], v[176:179]
    v_mfma_f32_16x16x32_bf16 v[180:183], v[52:55], v[32:35], v[180:183]
    ds_read_b64_tr_b16 v[76:77], v250 offset:8192
    v_mfma_f32_16x16x32_bf16 v[184:187], v[56:59], v[32:35], v[184:187]
    v_mfma_f32_16x16x32_bf16 v[188:191], v[60:63], v[32:35], v[188:191]
    ds_read_b128 v[32:35], v242 offset:12288
    v_mfma_f32_16x16x32_bf16 v[192:195], v[48:51], v[36:39], v[192:195]
    v_mfma_f32_16x16x32_bf16 v[196:199], v[52:55], v[36:39], v[196:199]
    ds_read_b64_tr_b16 v[78:79], v250 offset:9216
    v_mfma_f32_16x16x32_bf16 v[200:203], v[56:59], v[36:39], v[200:203]
    v_mfma_f32_16x16x32_bf16 v[204:207], v[60:63], v[36:39], v[204:207]
    ds_read_b128 v[36:39], v242 offset:13312
    v_mfma_f32_16x16x32_bf16 v[208:211], v[48:51], v[40:43], v[208:211]
    v_mfma_f32_16x16x32_bf16 v[212:215], v[52:55], v[40:43], v[212:215]
    v_mfma_f32_16x16x32_bf16 v[216:219], v[56:59], v[40:43], v[216:219]
    v_mfma_f32_16x16x32_bf16 v[220:223], v[60:63], v[40:43], v[220:223]
    ds_read_b128 v[40:43], v242 offset:16384
    s_waitcnt lgkmcnt(15)
    v_mfma_f32_16x16x32_bf16 v[224:227], v[48:51], v[44:47], v[224:227]
    v_mfma_f32_16x16x32_bf16 v[228:231], v[52:55], v[44:47], v[228:231]
    v_mfma_f32_16x16x32_bf16 v[232:235], v[56:59], v[44:47], v[232:235]
    v_mfma_f32_16x16x32_bf16 v[236:239], v[60:63], v[44:47], v[236:239]
    ds_read_b128 v[44:47], v242 offset:17408
    s_waitcnt lgkmcnt(15)
    v_mfma_f32_16x16x32_bf16 v[80:83], v[64:67], v[8:11], v[80:83]
    s_add_u32 s36, s36, 53248
    s_cmp_eq_u32 s36, 159744
    s_waitcnt lgkmcnt(11)
    v_mfma_f32_16x16x32_bf16 v[84:87], v[68:71], v[8:11], v[84:87]
    s_cselect_b32 s36, 0, s36
    s_add_u32 s37, s37, 1
    s_waitcnt lgkmcnt(7)
    v_mfma_f32_16x16x32_bf16 v[88:91], v[72:75], v[8:11], v[88:91]
    v_add_u32 v241, s36, v240
    v_add_u32 v242, s36, v240
    s_waitcnt lgkmcnt(3)
    v_mfma_f32_16x16x32_bf16 v[92:95], v[76:79], v[8:11], v[92:95]
    v_add_u32 v247, s36, v243
    v_add_u32 v248, s36, v244
    v_mfma_f32_16x16x32_bf16 v[96:99], v[64:67], v[12:15], v[96:99]
    v_add_u32 v249, s36, v245
    v_add_u32 v250, s36, v246
    v_mfma_f32_16x16x32_bf16 v[100:103], v[68:71], v[12:15], v[100:103]
    s_cmp_eq_u32 s37, 10
    v_mfma_f32_16x16x32_bf16 v[104:107], v[72:75], v[12:15], v[104:107]
    v_mfma_f32_16x16x32_bf16 v[108:111], v[76:79], v[12:15], v[108:111]
    s_waitcnt lgkmcnt(0)
    s_barrier
    ds_read_b128 v[8:11], v242 offset:0
    v_mfma_f32_16x16x32_bf16 v[112:115], v[64:67], v[16:19], v[112:115]
    v_mfma_f32_16x16x32_bf16 v[116:119], v[68:71], v[16:19], v[116:119]
    ds_read_b128 v[12:15], v242 offset:1024
    v_mfma_f32_16x16x32_bf16 v[120:123], v[72:75], v[16:19], v[120:123]
    v_mfma_f32_16x16x32_bf16 v[124:127], v[76:79], v[16:19], v[124:127]
    ds_read_b128 v[16:19], v242 offset:4096
    v_mfma_f32_16x16x32_bf16 v[128:131], v[64:67], v[20:23], v[128:131]
    v_mfma_f32_16x16x32_bf16 v[132:135], v[68:71], v[20:23], v[132:135]
    ds_read_b64_tr_b16 v[48:49], v247 offset:0
    v_mfma_f32_16x16x32_bf16 v[136:139], v[72:75], v[20:23], v[136:139]
    v_mfma_f32_16x16x32_bf16 v[140:143], v[76:79], v[20:23], v[140:143]
    ds_read_b128 v[20:23], v242 offset:5120
    v_mfma_f32_16x16x32_bf16 v[144:147], v[64:67], v[24:27], v[144:147]
    v_mfma_f32_16x16x32_bf16 v[148:151], v[68:71], v[24:27], v[148:151]
    ds_read_b64_tr_b16 v[50:51], v247 offset:1024
    v_mfma_f32_16x16x32_bf16 v[152:155], v[72:75], v[24:27], v[152:155]
    v_mfma_f32_16x16x32_bf16 v[156:159], v[76:79], v[24:27], v[156:159]
    ds_read_b128 v[24:27], v242 offset:8192
    v_mfma_f32_16x16x32_bf16 v[160:163], v[64:67], v[28:31], v[160:163]
    v_mfma_f32_16x16x32_bf16 v[164:167], v[68:71], v[28:31], v[164:167]
    ds_read_b64_tr_b16 v[52:53], v248 offset:0
    v_mfma_f32_16x16x32_bf16 v[168:171], v[72:75], v[28:31], v[168:171]
    v_mfma_f32_16x16x32_bf16 v[172:175], v[76:79], v[28:31], v[172:175]
    ds_read_b128 v[28:31], v242 offset:9216
    v_mfma_f32_16x16x32_bf16 v[176:179], v[64:67], v[32:35], v[176:179]
    v_mfma_f32_16x16x32_bf16 v[180:183], v[68:71], v[32:35], v[180:183]
    ds_read_b64_tr_b16 v[54:55], v248 offset:1024
    v_mfma_f32_16x16x32_bf16 v[184:187], v[72:75], v[32:35], v[184:187]
    v_mfma_f32_16x16x32_bf16 v[188:191], v[76:79], v[32:35], v[188:191]
    ds_read_b128 v[32:35], v242 offset:12288
    v_mfma_f32_16x16x32_bf16 v[192:195], v[64:67], v[36:39], v[192:195]
    v_mfma_f32_16x16x32_bf16 v[196:199], v[68:71], v[36:39], v[196:199]
    ds_read_b64_tr_b16 v[56:57], v249 offset:0
    v_mfma_f32_16x16x32_bf16 v[200:203], v[72:75], v[36:39], v[200:203]
    v_mfma_f32_16x16x32_bf16 v[204:207], v[76:79], v[36:39], v[204:207]
    ds_read_b128 v[36:39], v242 offset:13312
    v_mfma_f32_16x16x32_bf16 v[208:211], v[64:67], v[40:43], v[208:211]
    v_mfma_f32_16x16x32_bf16 v[212:215], v[68:71], v[40:43], v[212:215]
    ds_read_b64_tr_b16 v[58:59], v249 offset:1024
    v_mfma_f32_16x16x32_bf16 v[216:219], v[72:75], v[40:43], v[216:219]
    v_mfma_f32_16x16x32_bf16 v[220:223], v[76:79], v[40:43], v[220:223]
    ds_read_b128 v[40:43], v242 offset:16384
    v_mfma_f32_16x16x32_bf16 v[224:227], v[64:67], v[44:47], v[224:227]
    ds_read_b64_tr_b16 v[60:61], v250 offset:0
    v_mfma_f32_16x16x32_bf16 v[228:231], v[68:71], v[44:47], v[228:231]
    ds_read_b64_tr_b16 v[62:63], v250 offset:1024
    v_mfma_f32_16x16x32_bf16 v[232:235], v[72:75], v[44:47], v[232:235]
    v_mfma_f32_16x16x32_bf16 v[236:239], v[76:79], v[44:47], v[236:239]
    ds_read_b128 v[44:47], v242 offset:17408
    s_waitcnt lgkmcnt(12)
    v_mfma_f32_16x16x32_bf16 v[80:83], v[48:51], v[8:11], v[80:83]
    v_xor_b32 v242, 64, v241
    s_waitcnt lgkmcnt(8)
    v_mfma_f32_16x16x32_bf16 v[84:87], v[52:55], v[8:11], v[84:87]
    ds_read_b64_tr_b16 v[64:65], v247 offset:8192
    s_waitcnt lgkmcnt(5)
    v_mfma_f32_16x16x32_bf16 v[88:91], v[56:59], v[8:11], v[88:91]
    s_waitcnt lgkmcnt(2)
    v_mfma_f32_16x16x32_bf16 v[92:95], v[60:63], v[8:11], v[92:95]
    ds_read_b128 v[8:11], v242 offset:0
    v_mfma_f32_16x16x32_bf16 v[96:99], v[48:51], v[12:15], v[96:99]
    v_mfma_f32_16x16x32_bf16 v[100:103], v[52:55], v[12:15], v[100:103]
    ds_read_b64_tr_b16 v[66:67], v247 offset:9216
    v_mfma_f32_16x16x32_bf16 v[104:107], v[56:59], v[12:15], v[104:107]
    v_mfma_f32_16x16x32_bf16 v[108:111], v[60:63], v[12:15], v[108:111]
    ds_read_b128 v[12:15], v242 offset:1024
    v_mfma_f32_16x16x32_bf16 v[112:115], v[48:51], v[16:19], v[112:115]
    v_mfma_f32_16x16x32_bf16 v[116:119], v[52:55], v[16:19], v[116:119]
    ds_read_b64_tr_b16 v[68:69], v248 offset:8192
    v_mfma_f32_16x16x32_bf16 v[120:123], v[56:59], v[16:19], v[120:123]
    v_mfma_f32_16x16x32_bf16 v[124:127], v[60:63], v[16:19], v[124:127]
    ds_read_b128 v[16:19], v242 offset:4096
    v_mfma_f32_16x16x32_bf16 v[128:131], v[48:51], v[20:23], v[128:131]
    v_mfma_f32_16x16x32_bf16 v[132:135], v[52:55], v[20:23], v[132:135]
    ds_read_b64_tr_b16 v[70:71], v248 offset:9216
    v_mfma_f32_16x16x32_bf16 v[136:139], v[56:59], v[20:23], v[136:139]
    v_mfma_f32_16x16x32_bf16 v[140:143], v[60:63], v[20:23], v[140:143]
    ds_read_b128 v[20:23], v242 offset:5120
    v_mfma_f32_16x16x32_bf16 v[144:147], v[48:51], v[24:27], v[144:147]
    v_mfma_f32_16x16x32_bf16 v[148:151], v[52:55], v[24:27], v[148:151]
    ds_read_b64_tr_b16 v[72:73], v249 offset:8192
    v_mfma_f32_16x16x32_bf16 v[152:155], v[56:59], v[24:27], v[152:155]
    v_mfma_f32_16x16x32_bf16 v[156:159], v[60:63], v[24:27], v[156:159]
    ds_read_b128 v[24:27], v242 offset:8192
    v_mfma_f32_16x16x32_bf16 v[160:163], v[48:51], v[28:31], v[160:163]
    v_mfma_f32_16x16x32_bf16 v[164:167], v[52:55], v[28:31], v[164:167]
    ds_read_b64_tr_b16 v[74:75], v249 offset:9216
    v_mfma_f32_16x16x32_bf16 v[168:171], v[56:59], v[28:31], v[168:171]
    v_mfma_f32_16x16x32_bf16 v[172:175], v[60:63], v[28:31], v[172:175]
    ds_read_b128 v[28:31], v242 offset:9216
    v_mfma_f32_16x16x32_bf16 v[176:179], v[48:51], v[32:35], v[176:179]
    v_mfma_f32_16x16x32_bf16 v[180:183], v[52:55], v[32:35], v[180:183]
    ds_read_b64_tr_b16 v[76:77], v250 offset:8192
    v_mfma_f32_16x16x32_bf16 v[184:187], v[56:59], v[32:35], v[184:187]
    v_mfma_f32_16x16x32_bf16 v[188:191], v[60:63], v[32:35], v[188:191]
    ds_read_b128 v[32:35], v242 offset:12288
    v_mfma_f32_16x16x32_bf16 v[192:195], v[48:51], v[36:39], v[192:195]
    v_mfma_f32_16x16x32_bf16 v[196:199], v[52:55], v[36:39], v[196:199]
    ds_read_b64_tr_b16 v[78:79], v250 offset:9216
    v_mfma_f32_16x16x32_bf16 v[200:203], v[56:59], v[36:39], v[200:203]
    v_mfma_f32_16x16x32_bf16 v[204:207], v[60:63], v[36:39], v[204:207]
    ds_read_b128 v[36:39], v242 offset:13312
    v_mfma_f32_16x16x32_bf16 v[208:211], v[48:51], v[40:43], v[208:211]
    v_mfma_f32_16x16x32_bf16 v[212:215], v[52:55], v[40:43], v[212:215]
    v_mfma_f32_16x16x32_bf16 v[216:219], v[56:59], v[40:43], v[216:219]
    v_mfma_f32_16x16x32_bf16 v[220:223], v[60:63], v[40:43], v[220:223]
    ds_read_b128 v[40:43], v242 offset:16384
    s_waitcnt lgkmcnt(15)
    v_mfma_f32_16x16x32_bf16 v[224:227], v[48:51], v[44:47], v[224:227]
    v_mfma_f32_16x16x32_bf16 v[228:231], v[52:55], v[44:47], v[228:231]
    v_mfma_f32_16x16x32_bf16 v[232:235], v[56:59], v[44:47], v[232:235]
    v_mfma_f32_16x16x32_bf16 v[236:239], v[60:63], v[44:47], v[236:239]
    ds_read_b128 v[44:47], v242 offset:17408
    s_waitcnt lgkmcnt(15)
    v_mfma_f32_16x16x32_bf16 v[80:83], v[64:67], v[8:11], v[80:83]
    s_add_u32 s36, s36, 53248
    s_cmp_eq_u32 s36, 159744
    s_waitcnt lgkmcnt(11)
    v_mfma_f32_16x16x32_bf16 v[84:87], v[68:71], v[8:11], v[84:87]
    s_cselect_b32 s36, 0, s36
    s_add_u32 s37, s37, 1
    s_waitcnt lgkmcnt(7)
    v_mfma_f32_16x16x32_bf16 v[88:91], v[72:75], v[8:11], v[88:91]
    v_add_u32 v241, s36, v240
    v_add_u32 v242, s36, v240
    s_waitcnt lgkmcnt(3)
    v_mfma_f32_16x16x32_bf16 v[92:95], v[76:79], v[8:11], v[92:95]
    v_add_u32 v247, s36, v243
    v_add_u32 v248, s36, v244
    v_mfma_f32_16x16x32_bf16 v[96:99], v[64:67], v[12:15], v[96:99]
    v_add_u32 v249, s36, v245
    v_add_u32 v250, s36, v246
    v_mfma_f32_16x16x32_bf16 v[100:103], v[68:71], v[12:15], v[100:103]
    s_cmp_eq_u32 s37, 10
    v_mfma_f32_16x16x32_bf16 v[104:107], v[72:75], v[12:15], v[104:107]
    v_mfma_f32_16x16x32_bf16 v[108:111], v[76:79], v[12:15], v[108:111]
    s_waitcnt lgkmcnt(0)
    s_barrier
    ds_read_b128 v[8:11], v242 offset:0
    v_mfma_f32_16x16x32_bf16 v[112:115], v[64:67], v[16:19], v[112:115]
    v_mfma_f32_16x16x32_bf16 v[116:119], v[68:71], v[16:19], v[116:119]
    ds_read_b128 v[12:15], v242 offset:1024
    v_mfma_f32_16x16x32_bf16 v[120:123], v[72:75], v[16:19], v[120:123]
    v_mfma_f32_16x16x32_bf16 v[124:127], v[76:79], v[16:19], v[124:127]
    ds_read_b128 v[16:19], v242 offset:4096
    v_mfma_f32_16x16x32_bf16 v[128:131], v[64:67], v[20:23], v[128:131]
    v_mfma_f32_16x16x32_bf16 v[132:135], v[68:71], v[20:23], v[132:135]
    ds_read_b64_tr_b16 v[48:49], v247 offset:0
    v_mfma_f32_16x16x32_bf16 v[136:139], v[72:75], v[20:23], v[136:139]
    v_mfma_f32_16x16x32_bf16 v[140:143], v[76:79], v[20:23], v[140:143]
    ds_read_b128 v[20:23], v242 offset:5120
    v_mfma_f32_16x16x32_bf16 v[144:147], v[64:67], v[24:27], v[144:147]
    v_mfma_f32_16x16x32_bf16 v[148:151], v[68:71], v[24:27], v[148:151]
    ds_read_b64_tr_b16 v[50:51], v247 offset:1024
    v_mfma_f32_16x16x32_bf16 v[152:155], v[72:75], v[24:27], v[152:155]
    v_mfma_f32_16x16x32_bf16 v[156:159], v[76:79], v[24:27], v[156:159]
    ds_read_b128 v[24:27], v242 offset:8192
    v_mfma_f32_16x16x32_bf16 v[160:163], v[64:67], v[28:31], v[160:163]
    v_mfma_f32_16x16x32_bf16 v[164:167], v[68:71], v[28:31], v[164:167]
    ds_read_b64_tr_b16 v[52:53], v248 offset:0
    v_mfma_f32_16x16x32_bf16 v[168:171], v[72:75], v[28:31], v[168:171]
    v_mfma_f32_16x16x32_bf16 v[172:175], v[76:79], v[28:31], v[172:175]
    ds_read_b128 v[28:31], v242 offset:9216
    v_mfma_f32_16x16x32_bf16 v[176:179], v[64:67], v[32:35], v[176:179]
    v_mfma_f32_16x16x32_bf16 v[180:183], v[68:71], v[32:35], v[180:183]
    ds_read_b64_tr_b16 v[54:55], v248 offset:1024
    v_mfma_f32_16x16x32_bf16 v[184:187], v[72:75], v[32:35], v[184:187]
    v_mfma_f32_16x16x32_bf16 v[188:191], v[76:79], v[32:35], v[188:191]
    ds_read_b128 v[32:35], v242 offset:12288
    v_mfma_f32_16x16x32_bf16 v[192:195], v[64:67], v[36:39], v[192:195]
    v_mfma_f32_16x16x32_bf16 v[196:199], v[68:71], v[36:39], v[196:199]
    ds_read_b64_tr_b16 v[56:57], v249 offset:0
    v_mfma_f32_16x16x32_bf16 v[200:203], v[72:75], v[36:39], v[200:203]
    v_mfma_f32_16x16x32_bf16 v[204:207], v[76:79], v[36:39], v[204:207]
    ds_read_b128 v[36:39], v242 offset:13312
    v_mfma_f32_16x16x32_bf16 v[208:211], v[64:67], v[40:43], v[208:211]
    v_mfma_f32_16x16x32_bf16 v[212:215], v[68:71], v[40:43], v[212:215]
    ds_read_b64_tr_b16 v[58:59], v249 offset:1024
    v_mfma_f32_16x16x32_bf16 v[216:219], v[72:75], v[40:43], v[216:219]
    v_mfma_f32_16x16x32_bf16 v[220:223], v[76:79], v[40:43], v[220:223]
    ds_read_b128 v[40:43], v242 offset:16384
    v_mfma_f32_16x16x32_bf16 v[224:227], v[64:67], v[44:47], v[224:227]
    ds_read_b64_tr_b16 v[60:61], v250 offset:0
    v_mfma_f32_16x16x32_bf16 v[228:231], v[68:71], v[44:47], v[228:231]
    ds_read_b64_tr_b16 v[62:63], v250 offset:1024
    v_mfma_f32_16x16x32_bf16 v[232:235], v[72:75], v[44:47], v[232:235]
    v_mfma_f32_16x16x32_bf16 v[236:239], v[76:79], v[44:47], v[236:239]
    ds_read_b128 v[44:47], v242 offset:17408
    s_waitcnt lgkmcnt(12)
    v_mfma_f32_16x16x32_bf16 v[80:83], v[48:51], v[8:11], v[80:83]
    v_xor_b32 v242, 64, v241
    s_waitcnt lgkmcnt(8)
    v_mfma_f32_16x16x32_bf16 v[84:87], v[52:55], v[8:11], v[84:87]
    ds_read_b64_tr_b16 v[64:65], v247 offset:8192
    s_waitcnt lgkmcnt(5)
    v_mfma_f32_16x16x32_bf16 v[88:91], v[56:59], v[8:11], v[88:91]
    s_waitcnt lgkmcnt(2)
    v_mfma_f32_16x16x32_bf16 v[92:95], v[60:63], v[8:11], v[92:95]
    ds_read_b128 v[8:11], v242 offset:0
    v_mfma_f32_16x16x32_bf16 v[96:99], v[48:51], v[12:15], v[96:99]
    v_mfma_f32_16x16x32_bf16 v[100:103], v[52:55], v[12:15], v[100:103]
    ds_read_b64_tr_b16 v[66:67], v247 offset:9216
    v_mfma_f32_16x16x32_bf16 v[104:107], v[56:59], v[12:15], v[104:107]
    v_mfma_f32_16x16x32_bf16 v[108:111], v[60:63], v[12:15], v[108:111]
    ds_read_b128 v[12:15], v242 offset:1024
    v_mfma_f32_16x16x32_bf16 v[112:115], v[48:51], v[16:19], v[112:115]
    v_mfma_f32_16x16x32_bf16 v[116:119], v[52:55], v[16:19], v[116:119]
    ds_read_b64_tr_b16 v[68:69], v248 offset:8192
    v_mfma_f32_16x16x32_bf16 v[120:123], v[56:59], v[16:19], v[120:123]
    v_mfma_f32_16x16x32_bf16 v[124:127], v[60:63], v[16:19], v[124:127]
    ds_read_b128 v[16:19], v242 offset:4096
    v_mfma_f32_16x16x32_bf16 v[128:131], v[48:51], v[20:23], v[128:131]
    v_mfma_f32_16x16x32_bf16 v[132:135], v[52:55], v[20:23], v[132:135]
    ds_read_b64_tr_b16 v[70:71], v248 offset:9216
    v_mfma_f32_16x16x32_bf16 v[136:139], v[56:59], v[20:23], v[136:139]
    v_mfma_f32_16x16x32_bf16 v[140:143], v[60:63], v[20:23], v[140:143]
    ds_read_b128 v[20:23], v242 offset:5120
    v_mfma_f32_16x16x32_bf16 v[144:147], v[48:51], v[24:27], v[144:147]
    v_mfma_f32_16x16x32_bf16 v[148:151], v[52:55], v[24:27], v[148:151]
    ds_read_b64_tr_b16 v[72:73], v249 offset:8192
    v_mfma_f32_16x16x32_bf16 v[152:155], v[56:59], v[24:27], v[152:155]
    v_mfma_f32_16x16x32_bf16 v[156:159], v[60:63], v[24:27], v[156:159]
    ds_read_b128 v[24:27], v242 offset:8192
    v_mfma_f32_16x16x32_bf16 v[160:163], v[48:51], v[28:31], v[160:163]
    v_mfma_f32_16x16x32_bf16 v[164:167], v[52:55], v[28:31], v[164:167]
    ds_read_b64_tr_b16 v[74:75], v249 offset:9216
    v_mfma_f32_16x16x32_bf16 v[168:171], v[56:59], v[28:31], v[168:171]
    v_mfma_f32_16x16x32_bf16 v[172:175], v[60:63], v[28:31], v[172:175]
    ds_read_b128 v[28:31], v242 offset:9216
    v_mfma_f32_16x16x32_bf16 v[176:179], v[48:51], v[32:35], v[176:179]
    v_mfma_f32_16x16x32_bf16 v[180:183], v[52:55], v[32:35], v[180:183]
    ds_read_b64_tr_b16 v[76:77], v250 offset:8192
    v_mfma_f32_16x16x32_bf16 v[184:187], v[56:59], v[32:35], v[184:187]
    v_mfma_f32_16x16x32_bf16 v[188:191], v[60:63], v[32:35], v[188:191]
    ds_read_b128 v[32:35], v242 offset:12288
    v_mfma_f32_16x16x32_bf16 v[192:195], v[48:51], v[36:39], v[192:195]
    v_mfma_f32_16x16x32_bf16 v[196:199], v[52:55], v[36:39], v[196:199]
    ds_read_b64_tr_b16 v[78:79], v250 offset:9216
    v_mfma_f32_16x16x32_bf16 v[200:203], v[56:59], v[36:39], v[200:203]
    v_mfma_f32_16x16x32_bf16 v[204:207], v[60:63], v[36:39], v[204:207]
    ds_read_b128 v[36:39], v242 offset:13312
    v_mfma_f32_16x16x32_bf16 v[208:211], v[48:51], v[40:43], v[208:211]
    v_mfma_f32_16x16x32_bf16 v[212:215], v[52:55], v[40:43], v[212:215]
    v_mfma_f32_16x16x32_bf16 v[216:219], v[56:59], v[40:43], v[216:219]
    v_mfma_f32_16x16x32_bf16 v[220:223], v[60:63], v[40:43], v[220:223]
    ds_read_b128 v[40:43], v242 offset:16384
    s_waitcnt lgkmcnt(15)
    v_mfma_f32_16x16x32_bf16 v[224:227], v[48:51], v[44:47], v[224:227]
    v_mfma_f32_16x16x32_bf16 v[228:231], v[52:55], v[44:47], v[228:231]
    v_mfma_f32_16x16x32_bf16 v[232:235], v[56:59], v[44:47], v[232:235]
    v_mfma_f32_16x16x32_bf16 v[236:239], v[60:63], v[44:47], v[236:239]
    ds_read_b128 v[44:47], v242 offset:17408
    s_waitcnt lgkmcnt(15)
    v_mfma_f32_16x16x32_bf16 v[80:83], v[64:67], v[8:11], v[80:83]
    s_add_u32 s36, s36, 53248
    s_cmp_eq_u32 s36, 159744
    s_waitcnt lgkmcnt(11)
    v_mfma_f32_16x16x32_bf16 v[84:87], v[68:71], v[8:11], v[84:87]
    s_cselect_b32 s36, 0, s36
    s_add_u32 s37, s37, 1
    s_waitcnt lgkmcnt(7)
    v_mfma_f32_16x16x32_bf16 v[88:91], v[72:75], v[8:11], v[88:91]
    v_add_u32 v241, s36, v240
    v_add_u32 v242, s36, v240
    s_waitcnt lgkmcnt(3)
    v_mfma_f32_16x16x32_bf16 v[92:95], v[76:79], v[8:11], v[92:95]
    v_add_u32 v247, s36, v243
    v_add_u32 v248, s36, v244
    v_mfma_f32_16x16x32_bf16 v[96:99], v[64:67], v[12:15], v[96:99]
    v_add_u32 v249, s36, v245
    v_add_u32 v250, s36, v246
    v_mfma_f32_16x16x32_bf16 v[100:103], v[68:71], v[12:15], v[100:103]
    s_cmp_eq_u32 s37, 10
    v_mfma_f32_16x16x32_bf16 v[104:107], v[72:75], v[12:15], v[104:107]
    v_mfma_f32_16x16x32_bf16 v[108:111], v[76:79], v[12:15], v[108:111]
    s_waitcnt lgkmcnt(0)
    s_cbranch_scc1 Lk1nb_2
    s_barrier
Lk1nb_2:
    ds_read_b128 v[8:11], v242 offset:0
    v_mfma_f32_16x16x32_bf16 v[112:115], v[64:67], v[16:19], v[112:115]
    v_mfma_f32_16x16x32_bf16 v[116:119], v[68:71], v[16:19], v[116:119]
    ds_read_b128 v[12:15], v242 offset:1024
    v_mfma_f32_16x16x32_bf16 v[120:123], v[72:75], v[16:19], v[120:123]
    v_mfma_f32_16x16x32_bf16 v[124:127], v[76:79], v[16:19], v[124:127]
    ds_read_b128 v[16:19], v242 offset:4096
    v_mfma_f32_16x16x32_bf16 v[128:131], v[64:67], v[20:23], v[128:131]
    v_mfma_f32_16x16x32_bf16 v[132:135], v[68:71], v[20:23], v[132:135]
    ds_read_b64_tr_b16 v[48:49], v247 offset:0
    v_mfma_f32_16x16x32_bf16 v[136:139], v[72:75], v[20:23], v[136:139]
    v_mfma_f32_16x16x32_bf16 v[140:143], v[76:79], v[20:23], v[140:143]
    ds_read_b128 v[20:23], v242 offset:5120
    v_mfma_f32_16x16x32_bf16 v[144:147], v[64:67], v[24:27], v[144:147]
    v_mfma_f32_16x16x32_bf16 v[148:151], v[68:71], v[24:27], v[148:151]
    ds_read_b64_tr_b16 v[50:51], v247 offset:1024
    v_mfma_f32_16x16x32_bf16 v[152:155], v[72:75], v[24:27], v[152:155]
    v_mfma_f32_16x16x32_bf16 v[156:159], v[76:79], v[24:27], v[156:159]
    ds_read_b128 v[24:27], v242 offset:8192
    v_mfma_f32_16x16x32_bf16 v[160:163], v[64:67], v[28:31], v[160:163]
    v_mfma_f32_16x16x32_bf16 v[164:167], v[68:71], v[28:31], v[164:167]
    ds_read_b64_tr_b16 v[52:53], v248 offset:0
    v_mfma_f32_16x16x32_bf16 v[168:171], v[72:75], v[28:31], v[168:171]
    v_mfma_f32_16x16x32_bf16 v[172:175], v[76:79], v[28:31], v[172:175]
    ds_read_b128 v[28:31], v242 offset:9216
    v_mfma_f32_16x16x32_bf16 v[176:179], v[64:67], v[32:35], v[176:179]
    v_mfma_f32_16x16x32_bf16 v[180:183], v[68:71], v[32:35], v[180:183]
    ds_read_b64_tr_b16 v[54:55], v248 offset:1024
    v_mfma_f32_16x16x32_bf16 v[184:187], v[72:75], v[32:35], v[184:187]
    v_mfma_f32_16x16x32_bf16 v[188:191], v[76:79], v[32:35], v[188:191]
    ds_read_b128 v[32:35], v242 offset:12288
    v_mfma_f32_16x16x32_bf16 v[192:195], v[64:67], v[36:39], v[192:195]
    v_mfma_f32_16x16x32_bf16 v[196:199], v[68:71], v[36:39], v[196:199]
    ds_read_b64_tr_b16 v[56:57], v249 offset:0
    v_mfma_f32_16x16x32_bf16 v[200:203], v[72:75], v[36:39], v[200:203]
    v_mfma_f32_16x16x32_bf16 v[204:207], v[76:79], v[36:39], v[204:207]
    ds_read_b128 v[36:39], v242 offset:13312
    v_mfma_f32_16x16x32_bf16 v[208:211], v[64:67], v[40:43], v[208:211]
    v_mfma_f32_16x16x32_bf16 v[212:215], v[68:71], v[40:43], v[212:215]
    ds_read_b64_tr_b16 v[58:59], v249 offset:1024
    v_mfma_f32_16x16x32_bf16 v[216:219], v[72:75], v[40:43], v[216:219]
    v_mfma_f32_16x16x32_bf16 v[220:223], v[76:79], v[40:43], v[220:223]
    ds_read_b128 v[40:43], v242 offset:16384
    v_mfma_f32_16x16x32_bf16 v[224:227], v[64:67], v[44:47], v[224:227]
    ds_read_b64_tr_b16 v[60:61], v250 offset:0
    v_mfma_f32_16x16x32_bf16 v[228:231], v[68:71], v[44:47], v[228:231]
    ds_read_b64_tr_b16 v[62:63], v250 offset:1024
    v_mfma_f32_16x16x32_bf16 v[232:235], v[72:75], v[44:47], v[232:235]
    v_mfma_f32_16x16x32_bf16 v[236:239], v[76:79], v[44:47], v[236:239]
    ds_read_b128 v[44:47], v242 offset:17408
    s_cmp_lg_u32 s37, 10
    s_cbranch_scc1 Lk1loop_1
    s_waitcnt lgkmcnt(0)
    s_nop 7
    s_cmp_lt_u32 s19, 12
    s_cbranch_scc1 gated_mix__softmax_full_mha__glu_gated_geglu__prompt_kernel_gu_epi
    v_mov_b32 v8, s52
    v_mov_b32 v9, s52
    v_mov_b32 v10, s53
    v_mov_b32 v11, s53
    s_mul_i32 s49, s46, 2560
    v_pk_mul_f32 v[80:81], v[80:81], v[8:9]
    v_pk_mul_f32 v[82:83], v[82:83], v[8:9]
    v_pk_mul_f32 v[96:97], v[96:97], v[8:9]
    v_pk_mul_f32 v[98:99], v[98:99], v[8:9]
    v_cvt_pk_bf16_f32 v80, v80, v81
    v_cvt_pk_bf16_f32 v81, v82, v83
    v_cvt_pk_bf16_f32 v82, v96, v97
    v_cvt_pk_bf16_f32 v83, v98, v99
    buffer_store_dwordx4 v[80:83], v251, s[20:23], s49 offen sc1
    v_pk_mul_f32 v[84:85], v[84:85], v[8:9]
    v_pk_mul_f32 v[86:87], v[86:87], v[8:9]
    v_pk_mul_f32 v[100:101], v[100:101], v[8:9]
    v_pk_mul_f32 v[102:103], v[102:103], v[8:9]
    v_cvt_pk_bf16_f32 v84, v84, v85
    v_cvt_pk_bf16_f32 v85, v86, v87
    v_cvt_pk_bf16_f32 v86, v100, v101
    v_cvt_pk_bf16_f32 v87, v102, v103
    buffer_store_dwordx4 v[84:87], v252, s[20:23], s49 offen sc1
    v_pk_mul_f32 v[88:89], v[88:89], v[10:11]
    v_pk_mul_f32 v[90:91], v[90:91], v[10:11]
    v_pk_mul_f32 v[104:105], v[104:105], v[10:11]
    v_pk_mul_f32 v[106:107], v[106:107], v[10:11]
    v_cvt_pk_bf16_f32 v88, v88, v89
    v_cvt_pk_bf16_f32 v89, v90, v91
    v_cvt_pk_bf16_f32 v90, v104, v105
    v_cvt_pk_bf16_f32 v91, v106, v107
    buffer_store_dwordx4 v[88:91], v253, s[20:23], s49 offen sc1
    v_pk_mul_f32 v[92:93], v[92:93], v[10:11]
    v_pk_mul_f32 v[94:95], v[94:95], v[10:11]
    v_pk_mul_f32 v[108:109], v[108:109], v[10:11]
    v_pk_mul_f32 v[110:111], v[110:111], v[10:11]
    v_cvt_pk_bf16_f32 v92, v92, v93
    v_cvt_pk_bf16_f32 v93, v94, v95
    v_cvt_pk_bf16_f32 v94, v108, v109
    v_cvt_pk_bf16_f32 v95, v110, v111
    buffer_store_dwordx4 v[92:95], v254, s[20:23], s49 offen sc1
    s_add_u32 s49, s49, 2560
    v_pk_mul_f32 v[112:113], v[112:113], v[8:9]
    v_pk_mul_f32 v[114:115], v[114:115], v[8:9]
    v_pk_mul_f32 v[128:129], v[128:129], v[8:9]
    v_pk_mul_f32 v[130:131], v[130:131], v[8:9]
    v_cvt_pk_bf16_f32 v112, v112, v113
    v_cvt_pk_bf16_f32 v113, v114, v115
    v_cvt_pk_bf16_f32 v114, v128, v129
    v_cvt_pk_bf16_f32 v115, v130, v131
    buffer_store_dwordx4 v[112:115], v251, s[20:23], s49 offen sc1
    v_pk_mul_f32 v[116:117], v[116:117], v[8:9]
    v_pk_mul_f32 v[118:119], v[118:119], v[8:9]
    v_pk_mul_f32 v[132:133], v[132:133], v[8:9]
    v_pk_mul_f32 v[134:135], v[134:135], v[8:9]
    v_cvt_pk_bf16_f32 v116, v116, v117
    v_cvt_pk_bf16_f32 v117, v118, v119
    v_cvt_pk_bf16_f32 v118, v132, v133
    v_cvt_pk_bf16_f32 v119, v134, v135
    buffer_store_dwordx4 v[116:119], v252, s[20:23], s49 offen sc1
    v_pk_mul_f32 v[120:121], v[120:121], v[10:11]
    v_pk_mul_f32 v[122:123], v[122:123], v[10:11]
    v_pk_mul_f32 v[136:137], v[136:137], v[10:11]
    v_pk_mul_f32 v[138:139], v[138:139], v[10:11]
    v_cvt_pk_bf16_f32 v120, v120, v121
    v_cvt_pk_bf16_f32 v121, v122, v123
    v_cvt_pk_bf16_f32 v122, v136, v137
    v_cvt_pk_bf16_f32 v123, v138, v139
    buffer_store_dwordx4 v[120:123], v253, s[20:23], s49 offen sc1
    v_pk_mul_f32 v[124:125], v[124:125], v[10:11]
    v_pk_mul_f32 v[126:127], v[126:127], v[10:11]
    v_pk_mul_f32 v[140:141], v[140:141], v[10:11]
    v_pk_mul_f32 v[142:143], v[142:143], v[10:11]
    v_cvt_pk_bf16_f32 v124, v124, v125
    v_cvt_pk_bf16_f32 v125, v126, v127
    v_cvt_pk_bf16_f32 v126, v140, v141
    v_cvt_pk_bf16_f32 v127, v142, v143
    buffer_store_dwordx4 v[124:127], v254, s[20:23], s49 offen sc1
    s_add_u32 s49, s49, 2560
    v_pk_mul_f32 v[144:145], v[144:145], v[8:9]
    v_pk_mul_f32 v[146:147], v[146:147], v[8:9]
    v_pk_mul_f32 v[160:161], v[160:161], v[8:9]
    v_pk_mul_f32 v[162:163], v[162:163], v[8:9]
    v_cvt_pk_bf16_f32 v144, v144, v145
    v_cvt_pk_bf16_f32 v145, v146, v147
    v_cvt_pk_bf16_f32 v146, v160, v161
    v_cvt_pk_bf16_f32 v147, v162, v163
    buffer_store_dwordx4 v[144:147], v251, s[20:23], s49 offen sc1
    v_pk_mul_f32 v[148:149], v[148:149], v[8:9]
    v_pk_mul_f32 v[150:151], v[150:151], v[8:9]
    v_pk_mul_f32 v[164:165], v[164:165], v[8:9]
    v_pk_mul_f32 v[166:167], v[166:167], v[8:9]
    v_cvt_pk_bf16_f32 v148, v148, v149
    v_cvt_pk_bf16_f32 v149, v150, v151
    v_cvt_pk_bf16_f32 v150, v164, v165
    v_cvt_pk_bf16_f32 v151, v166, v167
    buffer_store_dwordx4 v[148:151], v252, s[20:23], s49 offen sc1
    v_pk_mul_f32 v[152:153], v[152:153], v[10:11]
    v_pk_mul_f32 v[154:155], v[154:155], v[10:11]
    v_pk_mul_f32 v[168:169], v[168:169], v[10:11]
    v_pk_mul_f32 v[170:171], v[170:171], v[10:11]
    v_cvt_pk_bf16_f32 v152, v152, v153
    v_cvt_pk_bf16_f32 v153, v154, v155
    v_cvt_pk_bf16_f32 v154, v168, v169
    v_cvt_pk_bf16_f32 v155, v170, v171
    buffer_store_dwordx4 v[152:155], v253, s[20:23], s49 offen sc1
    v_pk_mul_f32 v[156:157], v[156:157], v[10:11]
    v_pk_mul_f32 v[158:159], v[158:159], v[10:11]
    v_pk_mul_f32 v[172:173], v[172:173], v[10:11]
    v_pk_mul_f32 v[174:175], v[174:175], v[10:11]
    v_cvt_pk_bf16_f32 v156, v156, v157
    v_cvt_pk_bf16_f32 v157, v158, v159
    v_cvt_pk_bf16_f32 v158, v172, v173
    v_cvt_pk_bf16_f32 v159, v174, v175
    buffer_store_dwordx4 v[156:159], v254, s[20:23], s49 offen sc1
    s_add_u32 s49, s49, 2560
    v_pk_mul_f32 v[176:177], v[176:177], v[8:9]
    v_pk_mul_f32 v[178:179], v[178:179], v[8:9]
    v_pk_mul_f32 v[192:193], v[192:193], v[8:9]
    v_pk_mul_f32 v[194:195], v[194:195], v[8:9]
    v_cvt_pk_bf16_f32 v176, v176, v177
    v_cvt_pk_bf16_f32 v177, v178, v179
    v_cvt_pk_bf16_f32 v178, v192, v193
    v_cvt_pk_bf16_f32 v179, v194, v195
    buffer_store_dwordx4 v[176:179], v251, s[20:23], s49 offen sc1
    v_pk_mul_f32 v[180:181], v[180:181], v[8:9]
    v_pk_mul_f32 v[182:183], v[182:183], v[8:9]
    v_pk_mul_f32 v[196:197], v[196:197], v[8:9]
    v_pk_mul_f32 v[198:199], v[198:199], v[8:9]
    v_cvt_pk_bf16_f32 v180, v180, v181
    v_cvt_pk_bf16_f32 v181, v182, v183
    v_cvt_pk_bf16_f32 v182, v196, v197
    v_cvt_pk_bf16_f32 v183, v198, v199
    buffer_store_dwordx4 v[180:183], v252, s[20:23], s49 offen sc1
    v_pk_mul_f32 v[184:185], v[184:185], v[10:11]
    v_pk_mul_f32 v[186:187], v[186:187], v[10:11]
    v_pk_mul_f32 v[200:201], v[200:201], v[10:11]
    v_pk_mul_f32 v[202:203], v[202:203], v[10:11]
    v_cvt_pk_bf16_f32 v184, v184, v185
    v_cvt_pk_bf16_f32 v185, v186, v187
    v_cvt_pk_bf16_f32 v186, v200, v201
    v_cvt_pk_bf16_f32 v187, v202, v203
    buffer_store_dwordx4 v[184:187], v253, s[20:23], s49 offen sc1
    v_pk_mul_f32 v[188:189], v[188:189], v[10:11]
    v_pk_mul_f32 v[190:191], v[190:191], v[10:11]
    v_pk_mul_f32 v[204:205], v[204:205], v[10:11]
    v_pk_mul_f32 v[206:207], v[206:207], v[10:11]
    v_cvt_pk_bf16_f32 v188, v188, v189
    v_cvt_pk_bf16_f32 v189, v190, v191
    v_cvt_pk_bf16_f32 v190, v204, v205
    v_cvt_pk_bf16_f32 v191, v206, v207
    buffer_store_dwordx4 v[188:191], v254, s[20:23], s49 offen sc1
    s_add_u32 s49, s49, 2560
    s_cmp_eq_u32 s47, 4
    s_cbranch_scc1 gated_mix__softmax_full_mha__glu_gated_geglu__prompt_kernel_qk_done
    v_pk_mul_f32 v[208:209], v[208:209], v[8:9]
    v_pk_mul_f32 v[210:211], v[210:211], v[8:9]
    v_pk_mul_f32 v[224:225], v[224:225], v[8:9]
    v_pk_mul_f32 v[226:227], v[226:227], v[8:9]
    v_cvt_pk_bf16_f32 v208, v208, v209
    v_cvt_pk_bf16_f32 v209, v210, v211
    v_cvt_pk_bf16_f32 v210, v224, v225
    v_cvt_pk_bf16_f32 v211, v226, v227
    buffer_store_dwordx4 v[208:211], v251, s[20:23], s49 offen sc1
    v_pk_mul_f32 v[212:213], v[212:213], v[8:9]
    v_pk_mul_f32 v[214:215], v[214:215], v[8:9]
    v_pk_mul_f32 v[228:229], v[228:229], v[8:9]
    v_pk_mul_f32 v[230:231], v[230:231], v[8:9]
    v_cvt_pk_bf16_f32 v212, v212, v213
    v_cvt_pk_bf16_f32 v213, v214, v215
    v_cvt_pk_bf16_f32 v214, v228, v229
    v_cvt_pk_bf16_f32 v215, v230, v231
    buffer_store_dwordx4 v[212:215], v252, s[20:23], s49 offen sc1
    v_pk_mul_f32 v[216:217], v[216:217], v[10:11]
    v_pk_mul_f32 v[218:219], v[218:219], v[10:11]
    v_pk_mul_f32 v[232:233], v[232:233], v[10:11]
    v_pk_mul_f32 v[234:235], v[234:235], v[10:11]
    v_cvt_pk_bf16_f32 v216, v216, v217
    v_cvt_pk_bf16_f32 v217, v218, v219
    v_cvt_pk_bf16_f32 v218, v232, v233
    v_cvt_pk_bf16_f32 v219, v234, v235
    buffer_store_dwordx4 v[216:219], v253, s[20:23], s49 offen sc1
    v_pk_mul_f32 v[220:221], v[220:221], v[10:11]
    v_pk_mul_f32 v[222:223], v[222:223], v[10:11]
    v_pk_mul_f32 v[236:237], v[236:237], v[10:11]
    v_pk_mul_f32 v[238:239], v[238:239], v[10:11]
    v_cvt_pk_bf16_f32 v220, v220, v221
    v_cvt_pk_bf16_f32 v221, v222, v223
    v_cvt_pk_bf16_f32 v222, v236, v237
    v_cvt_pk_bf16_f32 v223, v238, v239
    buffer_store_dwordx4 v[220:223], v254, s[20:23], s49 offen sc1
gated_mix__softmax_full_mha__glu_gated_geglu__prompt_kernel_qk_done:
    s_branch gated_mix__softmax_full_mha__glu_gated_geglu__prompt_kernel_join
gated_mix__softmax_full_mha__glu_gated_geglu__prompt_kernel_gu_epi:
    v_mov_b32 v8, 0xbdd2d3e8
    v_mov_b32 v9, 0xbdd2d3e8
    v_mov_b32 v10, 0xc0135761
    v_mov_b32 v11, 0xc0135761
    v_mov_b32 v12, 1.0
    v_mov_b32 v13, 1.0
    v_lshrrev_b32 v14, 3, v1
    v_mul_u32_u24 v14, 69504, v14
    v_lshl_add_u32 v14, v1, 4, v14
    v_lshl_add_u32 v14, v2, 8, v14
    s_lshl_b32 s48, s19, 1
    s_add_u32 s48, s48, s3
    s_cmp_ge_u32 s3, 2
    s_cselect_b32 s50, 22, 0
    s_add_u32 s48, s48, s50
    s_lshl_b32 s48, s48, 10
    s_mul_i32 s49, s46, 139264
    s_add_u32 s49, s49, s48
    s_add_u32 s49, s49, 10506240
    v_pk_mul_f32 v[16:17], v[80:81], v[80:81]
    v_pk_mul_f32 v[18:19], v[82:83], v[82:83]
    v_pk_mul_f32 v[20:21], v[84:85], v[84:85]
    v_pk_mul_f32 v[22:23], v[86:87], v[86:87]
    v_pk_fma_f32 v[16:17], v[16:17], v[8:9], v[10:11]
    v_pk_fma_f32 v[18:19], v[18:19], v[8:9], v[10:11]
    v_pk_fma_f32 v[20:21], v[20:21], v[8:9], v[10:11]
    v_pk_fma_f32 v[22:23], v[22:23], v[8:9], v[10:11]
    v_pk_mul_f32 v[16:17], v[16:17], v[80:81]
    v_pk_mul_f32 v[18:19], v[18:19], v[82:83]
    v_pk_mul_f32 v[20:21], v[20:21], v[84:85]
    v_pk_mul_f32 v[22:23], v[22:23], v[86:87]
    v_exp_f32 v16, v16
    v_exp_f32 v17, v17
    v_exp_f32 v18, v18
    v_exp_f32 v19, v19
    v_exp_f32 v20, v20
    v_exp_f32 v21, v21
    v_exp_f32 v22, v22
    v_exp_f32 v23, v23
    v_pk_mul_f32 v[24:25], v[80:81], v[88:89]
    v_pk_mul_f32 v[26:27], v[82:83], v[90:91]
    v_pk_mul_f32 v[28:29], v[84:85], v[92:93]
    v_pk_mul_f32 v[30:31], v[86:87], v[94:95]
    v_pk_add_f32 v[16:17], v[16:17], v[12:13]
    v_pk_add_f32 v[18:19], v[18:19], v[12:13]
    v_pk_add_f32 v[20:21], v[20:21], v[12:13]
    v_pk_add_f32 v[22:23], v[22:23], v[12:13]
    v_rcp_f32 v16, v16
    v_rcp_f32 v17, v17
    v_rcp_f32 v18, v18
    v_rcp_f32 v19, v19
    v_rcp_f32 v20, v20
    v_rcp_f32 v21, v21
    v_rcp_f32 v22, v22
    v_rcp_f32 v23, v23
    s_nop 0
    v_pk_mul_f32 v[24:25], v[24:25], v[16:17]
    v_pk_mul_f32 v[26:27], v[26:27], v[18:19]
    v_pk_mul_f32 v[28:29], v[28:29], v[20:21]
    v_pk_mul_f32 v[30:31], v[30:31], v[22:23]
    v_cvt_pk_bf16_f32 v32, v24, v25
    v_cvt_pk_bf16_f32 v33, v26, v27
    v_cvt_pk_bf16_f32 v34, v28, v29
    v_cvt_pk_bf16_f32 v35, v30, v31
    buffer_store_dwordx4 v[32:35], v14, s[20:23], s49 offen offset:0 sc1
    v_pk_mul_f32 v[16:17], v[96:97], v[96:97]
    v_pk_mul_f32 v[18:19], v[98:99], v[98:99]
    v_pk_mul_f32 v[20:21], v[100:101], v[100:101]
    v_pk_mul_f32 v[22:23], v[102:103], v[102:103]
    v_pk_fma_f32 v[16:17], v[16:17], v[8:9], v[10:11]
    v_pk_fma_f32 v[18:19], v[18:19], v[8:9], v[10:11]
    v_pk_fma_f32 v[20:21], v[20:21], v[8:9], v[10:11]
    v_pk_fma_f32 v[22:23], v[22:23], v[8:9], v[10:11]
    v_pk_mul_f32 v[16:17], v[16:17], v[96:97]
    v_pk_mul_f32 v[18:19], v[18:19], v[98:99]
    v_pk_mul_f32 v[20:21], v[20:21], v[100:101]
    v_pk_mul_f32 v[22:23], v[22:23], v[102:103]
    v_exp_f32 v16, v16
    v_exp_f32 v17, v17
    v_exp_f32 v18, v18
    v_exp_f32 v19, v19
    v_exp_f32 v20, v20
    v_exp_f32 v21, v21
    v_exp_f32 v22, v22
    v_exp_f32 v23, v23
    v_pk_mul_f32 v[24:25], v[96:97], v[104:105]
    v_pk_mul_f32 v[26:27], v[98:99], v[106:107]
    v_pk_mul_f32 v[28:29], v[100:101], v[108:109]
    v_pk_mul_f32 v[30:31], v[102:103], v[110:111]
    v_pk_add_f32 v[16:17], v[16:17], v[12:13]
    v_pk_add_f32 v[18:19], v[18:19], v[12:13]
    v_pk_add_f32 v[20:21], v[20:21], v[12:13]
    v_pk_add_f32 v[22:23], v[22:23], v[12:13]
    v_rcp_f32 v16, v16
    v_rcp_f32 v17, v17
    v_rcp_f32 v18, v18
    v_rcp_f32 v19, v19
    v_rcp_f32 v20, v20
    v_rcp_f32 v21, v21
    v_rcp_f32 v22, v22
    v_rcp_f32 v23, v23
    s_nop 0
    v_pk_mul_f32 v[24:25], v[24:25], v[16:17]
    v_pk_mul_f32 v[26:27], v[26:27], v[18:19]
    v_pk_mul_f32 v[28:29], v[28:29], v[20:21]
    v_pk_mul_f32 v[30:31], v[30:31], v[22:23]
    v_cvt_pk_bf16_f32 v36, v24, v25
    v_cvt_pk_bf16_f32 v37, v26, v27
    v_cvt_pk_bf16_f32 v38, v28, v29
    v_cvt_pk_bf16_f32 v39, v30, v31
    buffer_store_dwordx4 v[36:39], v14, s[20:23], s49 offen offset:128 sc1
    s_add_u32 s49, s49, 139264
    v_pk_mul_f32 v[16:17], v[112:113], v[112:113]
    v_pk_mul_f32 v[18:19], v[114:115], v[114:115]
    v_pk_mul_f32 v[20:21], v[116:117], v[116:117]
    v_pk_mul_f32 v[22:23], v[118:119], v[118:119]
    v_pk_fma_f32 v[16:17], v[16:17], v[8:9], v[10:11]
    v_pk_fma_f32 v[18:19], v[18:19], v[8:9], v[10:11]
    v_pk_fma_f32 v[20:21], v[20:21], v[8:9], v[10:11]
    v_pk_fma_f32 v[22:23], v[22:23], v[8:9], v[10:11]
    v_pk_mul_f32 v[16:17], v[16:17], v[112:113]
    v_pk_mul_f32 v[18:19], v[18:19], v[114:115]
    v_pk_mul_f32 v[20:21], v[20:21], v[116:117]
    v_pk_mul_f32 v[22:23], v[22:23], v[118:119]
    v_exp_f32 v16, v16
    v_exp_f32 v17, v17
    v_exp_f32 v18, v18
    v_exp_f32 v19, v19
    v_exp_f32 v20, v20
    v_exp_f32 v21, v21
    v_exp_f32 v22, v22
    v_exp_f32 v23, v23
    v_pk_mul_f32 v[24:25], v[112:113], v[120:121]
    v_pk_mul_f32 v[26:27], v[114:115], v[122:123]
    v_pk_mul_f32 v[28:29], v[116:117], v[124:125]
    v_pk_mul_f32 v[30:31], v[118:119], v[126:127]
    v_pk_add_f32 v[16:17], v[16:17], v[12:13]
    v_pk_add_f32 v[18:19], v[18:19], v[12:13]
    v_pk_add_f32 v[20:21], v[20:21], v[12:13]
    v_pk_add_f32 v[22:23], v[22:23], v[12:13]
    v_rcp_f32 v16, v16
    v_rcp_f32 v17, v17
    v_rcp_f32 v18, v18
    v_rcp_f32 v19, v19
    v_rcp_f32 v20, v20
    v_rcp_f32 v21, v21
    v_rcp_f32 v22, v22
    v_rcp_f32 v23, v23
    s_nop 0
    v_pk_mul_f32 v[24:25], v[24:25], v[16:17]
    v_pk_mul_f32 v[26:27], v[26:27], v[18:19]
    v_pk_mul_f32 v[28:29], v[28:29], v[20:21]
    v_pk_mul_f32 v[30:31], v[30:31], v[22:23]
    v_cvt_pk_bf16_f32 v32, v24, v25
    v_cvt_pk_bf16_f32 v33, v26, v27
    v_cvt_pk_bf16_f32 v34, v28, v29
    v_cvt_pk_bf16_f32 v35, v30, v31
    buffer_store_dwordx4 v[32:35], v14, s[20:23], s49 offen offset:0 sc1
    v_pk_mul_f32 v[16:17], v[128:129], v[128:129]
    v_pk_mul_f32 v[18:19], v[130:131], v[130:131]
    v_pk_mul_f32 v[20:21], v[132:133], v[132:133]
    v_pk_mul_f32 v[22:23], v[134:135], v[134:135]
    v_pk_fma_f32 v[16:17], v[16:17], v[8:9], v[10:11]
    v_pk_fma_f32 v[18:19], v[18:19], v[8:9], v[10:11]
    v_pk_fma_f32 v[20:21], v[20:21], v[8:9], v[10:11]
    v_pk_fma_f32 v[22:23], v[22:23], v[8:9], v[10:11]
    v_pk_mul_f32 v[16:17], v[16:17], v[128:129]
    v_pk_mul_f32 v[18:19], v[18:19], v[130:131]
    v_pk_mul_f32 v[20:21], v[20:21], v[132:133]
    v_pk_mul_f32 v[22:23], v[22:23], v[134:135]
    v_exp_f32 v16, v16
    v_exp_f32 v17, v17
    v_exp_f32 v18, v18
    v_exp_f32 v19, v19
    v_exp_f32 v20, v20
    v_exp_f32 v21, v21
    v_exp_f32 v22, v22
    v_exp_f32 v23, v23
    v_pk_mul_f32 v[24:25], v[128:129], v[136:137]
    v_pk_mul_f32 v[26:27], v[130:131], v[138:139]
    v_pk_mul_f32 v[28:29], v[132:133], v[140:141]
    v_pk_mul_f32 v[30:31], v[134:135], v[142:143]
    v_pk_add_f32 v[16:17], v[16:17], v[12:13]
    v_pk_add_f32 v[18:19], v[18:19], v[12:13]
    v_pk_add_f32 v[20:21], v[20:21], v[12:13]
    v_pk_add_f32 v[22:23], v[22:23], v[12:13]
    v_rcp_f32 v16, v16
    v_rcp_f32 v17, v17
    v_rcp_f32 v18, v18
    v_rcp_f32 v19, v19
    v_rcp_f32 v20, v20
    v_rcp_f32 v21, v21
    v_rcp_f32 v22, v22
    v_rcp_f32 v23, v23
    s_nop 0
    v_pk_mul_f32 v[24:25], v[24:25], v[16:17]
    v_pk_mul_f32 v[26:27], v[26:27], v[18:19]
    v_pk_mul_f32 v[28:29], v[28:29], v[20:21]
    v_pk_mul_f32 v[30:31], v[30:31], v[22:23]
    v_cvt_pk_bf16_f32 v36, v24, v25
    v_cvt_pk_bf16_f32 v37, v26, v27
    v_cvt_pk_bf16_f32 v38, v28, v29
    v_cvt_pk_bf16_f32 v39, v30, v31
    buffer_store_dwordx4 v[36:39], v14, s[20:23], s49 offen offset:128 sc1
    s_add_u32 s49, s49, 139264
    v_pk_mul_f32 v[16:17], v[144:145], v[144:145]
    v_pk_mul_f32 v[18:19], v[146:147], v[146:147]
    v_pk_mul_f32 v[20:21], v[148:149], v[148:149]
    v_pk_mul_f32 v[22:23], v[150:151], v[150:151]
    v_pk_fma_f32 v[16:17], v[16:17], v[8:9], v[10:11]
    v_pk_fma_f32 v[18:19], v[18:19], v[8:9], v[10:11]
    v_pk_fma_f32 v[20:21], v[20:21], v[8:9], v[10:11]
    v_pk_fma_f32 v[22:23], v[22:23], v[8:9], v[10:11]
    v_pk_mul_f32 v[16:17], v[16:17], v[144:145]
    v_pk_mul_f32 v[18:19], v[18:19], v[146:147]
    v_pk_mul_f32 v[20:21], v[20:21], v[148:149]
    v_pk_mul_f32 v[22:23], v[22:23], v[150:151]
    v_exp_f32 v16, v16
    v_exp_f32 v17, v17
    v_exp_f32 v18, v18
    v_exp_f32 v19, v19
    v_exp_f32 v20, v20
    v_exp_f32 v21, v21
    v_exp_f32 v22, v22
    v_exp_f32 v23, v23
    v_pk_mul_f32 v[24:25], v[144:145], v[152:153]
    v_pk_mul_f32 v[26:27], v[146:147], v[154:155]
    v_pk_mul_f32 v[28:29], v[148:149], v[156:157]
    v_pk_mul_f32 v[30:31], v[150:151], v[158:159]
    v_pk_add_f32 v[16:17], v[16:17], v[12:13]
    v_pk_add_f32 v[18:19], v[18:19], v[12:13]
    v_pk_add_f32 v[20:21], v[20:21], v[12:13]
    v_pk_add_f32 v[22:23], v[22:23], v[12:13]
    v_rcp_f32 v16, v16
    v_rcp_f32 v17, v17
    v_rcp_f32 v18, v18
    v_rcp_f32 v19, v19
    v_rcp_f32 v20, v20
    v_rcp_f32 v21, v21
    v_rcp_f32 v22, v22
    v_rcp_f32 v23, v23
    s_nop 0
    v_pk_mul_f32 v[24:25], v[24:25], v[16:17]
    v_pk_mul_f32 v[26:27], v[26:27], v[18:19]
    v_pk_mul_f32 v[28:29], v[28:29], v[20:21]
    v_pk_mul_f32 v[30:31], v[30:31], v[22:23]
    v_cvt_pk_bf16_f32 v32, v24, v25
    v_cvt_pk_bf16_f32 v33, v26, v27
    v_cvt_pk_bf16_f32 v34, v28, v29
    v_cvt_pk_bf16_f32 v35, v30, v31
    buffer_store_dwordx4 v[32:35], v14, s[20:23], s49 offen offset:0 sc1
    v_pk_mul_f32 v[16:17], v[160:161], v[160:161]
    v_pk_mul_f32 v[18:19], v[162:163], v[162:163]
    v_pk_mul_f32 v[20:21], v[164:165], v[164:165]
    v_pk_mul_f32 v[22:23], v[166:167], v[166:167]
    v_pk_fma_f32 v[16:17], v[16:17], v[8:9], v[10:11]
    v_pk_fma_f32 v[18:19], v[18:19], v[8:9], v[10:11]
    v_pk_fma_f32 v[20:21], v[20:21], v[8:9], v[10:11]
    v_pk_fma_f32 v[22:23], v[22:23], v[8:9], v[10:11]
    v_pk_mul_f32 v[16:17], v[16:17], v[160:161]
    v_pk_mul_f32 v[18:19], v[18:19], v[162:163]
    v_pk_mul_f32 v[20:21], v[20:21], v[164:165]
    v_pk_mul_f32 v[22:23], v[22:23], v[166:167]
    v_exp_f32 v16, v16
    v_exp_f32 v17, v17
    v_exp_f32 v18, v18
    v_exp_f32 v19, v19
    v_exp_f32 v20, v20
    v_exp_f32 v21, v21
    v_exp_f32 v22, v22
    v_exp_f32 v23, v23
    v_pk_mul_f32 v[24:25], v[160:161], v[168:169]
    v_pk_mul_f32 v[26:27], v[162:163], v[170:171]
    v_pk_mul_f32 v[28:29], v[164:165], v[172:173]
    v_pk_mul_f32 v[30:31], v[166:167], v[174:175]
    v_pk_add_f32 v[16:17], v[16:17], v[12:13]
    v_pk_add_f32 v[18:19], v[18:19], v[12:13]
    v_pk_add_f32 v[20:21], v[20:21], v[12:13]
    v_pk_add_f32 v[22:23], v[22:23], v[12:13]
    v_rcp_f32 v16, v16
    v_rcp_f32 v17, v17
    v_rcp_f32 v18, v18
    v_rcp_f32 v19, v19
    v_rcp_f32 v20, v20
    v_rcp_f32 v21, v21
    v_rcp_f32 v22, v22
    v_rcp_f32 v23, v23
    s_nop 0
    v_pk_mul_f32 v[24:25], v[24:25], v[16:17]
    v_pk_mul_f32 v[26:27], v[26:27], v[18:19]
    v_pk_mul_f32 v[28:29], v[28:29], v[20:21]
    v_pk_mul_f32 v[30:31], v[30:31], v[22:23]
    v_cvt_pk_bf16_f32 v36, v24, v25
    v_cvt_pk_bf16_f32 v37, v26, v27
    v_cvt_pk_bf16_f32 v38, v28, v29
    v_cvt_pk_bf16_f32 v39, v30, v31
    buffer_store_dwordx4 v[36:39], v14, s[20:23], s49 offen offset:128 sc1
    s_add_u32 s49, s49, 139264
    v_pk_mul_f32 v[16:17], v[176:177], v[176:177]
    v_pk_mul_f32 v[18:19], v[178:179], v[178:179]
    v_pk_mul_f32 v[20:21], v[180:181], v[180:181]
    v_pk_mul_f32 v[22:23], v[182:183], v[182:183]
    v_pk_fma_f32 v[16:17], v[16:17], v[8:9], v[10:11]
    v_pk_fma_f32 v[18:19], v[18:19], v[8:9], v[10:11]
    v_pk_fma_f32 v[20:21], v[20:21], v[8:9], v[10:11]
    v_pk_fma_f32 v[22:23], v[22:23], v[8:9], v[10:11]
    v_pk_mul_f32 v[16:17], v[16:17], v[176:177]
    v_pk_mul_f32 v[18:19], v[18:19], v[178:179]
    v_pk_mul_f32 v[20:21], v[20:21], v[180:181]
    v_pk_mul_f32 v[22:23], v[22:23], v[182:183]
    v_exp_f32 v16, v16
    v_exp_f32 v17, v17
    v_exp_f32 v18, v18
    v_exp_f32 v19, v19
    v_exp_f32 v20, v20
    v_exp_f32 v21, v21
    v_exp_f32 v22, v22
    v_exp_f32 v23, v23
    v_pk_mul_f32 v[24:25], v[176:177], v[184:185]
    v_pk_mul_f32 v[26:27], v[178:179], v[186:187]
    v_pk_mul_f32 v[28:29], v[180:181], v[188:189]
    v_pk_mul_f32 v[30:31], v[182:183], v[190:191]
    v_pk_add_f32 v[16:17], v[16:17], v[12:13]
    v_pk_add_f32 v[18:19], v[18:19], v[12:13]
    v_pk_add_f32 v[20:21], v[20:21], v[12:13]
    v_pk_add_f32 v[22:23], v[22:23], v[12:13]
    v_rcp_f32 v16, v16
    v_rcp_f32 v17, v17
    v_rcp_f32 v18, v18
    v_rcp_f32 v19, v19
    v_rcp_f32 v20, v20
    v_rcp_f32 v21, v21
    v_rcp_f32 v22, v22
    v_rcp_f32 v23, v23
    s_nop 0
    v_pk_mul_f32 v[24:25], v[24:25], v[16:17]
    v_pk_mul_f32 v[26:27], v[26:27], v[18:19]
    v_pk_mul_f32 v[28:29], v[28:29], v[20:21]
    v_pk_mul_f32 v[30:31], v[30:31], v[22:23]
    v_cvt_pk_bf16_f32 v32, v24, v25
    v_cvt_pk_bf16_f32 v33, v26, v27
    v_cvt_pk_bf16_f32 v34, v28, v29
    v_cvt_pk_bf16_f32 v35, v30, v31
    buffer_store_dwordx4 v[32:35], v14, s[20:23], s49 offen offset:0 sc1
    v_pk_mul_f32 v[16:17], v[192:193], v[192:193]
    v_pk_mul_f32 v[18:19], v[194:195], v[194:195]
    v_pk_mul_f32 v[20:21], v[196:197], v[196:197]
    v_pk_mul_f32 v[22:23], v[198:199], v[198:199]
    v_pk_fma_f32 v[16:17], v[16:17], v[8:9], v[10:11]
    v_pk_fma_f32 v[18:19], v[18:19], v[8:9], v[10:11]
    v_pk_fma_f32 v[20:21], v[20:21], v[8:9], v[10:11]
    v_pk_fma_f32 v[22:23], v[22:23], v[8:9], v[10:11]
    v_pk_mul_f32 v[16:17], v[16:17], v[192:193]
    v_pk_mul_f32 v[18:19], v[18:19], v[194:195]
    v_pk_mul_f32 v[20:21], v[20:21], v[196:197]
    v_pk_mul_f32 v[22:23], v[22:23], v[198:199]
    v_exp_f32 v16, v16
    v_exp_f32 v17, v17
    v_exp_f32 v18, v18
    v_exp_f32 v19, v19
    v_exp_f32 v20, v20
    v_exp_f32 v21, v21
    v_exp_f32 v22, v22
    v_exp_f32 v23, v23
    v_pk_mul_f32 v[24:25], v[192:193], v[200:201]
    v_pk_mul_f32 v[26:27], v[194:195], v[202:203]
    v_pk_mul_f32 v[28:29], v[196:197], v[204:205]
    v_pk_mul_f32 v[30:31], v[198:199], v[206:207]
    v_pk_add_f32 v[16:17], v[16:17], v[12:13]
    v_pk_add_f32 v[18:19], v[18:19], v[12:13]
    v_pk_add_f32 v[20:21], v[20:21], v[12:13]
    v_pk_add_f32 v[22:23], v[22:23], v[12:13]
    v_rcp_f32 v16, v16
    v_rcp_f32 v17, v17
    v_rcp_f32 v18, v18
    v_rcp_f32 v19, v19
    v_rcp_f32 v20, v20
    v_rcp_f32 v21, v21
    v_rcp_f32 v22, v22
    v_rcp_f32 v23, v23
    s_nop 0
    v_pk_mul_f32 v[24:25], v[24:25], v[16:17]
    v_pk_mul_f32 v[26:27], v[26:27], v[18:19]
    v_pk_mul_f32 v[28:29], v[28:29], v[20:21]
    v_pk_mul_f32 v[30:31], v[30:31], v[22:23]
    v_cvt_pk_bf16_f32 v36, v24, v25
    v_cvt_pk_bf16_f32 v37, v26, v27
    v_cvt_pk_bf16_f32 v38, v28, v29
    v_cvt_pk_bf16_f32 v39, v30, v31
    buffer_store_dwordx4 v[36:39], v14, s[20:23], s49 offen offset:128 sc1
    s_add_u32 s49, s49, 139264
    s_cmp_eq_u32 s47, 4
    s_cbranch_scc1 gated_mix__softmax_full_mha__glu_gated_geglu__prompt_kernel_gu_done
    v_pk_mul_f32 v[16:17], v[208:209], v[208:209]
    v_pk_mul_f32 v[18:19], v[210:211], v[210:211]
    v_pk_mul_f32 v[20:21], v[212:213], v[212:213]
    v_pk_mul_f32 v[22:23], v[214:215], v[214:215]
    v_pk_fma_f32 v[16:17], v[16:17], v[8:9], v[10:11]
    v_pk_fma_f32 v[18:19], v[18:19], v[8:9], v[10:11]
    v_pk_fma_f32 v[20:21], v[20:21], v[8:9], v[10:11]
    v_pk_fma_f32 v[22:23], v[22:23], v[8:9], v[10:11]
    v_pk_mul_f32 v[16:17], v[16:17], v[208:209]
    v_pk_mul_f32 v[18:19], v[18:19], v[210:211]
    v_pk_mul_f32 v[20:21], v[20:21], v[212:213]
    v_pk_mul_f32 v[22:23], v[22:23], v[214:215]
    v_exp_f32 v16, v16
    v_exp_f32 v17, v17
    v_exp_f32 v18, v18
    v_exp_f32 v19, v19
    v_exp_f32 v20, v20
    v_exp_f32 v21, v21
    v_exp_f32 v22, v22
    v_exp_f32 v23, v23
    v_pk_mul_f32 v[24:25], v[208:209], v[216:217]
    v_pk_mul_f32 v[26:27], v[210:211], v[218:219]
    v_pk_mul_f32 v[28:29], v[212:213], v[220:221]
    v_pk_mul_f32 v[30:31], v[214:215], v[222:223]
    v_pk_add_f32 v[16:17], v[16:17], v[12:13]
    v_pk_add_f32 v[18:19], v[18:19], v[12:13]
    v_pk_add_f32 v[20:21], v[20:21], v[12:13]
    v_pk_add_f32 v[22:23], v[22:23], v[12:13]
    v_rcp_f32 v16, v16
    v_rcp_f32 v17, v17
    v_rcp_f32 v18, v18
    v_rcp_f32 v19, v19
    v_rcp_f32 v20, v20
    v_rcp_f32 v21, v21
    v_rcp_f32 v22, v22
    v_rcp_f32 v23, v23
    s_nop 0
    v_pk_mul_f32 v[24:25], v[24:25], v[16:17]
    v_pk_mul_f32 v[26:27], v[26:27], v[18:19]
    v_pk_mul_f32 v[28:29], v[28:29], v[20:21]
    v_pk_mul_f32 v[30:31], v[30:31], v[22:23]
    v_cvt_pk_bf16_f32 v32, v24, v25
    v_cvt_pk_bf16_f32 v33, v26, v27
    v_cvt_pk_bf16_f32 v34, v28, v29
    v_cvt_pk_bf16_f32 v35, v30, v31
    buffer_store_dwordx4 v[32:35], v14, s[20:23], s49 offen offset:0 sc1
    v_pk_mul_f32 v[16:17], v[224:225], v[224:225]
    v_pk_mul_f32 v[18:19], v[226:227], v[226:227]
    v_pk_mul_f32 v[20:21], v[228:229], v[228:229]
    v_pk_mul_f32 v[22:23], v[230:231], v[230:231]
    v_pk_fma_f32 v[16:17], v[16:17], v[8:9], v[10:11]
    v_pk_fma_f32 v[18:19], v[18:19], v[8:9], v[10:11]
    v_pk_fma_f32 v[20:21], v[20:21], v[8:9], v[10:11]
    v_pk_fma_f32 v[22:23], v[22:23], v[8:9], v[10:11]
    v_pk_mul_f32 v[16:17], v[16:17], v[224:225]
    v_pk_mul_f32 v[18:19], v[18:19], v[226:227]
    v_pk_mul_f32 v[20:21], v[20:21], v[228:229]
    v_pk_mul_f32 v[22:23], v[22:23], v[230:231]
    v_exp_f32 v16, v16
    v_exp_f32 v17, v17
    v_exp_f32 v18, v18
    v_exp_f32 v19, v19
    v_exp_f32 v20, v20
    v_exp_f32 v21, v21
    v_exp_f32 v22, v22
    v_exp_f32 v23, v23
    v_pk_mul_f32 v[24:25], v[224:225], v[232:233]
    v_pk_mul_f32 v[26:27], v[226:227], v[234:235]
    v_pk_mul_f32 v[28:29], v[228:229], v[236:237]
    v_pk_mul_f32 v[30:31], v[230:231], v[238:239]
    v_pk_add_f32 v[16:17], v[16:17], v[12:13]
    v_pk_add_f32 v[18:19], v[18:19], v[12:13]
    v_pk_add_f32 v[20:21], v[20:21], v[12:13]
    v_pk_add_f32 v[22:23], v[22:23], v[12:13]
    v_rcp_f32 v16, v16
    v_rcp_f32 v17, v17
    v_rcp_f32 v18, v18
    v_rcp_f32 v19, v19
    v_rcp_f32 v20, v20
    v_rcp_f32 v21, v21
    v_rcp_f32 v22, v22
    v_rcp_f32 v23, v23
    s_nop 0
    v_pk_mul_f32 v[24:25], v[24:25], v[16:17]
    v_pk_mul_f32 v[26:27], v[26:27], v[18:19]
    v_pk_mul_f32 v[28:29], v[28:29], v[20:21]
    v_pk_mul_f32 v[30:31], v[30:31], v[22:23]
    v_cvt_pk_bf16_f32 v36, v24, v25
    v_cvt_pk_bf16_f32 v37, v26, v27
    v_cvt_pk_bf16_f32 v38, v28, v29
    v_cvt_pk_bf16_f32 v39, v30, v31
    buffer_store_dwordx4 v[36:39], v14, s[20:23], s49 offen offset:128 sc1
gated_mix__softmax_full_mha__glu_gated_geglu__prompt_kernel_gu_done:
    s_branch gated_mix__softmax_full_mha__glu_gated_geglu__prompt_kernel_join
.p2align 12
.fill 512, 4, 0xbf800000
gated_mix__softmax_full_mha__glu_gated_geglu__prompt_kernel_v:
    s_mov_b32 s54, 163840
    v_add_u32 v8, s48, v1
    v_add_u32 v8, 0, v8
    v_mul_u32_u24 v11, 205, v8
    v_lshrrev_b32 v11, 12, v11
    v_mul_u32_u24 v12, 20, v11
    v_sub_u32 v10, v8, v12
    v_bfe_u32 v12, v10, 2, 2
    v_xor_b32 v12, v12, v2
    v_lshlrev_b32 v12, 4, v12
    v_lshl_add_u32 v12, v10, 6, v12
    v_mad_u32_u24 v11, v11, s54, v12
    v_add_u32 v251, 5244160, v11
    v_add_u32 v8, s48, v1
    v_add_u32 v8, 16, v8
    v_mul_u32_u24 v11, 205, v8
    v_lshrrev_b32 v11, 12, v11
    v_mul_u32_u24 v12, 20, v11
    v_sub_u32 v10, v8, v12
    v_bfe_u32 v12, v10, 2, 2
    v_xor_b32 v12, v12, v2
    v_lshlrev_b32 v12, 4, v12
    v_lshl_add_u32 v12, v10, 6, v12
    v_mad_u32_u24 v11, v11, s54, v12
    v_add_u32 v252, 5244160, v11
    v_add_u32 v8, s48, v1
    v_add_u32 v8, 0, v8
    v_add_u32 v8, s49, v8
    v_mul_u32_u24 v11, 205, v8
    v_lshrrev_b32 v11, 12, v11
    v_mul_u32_u24 v12, 20, v11
    v_sub_u32 v10, v8, v12
    v_bfe_u32 v12, v10, 2, 2
    v_xor_b32 v12, v12, v2
    v_lshlrev_b32 v12, 4, v12
    v_lshl_add_u32 v12, v10, 6, v12
    v_mad_u32_u24 v11, v11, s54, v12
    v_add_u32 v253, 5244160, v11
    v_add_u32 v8, s48, v1
    v_add_u32 v8, 16, v8
    v_add_u32 v8, s49, v8
    v_mul_u32_u24 v11, 205, v8
    v_lshrrev_b32 v11, 12, v11
    v_mul_u32_u24 v12, 20, v11
    v_sub_u32 v10, v8, v12
    v_bfe_u32 v12, v10, 2, 2
    v_xor_b32 v12, v12, v2
    v_lshlrev_b32 v12, 4, v12
    v_lshl_add_u32 v12, v10, 6, v12
    v_mad_u32_u24 v11, v11, s54, v12
    v_add_u32 v254, 5244160, v11
    s_mov_b32 s36, 0
    s_mov_b32 s37, 0
    v_mov_b32 v241, v240
    v_mov_b32 v242, v240
    v_mov_b32 v247, v243
    v_mov_b32 v248, v244
    v_mov_b32 v249, v245
    v_mov_b32 v250, v246
    s_barrier
    ds_read_b128 v[8:11], v242 offset:0
    ds_read_b128 v[12:15], v242 offset:1024
    ds_read_b128 v[16:19], v242 offset:4096
    ds_read_b64_tr_b16 v[48:49], v247 offset:0
    ds_read_b128 v[20:23], v242 offset:5120
    ds_read_b64_tr_b16 v[50:51], v247 offset:1024
    ds_read_b128 v[24:27], v242 offset:8192
    ds_read_b64_tr_b16 v[52:53], v248 offset:0
    ds_read_b128 v[28:31], v242 offset:9216
    ds_read_b64_tr_b16 v[54:55], v248 offset:1024
    ds_read_b128 v[32:35], v242 offset:12288
    ds_read_b64_tr_b16 v[56:57], v249 offset:0
    ds_read_b128 v[36:39], v242 offset:13312
    ds_read_b64_tr_b16 v[58:59], v249 offset:1024
    ds_read_b128 v[40:43], v242 offset:16384
    ds_read_b64_tr_b16 v[60:61], v250 offset:0
    ds_read_b64_tr_b16 v[62:63], v250 offset:1024
    ds_read_b128 v[44:47], v242 offset:17408
    s_waitcnt lgkmcnt(12)
    v_mfma_f32_16x16x32_bf16 v[80:83], v[8:11], v[48:51], v[80:83]
    v_xor_b32 v242, 64, v241
    s_waitcnt lgkmcnt(8)
    v_mfma_f32_16x16x32_bf16 v[84:87], v[8:11], v[52:55], v[84:87]
    s_waitcnt lgkmcnt(4)
    v_mfma_f32_16x16x32_bf16 v[88:91], v[8:11], v[56:59], v[88:91]
    s_waitcnt lgkmcnt(1)
    v_mfma_f32_16x16x32_bf16 v[92:95], v[8:11], v[60:63], v[92:95]
    v_mfma_f32_16x16x32_bf16 v[96:99], v[12:15], v[48:51], v[96:99]
    v_mfma_f32_16x16x32_bf16 v[100:103], v[12:15], v[52:55], v[100:103]
    v_mfma_f32_16x16x32_bf16 v[104:107], v[12:15], v[56:59], v[104:107]
    v_mfma_f32_16x16x32_bf16 v[108:111], v[12:15], v[60:63], v[108:111]
    s_waitcnt lgkmcnt(0)
    s_barrier
    ds_read_b128 v[8:11], v242 offset:0
    v_mfma_f32_16x16x32_bf16 v[112:115], v[16:19], v[48:51], v[112:115]
    v_mfma_f32_16x16x32_bf16 v[116:119], v[16:19], v[52:55], v[116:119]
    ds_read_b128 v[12:15], v242 offset:1024
    v_mfma_f32_16x16x32_bf16 v[120:123], v[16:19], v[56:59], v[120:123]
    v_mfma_f32_16x16x32_bf16 v[124:127], v[16:19], v[60:63], v[124:127]
    ds_read_b128 v[16:19], v242 offset:4096
    v_mfma_f32_16x16x32_bf16 v[128:131], v[20:23], v[48:51], v[128:131]
    v_mfma_f32_16x16x32_bf16 v[132:135], v[20:23], v[52:55], v[132:135]
    ds_read_b64_tr_b16 v[64:65], v247 offset:8192
    v_mfma_f32_16x16x32_bf16 v[136:139], v[20:23], v[56:59], v[136:139]
    v_mfma_f32_16x16x32_bf16 v[140:143], v[20:23], v[60:63], v[140:143]
    ds_read_b128 v[20:23], v242 offset:5120
    v_mfma_f32_16x16x32_bf16 v[144:147], v[24:27], v[48:51], v[144:147]
    v_mfma_f32_16x16x32_bf16 v[148:151], v[24:27], v[52:55], v[148:151]
    ds_read_b64_tr_b16 v[66:67], v247 offset:9216
    v_mfma_f32_16x16x32_bf16 v[152:155], v[24:27], v[56:59], v[152:155]
    v_mfma_f32_16x16x32_bf16 v[156:159], v[24:27], v[60:63], v[156:159]
    ds_read_b128 v[24:27], v242 offset:8192
    v_mfma_f32_16x16x32_bf16 v[160:163], v[28:31], v[48:51], v[160:163]
    v_mfma_f32_16x16x32_bf16 v[164:167], v[28:31], v[52:55], v[164:167]
    ds_read_b64_tr_b16 v[68:69], v248 offset:8192
    v_mfma_f32_16x16x32_bf16 v[168:171], v[28:31], v[56:59], v[168:171]
    v_mfma_f32_16x16x32_bf16 v[172:175], v[28:31], v[60:63], v[172:175]
    ds_read_b128 v[28:31], v242 offset:9216
    v_mfma_f32_16x16x32_bf16 v[176:179], v[32:35], v[48:51], v[176:179]
    v_mfma_f32_16x16x32_bf16 v[180:183], v[32:35], v[52:55], v[180:183]
    ds_read_b64_tr_b16 v[70:71], v248 offset:9216
    v_mfma_f32_16x16x32_bf16 v[184:187], v[32:35], v[56:59], v[184:187]
    v_mfma_f32_16x16x32_bf16 v[188:191], v[32:35], v[60:63], v[188:191]
    ds_read_b128 v[32:35], v242 offset:12288
    v_mfma_f32_16x16x32_bf16 v[192:195], v[36:39], v[48:51], v[192:195]
    v_mfma_f32_16x16x32_bf16 v[196:199], v[36:39], v[52:55], v[196:199]
    ds_read_b64_tr_b16 v[72:73], v249 offset:8192
    v_mfma_f32_16x16x32_bf16 v[200:203], v[36:39], v[56:59], v[200:203]
    v_mfma_f32_16x16x32_bf16 v[204:207], v[36:39], v[60:63], v[204:207]
    ds_read_b128 v[36:39], v242 offset:13312
    v_mfma_f32_16x16x32_bf16 v[208:211], v[40:43], v[48:51], v[208:211]
    v_mfma_f32_16x16x32_bf16 v[212:215], v[40:43], v[52:55], v[212:215]
    ds_read_b64_tr_b16 v[74:75], v249 offset:9216
    v_mfma_f32_16x16x32_bf16 v[216:219], v[40:43], v[56:59], v[216:219]
    v_mfma_f32_16x16x32_bf16 v[220:223], v[40:43], v[60:63], v[220:223]
    ds_read_b128 v[40:43], v242 offset:16384
    v_mfma_f32_16x16x32_bf16 v[224:227], v[44:47], v[48:51], v[224:227]
    ds_read_b64_tr_b16 v[76:77], v250 offset:8192
    v_mfma_f32_16x16x32_bf16 v[228:231], v[44:47], v[52:55], v[228:231]
    ds_read_b64_tr_b16 v[78:79], v250 offset:9216
    v_mfma_f32_16x16x32_bf16 v[232:235], v[44:47], v[56:59], v[232:235]
    v_mfma_f32_16x16x32_bf16 v[236:239], v[44:47], v[60:63], v[236:239]
    ds_read_b128 v[44:47], v242 offset:17408
    s_waitcnt lgkmcnt(12)
    v_mfma_f32_16x16x32_bf16 v[80:83], v[8:11], v[64:67], v[80:83]
    s_add_u32 s36, s36, 53248
    s_cmp_eq_u32 s36, 159744
    s_waitcnt lgkmcnt(8)
    v_mfma_f32_16x16x32_bf16 v[84:87], v[8:11], v[68:71], v[84:87]
    s_cselect_b32 s36, 0, s36
    s_add_u32 s37, s37, 1
    s_waitcnt lgkmcnt(4)
    v_mfma_f32_16x16x32_bf16 v[88:91], v[8:11], v[72:75], v[88:91]
    v_add_u32 v241, s36, v240
    v_add_u32 v242, s36, v240
    s_waitcnt lgkmcnt(1)
    v_mfma_f32_16x16x32_bf16 v[92:95], v[8:11], v[76:79], v[92:95]
    v_add_u32 v247, s36, v243
    v_add_u32 v248, s36, v244
    v_mfma_f32_16x16x32_bf16 v[96:99], v[12:15], v[64:67], v[96:99]
    v_add_u32 v249, s36, v245
    v_add_u32 v250, s36, v246
    v_mfma_f32_16x16x32_bf16 v[100:103], v[12:15], v[68:71], v[100:103]
    s_cmp_eq_u32 s37, 10
    v_mfma_f32_16x16x32_bf16 v[104:107], v[12:15], v[72:75], v[104:107]
    v_mfma_f32_16x16x32_bf16 v[108:111], v[12:15], v[76:79], v[108:111]
    s_waitcnt lgkmcnt(0)
    s_barrier
    ds_read_b128 v[8:11], v242 offset:0
    v_mfma_f32_16x16x32_bf16 v[112:115], v[16:19], v[64:67], v[112:115]
    v_mfma_f32_16x16x32_bf16 v[116:119], v[16:19], v[68:71], v[116:119]
    ds_read_b128 v[12:15], v242 offset:1024
    v_mfma_f32_16x16x32_bf16 v[120:123], v[16:19], v[72:75], v[120:123]
    v_mfma_f32_16x16x32_bf16 v[124:127], v[16:19], v[76:79], v[124:127]
    ds_read_b128 v[16:19], v242 offset:4096
    v_mfma_f32_16x16x32_bf16 v[128:131], v[20:23], v[64:67], v[128:131]
    v_mfma_f32_16x16x32_bf16 v[132:135], v[20:23], v[68:71], v[132:135]
    ds_read_b64_tr_b16 v[48:49], v247 offset:0
    v_mfma_f32_16x16x32_bf16 v[136:139], v[20:23], v[72:75], v[136:139]
    v_mfma_f32_16x16x32_bf16 v[140:143], v[20:23], v[76:79], v[140:143]
    ds_read_b128 v[20:23], v242 offset:5120
    v_mfma_f32_16x16x32_bf16 v[144:147], v[24:27], v[64:67], v[144:147]
    v_mfma_f32_16x16x32_bf16 v[148:151], v[24:27], v[68:71], v[148:151]
    ds_read_b64_tr_b16 v[50:51], v247 offset:1024
    v_mfma_f32_16x16x32_bf16 v[152:155], v[24:27], v[72:75], v[152:155]
    v_mfma_f32_16x16x32_bf16 v[156:159], v[24:27], v[76:79], v[156:159]
    ds_read_b128 v[24:27], v242 offset:8192
    v_mfma_f32_16x16x32_bf16 v[160:163], v[28:31], v[64:67], v[160:163]
    v_mfma_f32_16x16x32_bf16 v[164:167], v[28:31], v[68:71], v[164:167]
    ds_read_b64_tr_b16 v[52:53], v248 offset:0
    v_mfma_f32_16x16x32_bf16 v[168:171], v[28:31], v[72:75], v[168:171]
    v_mfma_f32_16x16x32_bf16 v[172:175], v[28:31], v[76:79], v[172:175]
    ds_read_b128 v[28:31], v242 offset:9216
    v_mfma_f32_16x16x32_bf16 v[176:179], v[32:35], v[64:67], v[176:179]
    v_mfma_f32_16x16x32_bf16 v[180:183], v[32:35], v[68:71], v[180:183]
    ds_read_b64_tr_b16 v[54:55], v248 offset:1024
    v_mfma_f32_16x16x32_bf16 v[184:187], v[32:35], v[72:75], v[184:187]
    v_mfma_f32_16x16x32_bf16 v[188:191], v[32:35], v[76:79], v[188:191]
    ds_read_b128 v[32:35], v242 offset:12288
    v_mfma_f32_16x16x32_bf16 v[192:195], v[36:39], v[64:67], v[192:195]
    v_mfma_f32_16x16x32_bf16 v[196:199], v[36:39], v[68:71], v[196:199]
    ds_read_b64_tr_b16 v[56:57], v249 offset:0
    v_mfma_f32_16x16x32_bf16 v[200:203], v[36:39], v[72:75], v[200:203]
    v_mfma_f32_16x16x32_bf16 v[204:207], v[36:39], v[76:79], v[204:207]
    ds_read_b128 v[36:39], v242 offset:13312
    v_mfma_f32_16x16x32_bf16 v[208:211], v[40:43], v[64:67], v[208:211]
    v_mfma_f32_16x16x32_bf16 v[212:215], v[40:43], v[68:71], v[212:215]
    ds_read_b64_tr_b16 v[58:59], v249 offset:1024
    v_mfma_f32_16x16x32_bf16 v[216:219], v[40:43], v[72:75], v[216:219]
    v_mfma_f32_16x16x32_bf16 v[220:223], v[40:43], v[76:79], v[220:223]
    ds_read_b128 v[40:43], v242 offset:16384
    v_mfma_f32_16x16x32_bf16 v[224:227], v[44:47], v[64:67], v[224:227]
    ds_read_b64_tr_b16 v[60:61], v250 offset:0
    v_mfma_f32_16x16x32_bf16 v[228:231], v[44:47], v[68:71], v[228:231]
    ds_read_b64_tr_b16 v[62:63], v250 offset:1024
    v_mfma_f32_16x16x32_bf16 v[232:235], v[44:47], v[72:75], v[232:235]
    v_mfma_f32_16x16x32_bf16 v[236:239], v[44:47], v[76:79], v[236:239]
    ds_read_b128 v[44:47], v242 offset:17408
.p2align 5
Lk1loop_3:
    s_waitcnt lgkmcnt(12)
    v_mfma_f32_16x16x32_bf16 v[80:83], v[8:11], v[48:51], v[80:83]
    v_xor_b32 v242, 64, v241
    s_waitcnt lgkmcnt(8)
    v_mfma_f32_16x16x32_bf16 v[84:87], v[8:11], v[52:55], v[84:87]
    ds_read_b64_tr_b16 v[64:65], v247 offset:8192
    s_waitcnt lgkmcnt(5)
    v_mfma_f32_16x16x32_bf16 v[88:91], v[8:11], v[56:59], v[88:91]
    s_waitcnt lgkmcnt(2)
    v_mfma_f32_16x16x32_bf16 v[92:95], v[8:11], v[60:63], v[92:95]
    ds_read_b128 v[8:11], v242 offset:0
    v_mfma_f32_16x16x32_bf16 v[96:99], v[12:15], v[48:51], v[96:99]
    v_mfma_f32_16x16x32_bf16 v[100:103], v[12:15], v[52:55], v[100:103]
    ds_read_b64_tr_b16 v[66:67], v247 offset:9216
    v_mfma_f32_16x16x32_bf16 v[104:107], v[12:15], v[56:59], v[104:107]
    v_mfma_f32_16x16x32_bf16 v[108:111], v[12:15], v[60:63], v[108:111]
    ds_read_b128 v[12:15], v242 offset:1024
    v_mfma_f32_16x16x32_bf16 v[112:115], v[16:19], v[48:51], v[112:115]
    v_mfma_f32_16x16x32_bf16 v[116:119], v[16:19], v[52:55], v[116:119]
    ds_read_b64_tr_b16 v[68:69], v248 offset:8192
    v_mfma_f32_16x16x32_bf16 v[120:123], v[16:19], v[56:59], v[120:123]
    v_mfma_f32_16x16x32_bf16 v[124:127], v[16:19], v[60:63], v[124:127]
    ds_read_b128 v[16:19], v242 offset:4096
    v_mfma_f32_16x16x32_bf16 v[128:131], v[20:23], v[48:51], v[128:131]
    v_mfma_f32_16x16x32_bf16 v[132:135], v[20:23], v[52:55], v[132:135]
    ds_read_b64_tr_b16 v[70:71], v248 offset:9216
    v_mfma_f32_16x16x32_bf16 v[136:139], v[20:23], v[56:59], v[136:139]
    v_mfma_f32_16x16x32_bf16 v[140:143], v[20:23], v[60:63], v[140:143]
    ds_read_b128 v[20:23], v242 offset:5120
    v_mfma_f32_16x16x32_bf16 v[144:147], v[24:27], v[48:51], v[144:147]
    v_mfma_f32_16x16x32_bf16 v[148:151], v[24:27], v[52:55], v[148:151]
    ds_read_b64_tr_b16 v[72:73], v249 offset:8192
    v_mfma_f32_16x16x32_bf16 v[152:155], v[24:27], v[56:59], v[152:155]
    v_mfma_f32_16x16x32_bf16 v[156:159], v[24:27], v[60:63], v[156:159]
    ds_read_b128 v[24:27], v242 offset:8192
    v_mfma_f32_16x16x32_bf16 v[160:163], v[28:31], v[48:51], v[160:163]
    v_mfma_f32_16x16x32_bf16 v[164:167], v[28:31], v[52:55], v[164:167]
    ds_read_b64_tr_b16 v[74:75], v249 offset:9216
    v_mfma_f32_16x16x32_bf16 v[168:171], v[28:31], v[56:59], v[168:171]
    v_mfma_f32_16x16x32_bf16 v[172:175], v[28:31], v[60:63], v[172:175]
    ds_read_b128 v[28:31], v242 offset:9216
    v_mfma_f32_16x16x32_bf16 v[176:179], v[32:35], v[48:51], v[176:179]
    v_mfma_f32_16x16x32_bf16 v[180:183], v[32:35], v[52:55], v[180:183]
    ds_read_b64_tr_b16 v[76:77], v250 offset:8192
    v_mfma_f32_16x16x32_bf16 v[184:187], v[32:35], v[56:59], v[184:187]
    v_mfma_f32_16x16x32_bf16 v[188:191], v[32:35], v[60:63], v[188:191]
    ds_read_b128 v[32:35], v242 offset:12288
    v_mfma_f32_16x16x32_bf16 v[192:195], v[36:39], v[48:51], v[192:195]
    v_mfma_f32_16x16x32_bf16 v[196:199], v[36:39], v[52:55], v[196:199]
    ds_read_b64_tr_b16 v[78:79], v250 offset:9216
    v_mfma_f32_16x16x32_bf16 v[200:203], v[36:39], v[56:59], v[200:203]
    v_mfma_f32_16x16x32_bf16 v[204:207], v[36:39], v[60:63], v[204:207]
    ds_read_b128 v[36:39], v242 offset:13312
    v_mfma_f32_16x16x32_bf16 v[208:211], v[40:43], v[48:51], v[208:211]
    v_mfma_f32_16x16x32_bf16 v[212:215], v[40:43], v[52:55], v[212:215]
    v_mfma_f32_16x16x32_bf16 v[216:219], v[40:43], v[56:59], v[216:219]
    v_mfma_f32_16x16x32_bf16 v[220:223], v[40:43], v[60:63], v[220:223]
    ds_read_b128 v[40:43], v242 offset:16384
    s_waitcnt lgkmcnt(15)
    v_mfma_f32_16x16x32_bf16 v[224:227], v[44:47], v[48:51], v[224:227]
    v_mfma_f32_16x16x32_bf16 v[228:231], v[44:47], v[52:55], v[228:231]
    v_mfma_f32_16x16x32_bf16 v[232:235], v[44:47], v[56:59], v[232:235]
    v_mfma_f32_16x16x32_bf16 v[236:239], v[44:47], v[60:63], v[236:239]
    ds_read_b128 v[44:47], v242 offset:17408
    s_waitcnt lgkmcnt(15)
    v_mfma_f32_16x16x32_bf16 v[80:83], v[8:11], v[64:67], v[80:83]
    s_add_u32 s36, s36, 53248
    s_cmp_eq_u32 s36, 159744
    s_waitcnt lgkmcnt(11)
    v_mfma_f32_16x16x32_bf16 v[84:87], v[8:11], v[68:71], v[84:87]
    s_cselect_b32 s36, 0, s36
    s_add_u32 s37, s37, 1
    s_waitcnt lgkmcnt(7)
    v_mfma_f32_16x16x32_bf16 v[88:91], v[8:11], v[72:75], v[88:91]
    v_add_u32 v241, s36, v240
    v_add_u32 v242, s36, v240
    s_waitcnt lgkmcnt(3)
    v_mfma_f32_16x16x32_bf16 v[92:95], v[8:11], v[76:79], v[92:95]
    v_add_u32 v247, s36, v243
    v_add_u32 v248, s36, v244
    v_mfma_f32_16x16x32_bf16 v[96:99], v[12:15], v[64:67], v[96:99]
    v_add_u32 v249, s36, v245
    v_add_u32 v250, s36, v246
    v_mfma_f32_16x16x32_bf16 v[100:103], v[12:15], v[68:71], v[100:103]
    s_cmp_eq_u32 s37, 10
    v_mfma_f32_16x16x32_bf16 v[104:107], v[12:15], v[72:75], v[104:107]
    v_mfma_f32_16x16x32_bf16 v[108:111], v[12:15], v[76:79], v[108:111]
    s_waitcnt lgkmcnt(0)
    s_barrier
    ds_read_b128 v[8:11], v242 offset:0
    v_mfma_f32_16x16x32_bf16 v[112:115], v[16:19], v[64:67], v[112:115]
    v_mfma_f32_16x16x32_bf16 v[116:119], v[16:19], v[68:71], v[116:119]
    ds_read_b128 v[12:15], v242 offset:1024
    v_mfma_f32_16x16x32_bf16 v[120:123], v[16:19], v[72:75], v[120:123]
    v_mfma_f32_16x16x32_bf16 v[124:127], v[16:19], v[76:79], v[124:127]
    ds_read_b128 v[16:19], v242 offset:4096
    v_mfma_f32_16x16x32_bf16 v[128:131], v[20:23], v[64:67], v[128:131]
    v_mfma_f32_16x16x32_bf16 v[132:135], v[20:23], v[68:71], v[132:135]
    ds_read_b64_tr_b16 v[48:49], v247 offset:0
    v_mfma_f32_16x16x32_bf16 v[136:139], v[20:23], v[72:75], v[136:139]
    v_mfma_f32_16x16x32_bf16 v[140:143], v[20:23], v[76:79], v[140:143]
    ds_read_b128 v[20:23], v242 offset:5120
    v_mfma_f32_16x16x32_bf16 v[144:147], v[24:27], v[64:67], v[144:147]
    v_mfma_f32_16x16x32_bf16 v[148:151], v[24:27], v[68:71], v[148:151]
    ds_read_b64_tr_b16 v[50:51], v247 offset:1024
    v_mfma_f32_16x16x32_bf16 v[152:155], v[24:27], v[72:75], v[152:155]
    v_mfma_f32_16x16x32_bf16 v[156:159], v[24:27], v[76:79], v[156:159]
    ds_read_b128 v[24:27], v242 offset:8192
    v_mfma_f32_16x16x32_bf16 v[160:163], v[28:31], v[64:67], v[160:163]
    v_mfma_f32_16x16x32_bf16 v[164:167], v[28:31], v[68:71], v[164:167]
    ds_read_b64_tr_b16 v[52:53], v248 offset:0
    v_mfma_f32_16x16x32_bf16 v[168:171], v[28:31], v[72:75], v[168:171]
    v_mfma_f32_16x16x32_bf16 v[172:175], v[28:31], v[76:79], v[172:175]
    ds_read_b128 v[28:31], v242 offset:9216
    v_mfma_f32_16x16x32_bf16 v[176:179], v[32:35], v[64:67], v[176:179]
    v_mfma_f32_16x16x32_bf16 v[180:183], v[32:35], v[68:71], v[180:183]
    ds_read_b64_tr_b16 v[54:55], v248 offset:1024
    v_mfma_f32_16x16x32_bf16 v[184:187], v[32:35], v[72:75], v[184:187]
    v_mfma_f32_16x16x32_bf16 v[188:191], v[32:35], v[76:79], v[188:191]
    ds_read_b128 v[32:35], v242 offset:12288
    v_mfma_f32_16x16x32_bf16 v[192:195], v[36:39], v[64:67], v[192:195]
    v_mfma_f32_16x16x32_bf16 v[196:199], v[36:39], v[68:71], v[196:199]
    ds_read_b64_tr_b16 v[56:57], v249 offset:0
    v_mfma_f32_16x16x32_bf16 v[200:203], v[36:39], v[72:75], v[200:203]
    v_mfma_f32_16x16x32_bf16 v[204:207], v[36:39], v[76:79], v[204:207]
    ds_read_b128 v[36:39], v242 offset:13312
    v_mfma_f32_16x16x32_bf16 v[208:211], v[40:43], v[64:67], v[208:211]
    v_mfma_f32_16x16x32_bf16 v[212:215], v[40:43], v[68:71], v[212:215]
    ds_read_b64_tr_b16 v[58:59], v249 offset:1024
    v_mfma_f32_16x16x32_bf16 v[216:219], v[40:43], v[72:75], v[216:219]
    v_mfma_f32_16x16x32_bf16 v[220:223], v[40:43], v[76:79], v[220:223]
    ds_read_b128 v[40:43], v242 offset:16384
    v_mfma_f32_16x16x32_bf16 v[224:227], v[44:47], v[64:67], v[224:227]
    ds_read_b64_tr_b16 v[60:61], v250 offset:0
    v_mfma_f32_16x16x32_bf16 v[228:231], v[44:47], v[68:71], v[228:231]
    ds_read_b64_tr_b16 v[62:63], v250 offset:1024
    v_mfma_f32_16x16x32_bf16 v[232:235], v[44:47], v[72:75], v[232:235]
    v_mfma_f32_16x16x32_bf16 v[236:239], v[44:47], v[76:79], v[236:239]
    ds_read_b128 v[44:47], v242 offset:17408
    s_waitcnt lgkmcnt(12)
    v_mfma_f32_16x16x32_bf16 v[80:83], v[8:11], v[48:51], v[80:83]
    v_xor_b32 v242, 64, v241
    s_waitcnt lgkmcnt(8)
    v_mfma_f32_16x16x32_bf16 v[84:87], v[8:11], v[52:55], v[84:87]
    ds_read_b64_tr_b16 v[64:65], v247 offset:8192
    s_waitcnt lgkmcnt(5)
    v_mfma_f32_16x16x32_bf16 v[88:91], v[8:11], v[56:59], v[88:91]
    s_waitcnt lgkmcnt(2)
    v_mfma_f32_16x16x32_bf16 v[92:95], v[8:11], v[60:63], v[92:95]
    ds_read_b128 v[8:11], v242 offset:0
    v_mfma_f32_16x16x32_bf16 v[96:99], v[12:15], v[48:51], v[96:99]
    v_mfma_f32_16x16x32_bf16 v[100:103], v[12:15], v[52:55], v[100:103]
    ds_read_b64_tr_b16 v[66:67], v247 offset:9216
    v_mfma_f32_16x16x32_bf16 v[104:107], v[12:15], v[56:59], v[104:107]
    v_mfma_f32_16x16x32_bf16 v[108:111], v[12:15], v[60:63], v[108:111]
    ds_read_b128 v[12:15], v242 offset:1024
    v_mfma_f32_16x16x32_bf16 v[112:115], v[16:19], v[48:51], v[112:115]
    v_mfma_f32_16x16x32_bf16 v[116:119], v[16:19], v[52:55], v[116:119]
    ds_read_b64_tr_b16 v[68:69], v248 offset:8192
    v_mfma_f32_16x16x32_bf16 v[120:123], v[16:19], v[56:59], v[120:123]
    v_mfma_f32_16x16x32_bf16 v[124:127], v[16:19], v[60:63], v[124:127]
    ds_read_b128 v[16:19], v242 offset:4096
    v_mfma_f32_16x16x32_bf16 v[128:131], v[20:23], v[48:51], v[128:131]
    v_mfma_f32_16x16x32_bf16 v[132:135], v[20:23], v[52:55], v[132:135]
    ds_read_b64_tr_b16 v[70:71], v248 offset:9216
    v_mfma_f32_16x16x32_bf16 v[136:139], v[20:23], v[56:59], v[136:139]
    v_mfma_f32_16x16x32_bf16 v[140:143], v[20:23], v[60:63], v[140:143]
    ds_read_b128 v[20:23], v242 offset:5120
    v_mfma_f32_16x16x32_bf16 v[144:147], v[24:27], v[48:51], v[144:147]
    v_mfma_f32_16x16x32_bf16 v[148:151], v[24:27], v[52:55], v[148:151]
    ds_read_b64_tr_b16 v[72:73], v249 offset:8192
    v_mfma_f32_16x16x32_bf16 v[152:155], v[24:27], v[56:59], v[152:155]
    v_mfma_f32_16x16x32_bf16 v[156:159], v[24:27], v[60:63], v[156:159]
    ds_read_b128 v[24:27], v242 offset:8192
    v_mfma_f32_16x16x32_bf16 v[160:163], v[28:31], v[48:51], v[160:163]
    v_mfma_f32_16x16x32_bf16 v[164:167], v[28:31], v[52:55], v[164:167]
    ds_read_b64_tr_b16 v[74:75], v249 offset:9216
    v_mfma_f32_16x16x32_bf16 v[168:171], v[28:31], v[56:59], v[168:171]
    v_mfma_f32_16x16x32_bf16 v[172:175], v[28:31], v[60:63], v[172:175]
    ds_read_b128 v[28:31], v242 offset:9216
    v_mfma_f32_16x16x32_bf16 v[176:179], v[32:35], v[48:51], v[176:179]
    v_mfma_f32_16x16x32_bf16 v[180:183], v[32:35], v[52:55], v[180:183]
    ds_read_b64_tr_b16 v[76:77], v250 offset:8192
    v_mfma_f32_16x16x32_bf16 v[184:187], v[32:35], v[56:59], v[184:187]
    v_mfma_f32_16x16x32_bf16 v[188:191], v[32:35], v[60:63], v[188:191]
    ds_read_b128 v[32:35], v242 offset:12288
    v_mfma_f32_16x16x32_bf16 v[192:195], v[36:39], v[48:51], v[192:195]
    v_mfma_f32_16x16x32_bf16 v[196:199], v[36:39], v[52:55], v[196:199]
    ds_read_b64_tr_b16 v[78:79], v250 offset:9216
    v_mfma_f32_16x16x32_bf16 v[200:203], v[36:39], v[56:59], v[200:203]
    v_mfma_f32_16x16x32_bf16 v[204:207], v[36:39], v[60:63], v[204:207]
    ds_read_b128 v[36:39], v242 offset:13312
    v_mfma_f32_16x16x32_bf16 v[208:211], v[40:43], v[48:51], v[208:211]
    v_mfma_f32_16x16x32_bf16 v[212:215], v[40:43], v[52:55], v[212:215]
    v_mfma_f32_16x16x32_bf16 v[216:219], v[40:43], v[56:59], v[216:219]
    v_mfma_f32_16x16x32_bf16 v[220:223], v[40:43], v[60:63], v[220:223]
    ds_read_b128 v[40:43], v242 offset:16384
    s_waitcnt lgkmcnt(15)
    v_mfma_f32_16x16x32_bf16 v[224:227], v[44:47], v[48:51], v[224:227]
    v_mfma_f32_16x16x32_bf16 v[228:231], v[44:47], v[52:55], v[228:231]
    v_mfma_f32_16x16x32_bf16 v[232:235], v[44:47], v[56:59], v[232:235]
    v_mfma_f32_16x16x32_bf16 v[236:239], v[44:47], v[60:63], v[236:239]
    ds_read_b128 v[44:47], v242 offset:17408
    s_waitcnt lgkmcnt(15)
    v_mfma_f32_16x16x32_bf16 v[80:83], v[8:11], v[64:67], v[80:83]
    s_add_u32 s36, s36, 53248
    s_cmp_eq_u32 s36, 159744
    s_waitcnt lgkmcnt(11)
    v_mfma_f32_16x16x32_bf16 v[84:87], v[8:11], v[68:71], v[84:87]
    s_cselect_b32 s36, 0, s36
    s_add_u32 s37, s37, 1
    s_waitcnt lgkmcnt(7)
    v_mfma_f32_16x16x32_bf16 v[88:91], v[8:11], v[72:75], v[88:91]
    v_add_u32 v241, s36, v240
    v_add_u32 v242, s36, v240
    s_waitcnt lgkmcnt(3)
    v_mfma_f32_16x16x32_bf16 v[92:95], v[8:11], v[76:79], v[92:95]
    v_add_u32 v247, s36, v243
    v_add_u32 v248, s36, v244
    v_mfma_f32_16x16x32_bf16 v[96:99], v[12:15], v[64:67], v[96:99]
    v_add_u32 v249, s36, v245
    v_add_u32 v250, s36, v246
    v_mfma_f32_16x16x32_bf16 v[100:103], v[12:15], v[68:71], v[100:103]
    s_cmp_eq_u32 s37, 10
    v_mfma_f32_16x16x32_bf16 v[104:107], v[12:15], v[72:75], v[104:107]
    v_mfma_f32_16x16x32_bf16 v[108:111], v[12:15], v[76:79], v[108:111]
    s_waitcnt lgkmcnt(0)
    s_barrier
    ds_read_b128 v[8:11], v242 offset:0
    v_mfma_f32_16x16x32_bf16 v[112:115], v[16:19], v[64:67], v[112:115]
    v_mfma_f32_16x16x32_bf16 v[116:119], v[16:19], v[68:71], v[116:119]
    ds_read_b128 v[12:15], v242 offset:1024
    v_mfma_f32_16x16x32_bf16 v[120:123], v[16:19], v[72:75], v[120:123]
    v_mfma_f32_16x16x32_bf16 v[124:127], v[16:19], v[76:79], v[124:127]
    ds_read_b128 v[16:19], v242 offset:4096
    v_mfma_f32_16x16x32_bf16 v[128:131], v[20:23], v[64:67], v[128:131]
    v_mfma_f32_16x16x32_bf16 v[132:135], v[20:23], v[68:71], v[132:135]
    ds_read_b64_tr_b16 v[48:49], v247 offset:0
    v_mfma_f32_16x16x32_bf16 v[136:139], v[20:23], v[72:75], v[136:139]
    v_mfma_f32_16x16x32_bf16 v[140:143], v[20:23], v[76:79], v[140:143]
    ds_read_b128 v[20:23], v242 offset:5120
    v_mfma_f32_16x16x32_bf16 v[144:147], v[24:27], v[64:67], v[144:147]
    v_mfma_f32_16x16x32_bf16 v[148:151], v[24:27], v[68:71], v[148:151]
    ds_read_b64_tr_b16 v[50:51], v247 offset:1024
    v_mfma_f32_16x16x32_bf16 v[152:155], v[24:27], v[72:75], v[152:155]
    v_mfma_f32_16x16x32_bf16 v[156:159], v[24:27], v[76:79], v[156:159]
    ds_read_b128 v[24:27], v242 offset:8192
    v_mfma_f32_16x16x32_bf16 v[160:163], v[28:31], v[64:67], v[160:163]
    v_mfma_f32_16x16x32_bf16 v[164:167], v[28:31], v[68:71], v[164:167]
    ds_read_b64_tr_b16 v[52:53], v248 offset:0
    v_mfma_f32_16x16x32_bf16 v[168:171], v[28:31], v[72:75], v[168:171]
    v_mfma_f32_16x16x32_bf16 v[172:175], v[28:31], v[76:79], v[172:175]
    ds_read_b128 v[28:31], v242 offset:9216
    v_mfma_f32_16x16x32_bf16 v[176:179], v[32:35], v[64:67], v[176:179]
    v_mfma_f32_16x16x32_bf16 v[180:183], v[32:35], v[68:71], v[180:183]
    ds_read_b64_tr_b16 v[54:55], v248 offset:1024
    v_mfma_f32_16x16x32_bf16 v[184:187], v[32:35], v[72:75], v[184:187]
    v_mfma_f32_16x16x32_bf16 v[188:191], v[32:35], v[76:79], v[188:191]
    ds_read_b128 v[32:35], v242 offset:12288
    v_mfma_f32_16x16x32_bf16 v[192:195], v[36:39], v[64:67], v[192:195]
    v_mfma_f32_16x16x32_bf16 v[196:199], v[36:39], v[68:71], v[196:199]
    ds_read_b64_tr_b16 v[56:57], v249 offset:0
    v_mfma_f32_16x16x32_bf16 v[200:203], v[36:39], v[72:75], v[200:203]
    v_mfma_f32_16x16x32_bf16 v[204:207], v[36:39], v[76:79], v[204:207]
    ds_read_b128 v[36:39], v242 offset:13312
    v_mfma_f32_16x16x32_bf16 v[208:211], v[40:43], v[64:67], v[208:211]
    v_mfma_f32_16x16x32_bf16 v[212:215], v[40:43], v[68:71], v[212:215]
    ds_read_b64_tr_b16 v[58:59], v249 offset:1024
    v_mfma_f32_16x16x32_bf16 v[216:219], v[40:43], v[72:75], v[216:219]
    v_mfma_f32_16x16x32_bf16 v[220:223], v[40:43], v[76:79], v[220:223]
    ds_read_b128 v[40:43], v242 offset:16384
    v_mfma_f32_16x16x32_bf16 v[224:227], v[44:47], v[64:67], v[224:227]
    ds_read_b64_tr_b16 v[60:61], v250 offset:0
    v_mfma_f32_16x16x32_bf16 v[228:231], v[44:47], v[68:71], v[228:231]
    ds_read_b64_tr_b16 v[62:63], v250 offset:1024
    v_mfma_f32_16x16x32_bf16 v[232:235], v[44:47], v[72:75], v[232:235]
    v_mfma_f32_16x16x32_bf16 v[236:239], v[44:47], v[76:79], v[236:239]
    ds_read_b128 v[44:47], v242 offset:17408
    s_waitcnt lgkmcnt(12)
    v_mfma_f32_16x16x32_bf16 v[80:83], v[8:11], v[48:51], v[80:83]
    v_xor_b32 v242, 64, v241
    s_waitcnt lgkmcnt(8)
    v_mfma_f32_16x16x32_bf16 v[84:87], v[8:11], v[52:55], v[84:87]
    ds_read_b64_tr_b16 v[64:65], v247 offset:8192
    s_waitcnt lgkmcnt(5)
    v_mfma_f32_16x16x32_bf16 v[88:91], v[8:11], v[56:59], v[88:91]
    s_waitcnt lgkmcnt(2)
    v_mfma_f32_16x16x32_bf16 v[92:95], v[8:11], v[60:63], v[92:95]
    ds_read_b128 v[8:11], v242 offset:0
    v_mfma_f32_16x16x32_bf16 v[96:99], v[12:15], v[48:51], v[96:99]
    v_mfma_f32_16x16x32_bf16 v[100:103], v[12:15], v[52:55], v[100:103]
    ds_read_b64_tr_b16 v[66:67], v247 offset:9216
    v_mfma_f32_16x16x32_bf16 v[104:107], v[12:15], v[56:59], v[104:107]
    v_mfma_f32_16x16x32_bf16 v[108:111], v[12:15], v[60:63], v[108:111]
    ds_read_b128 v[12:15], v242 offset:1024
    v_mfma_f32_16x16x32_bf16 v[112:115], v[16:19], v[48:51], v[112:115]
    v_mfma_f32_16x16x32_bf16 v[116:119], v[16:19], v[52:55], v[116:119]
    ds_read_b64_tr_b16 v[68:69], v248 offset:8192
    v_mfma_f32_16x16x32_bf16 v[120:123], v[16:19], v[56:59], v[120:123]
    v_mfma_f32_16x16x32_bf16 v[124:127], v[16:19], v[60:63], v[124:127]
    ds_read_b128 v[16:19], v242 offset:4096
    v_mfma_f32_16x16x32_bf16 v[128:131], v[20:23], v[48:51], v[128:131]
    v_mfma_f32_16x16x32_bf16 v[132:135], v[20:23], v[52:55], v[132:135]
    ds_read_b64_tr_b16 v[70:71], v248 offset:9216
    v_mfma_f32_16x16x32_bf16 v[136:139], v[20:23], v[56:59], v[136:139]
    v_mfma_f32_16x16x32_bf16 v[140:143], v[20:23], v[60:63], v[140:143]
    ds_read_b128 v[20:23], v242 offset:5120
    v_mfma_f32_16x16x32_bf16 v[144:147], v[24:27], v[48:51], v[144:147]
    v_mfma_f32_16x16x32_bf16 v[148:151], v[24:27], v[52:55], v[148:151]
    ds_read_b64_tr_b16 v[72:73], v249 offset:8192
    v_mfma_f32_16x16x32_bf16 v[152:155], v[24:27], v[56:59], v[152:155]
    v_mfma_f32_16x16x32_bf16 v[156:159], v[24:27], v[60:63], v[156:159]
    ds_read_b128 v[24:27], v242 offset:8192
    v_mfma_f32_16x16x32_bf16 v[160:163], v[28:31], v[48:51], v[160:163]
    v_mfma_f32_16x16x32_bf16 v[164:167], v[28:31], v[52:55], v[164:167]
    ds_read_b64_tr_b16 v[74:75], v249 offset:9216
    v_mfma_f32_16x16x32_bf16 v[168:171], v[28:31], v[56:59], v[168:171]
    v_mfma_f32_16x16x32_bf16 v[172:175], v[28:31], v[60:63], v[172:175]
    ds_read_b128 v[28:31], v242 offset:9216
    v_mfma_f32_16x16x32_bf16 v[176:179], v[32:35], v[48:51], v[176:179]
    v_mfma_f32_16x16x32_bf16 v[180:183], v[32:35], v[52:55], v[180:183]
    ds_read_b64_tr_b16 v[76:77], v250 offset:8192
    v_mfma_f32_16x16x32_bf16 v[184:187], v[32:35], v[56:59], v[184:187]
    v_mfma_f32_16x16x32_bf16 v[188:191], v[32:35], v[60:63], v[188:191]
    ds_read_b128 v[32:35], v242 offset:12288
    v_mfma_f32_16x16x32_bf16 v[192:195], v[36:39], v[48:51], v[192:195]
    v_mfma_f32_16x16x32_bf16 v[196:199], v[36:39], v[52:55], v[196:199]
    ds_read_b64_tr_b16 v[78:79], v250 offset:9216
    v_mfma_f32_16x16x32_bf16 v[200:203], v[36:39], v[56:59], v[200:203]
    v_mfma_f32_16x16x32_bf16 v[204:207], v[36:39], v[60:63], v[204:207]
    ds_read_b128 v[36:39], v242 offset:13312
    v_mfma_f32_16x16x32_bf16 v[208:211], v[40:43], v[48:51], v[208:211]
    v_mfma_f32_16x16x32_bf16 v[212:215], v[40:43], v[52:55], v[212:215]
    v_mfma_f32_16x16x32_bf16 v[216:219], v[40:43], v[56:59], v[216:219]
    v_mfma_f32_16x16x32_bf16 v[220:223], v[40:43], v[60:63], v[220:223]
    ds_read_b128 v[40:43], v242 offset:16384
    s_waitcnt lgkmcnt(15)
    v_mfma_f32_16x16x32_bf16 v[224:227], v[44:47], v[48:51], v[224:227]
    v_mfma_f32_16x16x32_bf16 v[228:231], v[44:47], v[52:55], v[228:231]
    v_mfma_f32_16x16x32_bf16 v[232:235], v[44:47], v[56:59], v[232:235]
    v_mfma_f32_16x16x32_bf16 v[236:239], v[44:47], v[60:63], v[236:239]
    ds_read_b128 v[44:47], v242 offset:17408
    s_waitcnt lgkmcnt(15)
    v_mfma_f32_16x16x32_bf16 v[80:83], v[8:11], v[64:67], v[80:83]
    s_add_u32 s36, s36, 53248
    s_cmp_eq_u32 s36, 159744
    s_waitcnt lgkmcnt(11)
    v_mfma_f32_16x16x32_bf16 v[84:87], v[8:11], v[68:71], v[84:87]
    s_cselect_b32 s36, 0, s36
    s_add_u32 s37, s37, 1
    s_waitcnt lgkmcnt(7)
    v_mfma_f32_16x16x32_bf16 v[88:91], v[8:11], v[72:75], v[88:91]
    v_add_u32 v241, s36, v240
    v_add_u32 v242, s36, v240
    s_waitcnt lgkmcnt(3)
    v_mfma_f32_16x16x32_bf16 v[92:95], v[8:11], v[76:79], v[92:95]
    v_add_u32 v247, s36, v243
    v_add_u32 v248, s36, v244
    v_mfma_f32_16x16x32_bf16 v[96:99], v[12:15], v[64:67], v[96:99]
    v_add_u32 v249, s36, v245
    v_add_u32 v250, s36, v246
    v_mfma_f32_16x16x32_bf16 v[100:103], v[12:15], v[68:71], v[100:103]
    s_cmp_eq_u32 s37, 10
    v_mfma_f32_16x16x32_bf16 v[104:107], v[12:15], v[72:75], v[104:107]
    v_mfma_f32_16x16x32_bf16 v[108:111], v[12:15], v[76:79], v[108:111]
    s_waitcnt lgkmcnt(0)
    s_cbranch_scc1 Lk1nb_4
    s_barrier
Lk1nb_4:
    ds_read_b128 v[8:11], v242 offset:0
    v_mfma_f32_16x16x32_bf16 v[112:115], v[16:19], v[64:67], v[112:115]
    v_mfma_f32_16x16x32_bf16 v[116:119], v[16:19], v[68:71], v[116:119]
    ds_read_b128 v[12:15], v242 offset:1024
    v_mfma_f32_16x16x32_bf16 v[120:123], v[16:19], v[72:75], v[120:123]
    v_mfma_f32_16x16x32_bf16 v[124:127], v[16:19], v[76:79], v[124:127]
    ds_read_b128 v[16:19], v242 offset:4096
    v_mfma_f32_16x16x32_bf16 v[128:131], v[20:23], v[64:67], v[128:131]
    v_mfma_f32_16x16x32_bf16 v[132:135], v[20:23], v[68:71], v[132:135]
    ds_read_b64_tr_b16 v[48:49], v247 offset:0
    v_mfma_f32_16x16x32_bf16 v[136:139], v[20:23], v[72:75], v[136:139]
    v_mfma_f32_16x16x32_bf16 v[140:143], v[20:23], v[76:79], v[140:143]
    ds_read_b128 v[20:23], v242 offset:5120
    v_mfma_f32_16x16x32_bf16 v[144:147], v[24:27], v[64:67], v[144:147]
    v_mfma_f32_16x16x32_bf16 v[148:151], v[24:27], v[68:71], v[148:151]
    ds_read_b64_tr_b16 v[50:51], v247 offset:1024
    v_mfma_f32_16x16x32_bf16 v[152:155], v[24:27], v[72:75], v[152:155]
    v_mfma_f32_16x16x32_bf16 v[156:159], v[24:27], v[76:79], v[156:159]
    ds_read_b128 v[24:27], v242 offset:8192
    v_mfma_f32_16x16x32_bf16 v[160:163], v[28:31], v[64:67], v[160:163]
    v_mfma_f32_16x16x32_bf16 v[164:167], v[28:31], v[68:71], v[164:167]
    ds_read_b64_tr_b16 v[52:53], v248 offset:0
    v_mfma_f32_16x16x32_bf16 v[168:171], v[28:31], v[72:75], v[168:171]
    v_mfma_f32_16x16x32_bf16 v[172:175], v[28:31], v[76:79], v[172:175]
    ds_read_b128 v[28:31], v242 offset:9216
    v_mfma_f32_16x16x32_bf16 v[176:179], v[32:35], v[64:67], v[176:179]
    v_mfma_f32_16x16x32_bf16 v[180:183], v[32:35], v[68:71], v[180:183]
    ds_read_b64_tr_b16 v[54:55], v248 offset:1024
    v_mfma_f32_16x16x32_bf16 v[184:187], v[32:35], v[72:75], v[184:187]
    v_mfma_f32_16x16x32_bf16 v[188:191], v[32:35], v[76:79], v[188:191]
    ds_read_b128 v[32:35], v242 offset:12288
    v_mfma_f32_16x16x32_bf16 v[192:195], v[36:39], v[64:67], v[192:195]
    v_mfma_f32_16x16x32_bf16 v[196:199], v[36:39], v[68:71], v[196:199]
    ds_read_b64_tr_b16 v[56:57], v249 offset:0
    v_mfma_f32_16x16x32_bf16 v[200:203], v[36:39], v[72:75], v[200:203]
    v_mfma_f32_16x16x32_bf16 v[204:207], v[36:39], v[76:79], v[204:207]
    ds_read_b128 v[36:39], v242 offset:13312
    v_mfma_f32_16x16x32_bf16 v[208:211], v[40:43], v[64:67], v[208:211]
    v_mfma_f32_16x16x32_bf16 v[212:215], v[40:43], v[68:71], v[212:215]
    ds_read_b64_tr_b16 v[58:59], v249 offset:1024
    v_mfma_f32_16x16x32_bf16 v[216:219], v[40:43], v[72:75], v[216:219]
    v_mfma_f32_16x16x32_bf16 v[220:223], v[40:43], v[76:79], v[220:223]
    ds_read_b128 v[40:43], v242 offset:16384
    v_mfma_f32_16x16x32_bf16 v[224:227], v[44:47], v[64:67], v[224:227]
    ds_read_b64_tr_b16 v[60:61], v250 offset:0
    v_mfma_f32_16x16x32_bf16 v[228:231], v[44:47], v[68:71], v[228:231]
    ds_read_b64_tr_b16 v[62:63], v250 offset:1024
    v_mfma_f32_16x16x32_bf16 v[232:235], v[44:47], v[72:75], v[232:235]
    v_mfma_f32_16x16x32_bf16 v[236:239], v[44:47], v[76:79], v[236:239]
    ds_read_b128 v[44:47], v242 offset:17408
    s_cmp_lg_u32 s37, 10
    s_cbranch_scc1 Lk1loop_3
    s_waitcnt lgkmcnt(0)
    s_nop 7
    s_mul_i32 s49, s46, 2560
    v_cvt_pk_bf16_f32 v80, v80, v81
    v_cvt_pk_bf16_f32 v81, v82, v83
    v_cvt_pk_bf16_f32 v82, v96, v97
    v_cvt_pk_bf16_f32 v83, v98, v99
    buffer_store_dwordx4 v[80:83], v251, s[20:23], s49 offen sc1
    v_cvt_pk_bf16_f32 v84, v84, v85
    v_cvt_pk_bf16_f32 v85, v86, v87
    v_cvt_pk_bf16_f32 v86, v100, v101
    v_cvt_pk_bf16_f32 v87, v102, v103
    buffer_store_dwordx4 v[84:87], v252, s[20:23], s49 offen sc1
    v_cvt_pk_bf16_f32 v88, v88, v89
    v_cvt_pk_bf16_f32 v89, v90, v91
    v_cvt_pk_bf16_f32 v90, v104, v105
    v_cvt_pk_bf16_f32 v91, v106, v107
    buffer_store_dwordx4 v[88:91], v253, s[20:23], s49 offen sc1
    v_cvt_pk_bf16_f32 v92, v92, v93
    v_cvt_pk_bf16_f32 v93, v94, v95
    v_cvt_pk_bf16_f32 v94, v108, v109
    v_cvt_pk_bf16_f32 v95, v110, v111
    buffer_store_dwordx4 v[92:95], v254, s[20:23], s49 offen sc1
    s_add_u32 s49, s49, 2560
    v_cvt_pk_bf16_f32 v112, v112, v113
    v_cvt_pk_bf16_f32 v113, v114, v115
    v_cvt_pk_bf16_f32 v114, v128, v129
    v_cvt_pk_bf16_f32 v115, v130, v131
    buffer_store_dwordx4 v[112:115], v251, s[20:23], s49 offen sc1
    v_cvt_pk_bf16_f32 v116, v116, v117
    v_cvt_pk_bf16_f32 v117, v118, v119
    v_cvt_pk_bf16_f32 v118, v132, v133
    v_cvt_pk_bf16_f32 v119, v134, v135
    buffer_store_dwordx4 v[116:119], v252, s[20:23], s49 offen sc1
    v_cvt_pk_bf16_f32 v120, v120, v121
    v_cvt_pk_bf16_f32 v121, v122, v123
    v_cvt_pk_bf16_f32 v122, v136, v137
    v_cvt_pk_bf16_f32 v123, v138, v139
    buffer_store_dwordx4 v[120:123], v253, s[20:23], s49 offen sc1
    v_cvt_pk_bf16_f32 v124, v124, v125
    v_cvt_pk_bf16_f32 v125, v126, v127
    v_cvt_pk_bf16_f32 v126, v140, v141
    v_cvt_pk_bf16_f32 v127, v142, v143
    buffer_store_dwordx4 v[124:127], v254, s[20:23], s49 offen sc1
    s_add_u32 s49, s49, 2560
    v_cvt_pk_bf16_f32 v144, v144, v145
    v_cvt_pk_bf16_f32 v145, v146, v147
    v_cvt_pk_bf16_f32 v146, v160, v161
    v_cvt_pk_bf16_f32 v147, v162, v163
    buffer_store_dwordx4 v[144:147], v251, s[20:23], s49 offen sc1
    v_cvt_pk_bf16_f32 v148, v148, v149
    v_cvt_pk_bf16_f32 v149, v150, v151
    v_cvt_pk_bf16_f32 v150, v164, v165
    v_cvt_pk_bf16_f32 v151, v166, v167
    buffer_store_dwordx4 v[148:151], v252, s[20:23], s49 offen sc1
    v_cvt_pk_bf16_f32 v152, v152, v153
    v_cvt_pk_bf16_f32 v153, v154, v155
    v_cvt_pk_bf16_f32 v154, v168, v169
    v_cvt_pk_bf16_f32 v155, v170, v171
    buffer_store_dwordx4 v[152:155], v253, s[20:23], s49 offen sc1
    v_cvt_pk_bf16_f32 v156, v156, v157
    v_cvt_pk_bf16_f32 v157, v158, v159
    v_cvt_pk_bf16_f32 v158, v172, v173
    v_cvt_pk_bf16_f32 v159, v174, v175
    buffer_store_dwordx4 v[156:159], v254, s[20:23], s49 offen sc1
    s_add_u32 s49, s49, 2560
    v_cvt_pk_bf16_f32 v176, v176, v177
    v_cvt_pk_bf16_f32 v177, v178, v179
    v_cvt_pk_bf16_f32 v178, v192, v193
    v_cvt_pk_bf16_f32 v179, v194, v195
    buffer_store_dwordx4 v[176:179], v251, s[20:23], s49 offen sc1
    v_cvt_pk_bf16_f32 v180, v180, v181
    v_cvt_pk_bf16_f32 v181, v182, v183
    v_cvt_pk_bf16_f32 v182, v196, v197
    v_cvt_pk_bf16_f32 v183, v198, v199
    buffer_store_dwordx4 v[180:183], v252, s[20:23], s49 offen sc1
    v_cvt_pk_bf16_f32 v184, v184, v185
    v_cvt_pk_bf16_f32 v185, v186, v187
    v_cvt_pk_bf16_f32 v186, v200, v201
    v_cvt_pk_bf16_f32 v187, v202, v203
    buffer_store_dwordx4 v[184:187], v253, s[20:23], s49 offen sc1
    v_cvt_pk_bf16_f32 v188, v188, v189
    v_cvt_pk_bf16_f32 v189, v190, v191
    v_cvt_pk_bf16_f32 v190, v204, v205
    v_cvt_pk_bf16_f32 v191, v206, v207
    buffer_store_dwordx4 v[188:191], v254, s[20:23], s49 offen sc1
    s_add_u32 s49, s49, 2560
    s_cmp_eq_u32 s47, 4
    s_cbranch_scc1 gated_mix__softmax_full_mha__glu_gated_geglu__prompt_kernel_v_done
    v_cvt_pk_bf16_f32 v208, v208, v209
    v_cvt_pk_bf16_f32 v209, v210, v211
    v_cvt_pk_bf16_f32 v210, v224, v225
    v_cvt_pk_bf16_f32 v211, v226, v227
    buffer_store_dwordx4 v[208:211], v251, s[20:23], s49 offen sc1
    v_cvt_pk_bf16_f32 v212, v212, v213
    v_cvt_pk_bf16_f32 v213, v214, v215
    v_cvt_pk_bf16_f32 v214, v228, v229
    v_cvt_pk_bf16_f32 v215, v230, v231
    buffer_store_dwordx4 v[212:215], v252, s[20:23], s49 offen sc1
    v_cvt_pk_bf16_f32 v216, v216, v217
    v_cvt_pk_bf16_f32 v217, v218, v219
    v_cvt_pk_bf16_f32 v218, v232, v233
    v_cvt_pk_bf16_f32 v219, v234, v235
    buffer_store_dwordx4 v[216:219], v253, s[20:23], s49 offen sc1
    v_cvt_pk_bf16_f32 v220, v220, v221
    v_cvt_pk_bf16_f32 v221, v222, v223
    v_cvt_pk_bf16_f32 v222, v236, v237
    v_cvt_pk_bf16_f32 v223, v238, v239
    buffer_store_dwordx4 v[220:223], v254, s[20:23], s49 offen sc1
gated_mix__softmax_full_mha__glu_gated_geglu__prompt_kernel_v_done:
    s_branch gated_mix__softmax_full_mha__glu_gated_geglu__prompt_kernel_join
.p2align 12
.fill 500, 4, 0xbf800000
gated_mix__softmax_full_mha__glu_gated_geglu__prompt_kernel_join:
    s_mov_b64 exec, -1
    s_setprio 0
    s_mov_b32 s3, s55
    s_mov_b32 s74, s19
    s_load_dwordx2 s[6:7], s[0:1], 72
    s_load_dwordx2 s[4:5], s[0:1], 64
    v_mbcnt_lo_u32_b32 v0, -1, 0
    v_mbcnt_hi_u32_b32 v0, -1, v0
    s_and_b32 s40, s2, 7
    s_lshr_b32 s41, s2, 3
    s_lshl_b32 s18, s40, 2
    s_lshr_b32 s42, s41, 3
    s_add_u32 s18, s18, s42
    s_mul_i32 s43, s18, 163840
    v_lshlrev_b32 v3, 4, v0
    s_lshl_b32 s45, s3, 10
    s_add_u32 s46, s43, s45
    s_add_u32 s46, s46, 5242880
    s_mov_b32 m0, s45
    s_and_b32 s19, s41, 7
    s_lshl_b32 s19, s19, 3
    s_add_u32 s19, s19, s3
    v_and_b32 v1, 31, v0
    v_lshrrev_b32 v2, 5, v0
    v_bfe_u32 v85, v1, 2, 2
    v_xor_b32 v85, v85, v2
    v_lshlrev_b32 v85, 4, v85
    v_lshl_add_u32 v80, v1, 6, v85
    v_add_u32 v80, 1280, v80
    v_xor_b32 v84, 32, v80
    v_and_b32 v81, 7, v1
    v_lshlrev_b32 v81, 4, v81
    v_and_b32 v85, 8, v1
    v_add_u32 v81, v85, v81
    v_and_b32 v85, 16, v1
    v_lshl_add_u32 v81, v85, 3, v81
    v_lshl_add_u32 v83, v2, 8, v81
    v_add_u32 v81, 1024, v81
    s_mul_i32 s44, s19, 2560
    s_add_u32 s44, s44, s43
    s_lshl_b32 s47, s19, 7
    s_add_u32 s47, s47, 22183936
    v_lshlrev_b32 v82, 2, v1
    v_mov_b32 v37, 0
    s_waitcnt lgkmcnt(0)
    s_cmp_lg_u32 s3, 4
    s_cbranch_scc1 Ljoin_13s
    global_load_dword v36, v37, s[6:7] sc1
Ljoin_13s:
    s_mov_b32 s20, s16
    s_and_b32 s21, s17, 0xffff
    s_mov_b32 s22, 22261760
    s_mov_b32 s23, 0x20000
    s_mov_b32 s24, s4
    s_and_b32 s25, s5, 0xffff
    s_mov_b32 s26, 2621440
    s_mov_b32 s27, 0x20000
    s_lshl_b32 s60, s40, 2
    s_lshr_b32 s42, s41, 3
    s_add_u32 s60, s60, s42
    s_and_b32 s61, s41, 7
    s_mov_b32 s42, s61
    s_add_u32 s75, s3, s42
    s_and_b32 s75, s75, 7
    s_mul_i32 s48, s75, 6144
    s_add_u32 s48, s48, 20480
    s_mul_i32 s71, s60, 278528
    s_add_u32 s71, s71, 10485760
    s_add_u32 s62, s71, s48
    s_mul_i32 s72, s61, 348160
    s_add_u32 s72, s72, 19398656
    s_add_u32 s66, s72, s48
    s_mul_i32 s76, s3, 13312
    s_add_u32 s63, s62, 69632
    s_add_u32 s64, s63, 69632
    s_add_u32 s65, s64, 69632
    s_add_u32 s67, s66, 69632
    s_add_u32 s68, s67, 69632
    s_add_u32 s69, s68, 69632
    s_add_u32 s70, s69, 69632
    s_mov_b32 s30, 0x000fffff
    s_mov_b32 s31, 0x000fffff
    v_cmp_eq_u32 vcc, 20, v1
    v_mov_b32 v85, 0x3f803f80
    v_mov_b32 v86, 0
    v_cndmask_b32 v16, v86, v85, vcc
    v_mov_b32 v8, 0
    v_mov_b32 v9, 0
    v_mov_b32 v17, v16
    v_mov_b32 v18, v16
    v_mov_b32 v19, v16
    v_mov_b32 v20, v16
    v_mov_b32 v21, v16
    v_mov_b32 v22, v16
    v_mov_b32 v23, v16
    v_mov_b32 v64, 0
    v_mov_b32 v65, 0
    v_mov_b32 v66, 0
    v_mov_b32 v67, 0
    v_mov_b32 v68, 0
    v_mov_b32 v69, 0
    v_mov_b32 v70, 0
    v_mov_b32 v71, 0
    v_mov_b32 v72, 0
    v_mov_b32 v73, 0
    v_mov_b32 v74, 0
    v_mov_b32 v75, 0
    v_mov_b32 v76, 0
    v_mov_b32 v77, 0
    v_mov_b32 v78, 0
    v_mov_b32 v79, 0
    v_mov_b32 v24, 0
    v_mov_b32 v25, 0
    v_mov_b32 v26, 0
    v_mov_b32 v27, 0
    v_mov_b32 v28, 0
    v_mov_b32 v29, 0
    v_mov_b32 v30, 0
    v_mov_b32 v31, 0
    s_waitcnt vmcnt(0)
    s_barrier
    s_cmp_lg_u32 s3, 4
    s_cbranch_scc1 Ljoin_13d
    s_mov_b32 s49, 0
Ljoin_13t:
    v_readfirstlane_b32 s77, v36
    s_add_u32 s49, s49, 1
    s_cmp_ge_u32 s49, 0x40000
    s_cbranch_scc1 Ljoin_13u
    s_cmp_lg_u32 s77, 0
    s_cbranch_scc1 Ljoin_13u
    global_load_dword v36, v37, s[6:7] sc1
    s_waitcnt vmcnt(0)
    s_branch Ljoin_13t
Ljoin_13u:
    v_mov_b32 v34, s77
    s_lshl_b32 s48, s2, 2
    s_add_u32 s48, s48, 22257664
    s_mov_b32 s50, 22224896
    v_lshlrev_b32 v33, 11, v0
    s_mov_b64 exec, 1
    s_cmp_lt_u32 s74, 12
    s_cbranch_scc1 Ljoin_13n
    v_mov_b32 v35, 1
    global_atomic_add v35, v37, v35, s[6:7] offset:128 sc0 sc1
    s_waitcnt vmcnt(0)
    v_readfirstlane_b32 s49, v35
    s_cmp_lg_u32 s49, 98
    s_cbranch_scc1 Ljoin_13n
    s_mov_b64 exec, 0xffff
    buffer_store_dword v34, v33, s[20:23], s50 offen sc1
    s_mov_b64 exec, 1
    global_store_dword v37, v37, s[6:7] offset:128 sc1
Ljoin_13n:
    buffer_store_dword v34, v37, s[20:23], s48 offen sc1
    s_and_b32 s48, s2, 15
    s_lshl_b32 s48, s48, 11
    s_add_u32 s48, s48, 22224896
    s_mov_b32 s49, 0
Ljoin_13:
    buffer_load_dword v33, v37, s[20:23], s48 offen sc1
    s_add_u32 s49, s49, 1
    s_waitcnt vmcnt(0)
    v_cmp_ne_u32 vcc, s77, v33
    s_cmp_ge_u32 s49, 0x40000
    s_cbranch_scc1 Ljoin_13x
    s_cbranch_vccnz Ljoin_13
Ljoin_13x:
    s_mov_b64 exec, -1
Ljoin_13d:
    s_barrier
    buffer_load_dwordx4 v3, s[20:23], s46 offen sc1 lds
    buffer_load_dwordx2 v[4:5], v83, s[20:23], s44 offen sc1
    buffer_load_dwordx2 v[6:7], v83, s[20:23], s44 offen offset:512 sc1
    s_mov_b32 exec_hi, 0
    buffer_load_dwordx2 v[8:9], v81, s[20:23], s44 offen sc1
    s_mov_b32 exec_hi, -1
    s_add_u32 m0, m0, 8192
    s_add_u32 s46, s46, 8192
    buffer_load_dwordx4 v3, s[20:23], s46 offen sc1 lds
    s_add_u32 m0, m0, 8192
    s_add_u32 s46, s46, 8192
    buffer_load_dwordx4 v3, s[20:23], s46 offen sc1 lds
    s_add_u32 m0, m0, 8192
    s_add_u32 s46, s46, 8192
    buffer_load_dwordx4 v3, s[20:23], s46 offen sc1 lds
    v_lshl_add_u32 v81, v2, 18, v81
    s_waitcnt vmcnt(2)
    s_barrier
    ds_read2st64_b64 v[10:13], v83 offset0:0 offset1:1
    ds_read_b64 v[14:15], v81
    s_waitcnt lgkmcnt(0)
    v_mfma_f32_32x32x16_bf16 v[32:47], v[10:13], v[4:7], 0
    v_mfma_f32_32x32x8bf16_1k v[32:47], v[14:15], v[8:9], v[32:47]
    ds_read2st64_b64 v[10:13], v83 offset0:5 offset1:6
    ds_read_b64 v[14:15], v81 offset:2560
    s_mov_b64 exec, s[30:31]
    ds_read_b128 v[16:19], v80
    ds_read_b128 v[20:23], v84
    s_mov_b64 exec, -1
    s_nop 7
    s_nop 3
    s_setprio 3
Ltile0:
    s_waitcnt lgkmcnt(3)
    v_mfma_f32_32x32x16_bf16 v[48:63], v[10:13], v[4:7], 0
    ds_read2st64_b64 v[10:13], v83 offset0:10 offset1:11
    v_exp_f32 v32, v32
    v_exp_f32 v33, v33
    v_exp_f32 v34, v34
    v_exp_f32 v35, v35
    v_exp_f32 v36, v36
    s_waitcnt lgkmcnt(1)
    v_mfma_f32_32x32x16_bf16 v[64:79], v[16:19], v[24:27], v[64:79]
    s_add_u32 m0, m0, 8192
    s_add_u32 s46, s46, 8192
    buffer_load_dwordx4 v3, s[20:23], s46 offen sc1 lds
    v_exp_f32 v37, v37
    v_exp_f32 v38, v38
    v_exp_f32 v39, v39
    v_cvt_pk_bf16_f32 v24, v32, v33
    v_cvt_pk_bf16_f32 v25, v34, v35
    v_cvt_pk_bf16_f32 v26, v36, v37
    v_cvt_pk_bf16_f32 v27, v38, v39
    v_mfma_f32_32x32x8bf16_1k v[48:63], v[14:15], v[8:9], v[48:63]
    ds_read_b64 v[14:15], v81 offset:5120
    v_exp_f32 v40, v40
    v_exp_f32 v41, v41
    v_exp_f32 v42, v42
    v_exp_f32 v43, v43
    v_exp_f32 v44, v44
    v_mfma_f32_32x32x16_bf16 v[64:79], v[20:23], v[28:31], v[64:79]
    s_mov_b64 exec, s[30:31]
    ds_read_b128 v[16:19], v80 offset:0
    ds_read_b128 v[20:23], v84 offset:0
    s_mov_b64 exec, -1
    s_add_u32 m0, m0, 8192
    s_add_u32 s46, s46, 8192
    buffer_load_dwordx4 v3, s[20:23], s46 offen sc1 lds
    v_exp_f32 v45, v45
    v_exp_f32 v46, v46
    v_exp_f32 v47, v47
    v_cvt_pk_bf16_f32 v28, v40, v41
    v_cvt_pk_bf16_f32 v29, v42, v43
    v_cvt_pk_bf16_f32 v30, v44, v45
    v_cvt_pk_bf16_f32 v31, v46, v47
Ltile1:
    s_waitcnt lgkmcnt(3)
    v_mfma_f32_32x32x16_bf16 v[32:47], v[10:13], v[4:7], 0
    ds_read2st64_b64 v[10:13], v83 offset0:15 offset1:16
    v_exp_f32 v48, v48
    v_exp_f32 v49, v49
    v_exp_f32 v50, v50
    v_exp_f32 v51, v51
    v_exp_f32 v52, v52
    s_waitcnt lgkmcnt(1)
    v_mfma_f32_32x32x16_bf16 v[64:79], v[16:19], v[24:27], v[64:79]
    s_add_u32 m0, m0, 8192
    s_add_u32 s46, s46, 8192
    buffer_load_dwordx4 v3, s[20:23], s46 offen sc1 lds
    v_exp_f32 v53, v53
    v_exp_f32 v54, v54
    v_exp_f32 v55, v55
    v_cvt_pk_bf16_f32 v24, v48, v49
    v_cvt_pk_bf16_f32 v25, v50, v51
    v_cvt_pk_bf16_f32 v26, v52, v53
    v_cvt_pk_bf16_f32 v27, v54, v55
    v_mfma_f32_32x32x8bf16_1k v[32:47], v[14:15], v[8:9], v[32:47]
    ds_read_b64 v[14:15], v81 offset:7680
    v_exp_f32 v56, v56
    v_exp_f32 v57, v57
    v_exp_f32 v58, v58
    v_exp_f32 v59, v59
    v_exp_f32 v60, v60
    v_mfma_f32_32x32x16_bf16 v[64:79], v[20:23], v[28:31], v[64:79]
    s_mov_b64 exec, s[30:31]
    ds_read_b128 v[16:19], v80 offset:2560
    ds_read_b128 v[20:23], v84 offset:2560
    s_mov_b64 exec, -1
    s_add_u32 m0, m0, 8192
    s_add_u32 s46, s46, 8192
    buffer_load_dwordx4 v3, s[20:23], s46 offen sc1 lds
    v_exp_f32 v61, v61
    v_exp_f32 v62, v62
    v_exp_f32 v63, v63
    v_cvt_pk_bf16_f32 v28, v56, v57
    v_cvt_pk_bf16_f32 v29, v58, v59
    v_cvt_pk_bf16_f32 v30, v60, v61
    v_cvt_pk_bf16_f32 v31, v62, v63
    s_setprio 2
Ltile2:
    s_waitcnt lgkmcnt(3)
    v_mfma_f32_32x32x16_bf16 v[48:63], v[10:13], v[4:7], 0
    ds_read2st64_b64 v[10:13], v83 offset0:20 offset1:21
    v_exp_f32 v32, v32
    v_exp_f32 v33, v33
    v_exp_f32 v34, v34
    v_exp_f32 v35, v35
    v_exp_f32 v36, v36
    s_waitcnt lgkmcnt(1)
    v_mfma_f32_32x32x16_bf16 v[64:79], v[16:19], v[24:27], v[64:79]
    s_add_u32 m0, m0, 8192
    s_add_u32 s46, s46, 8192
    buffer_load_dwordx4 v3, s[20:23], s46 offen sc1 lds
    v_exp_f32 v37, v37
    v_exp_f32 v38, v38
    v_exp_f32 v39, v39
    v_cvt_pk_bf16_f32 v24, v32, v33
    v_cvt_pk_bf16_f32 v25, v34, v35
    v_cvt_pk_bf16_f32 v26, v36, v37
    v_cvt_pk_bf16_f32 v27, v38, v39
    v_mfma_f32_32x32x8bf16_1k v[48:63], v[14:15], v[8:9], v[48:63]
    ds_read_b64 v[14:15], v81 offset:10240
    v_exp_f32 v40, v40
    v_exp_f32 v41, v41
    v_exp_f32 v42, v42
    v_exp_f32 v43, v43
    v_exp_f32 v44, v44
    v_mfma_f32_32x32x16_bf16 v[64:79], v[20:23], v[28:31], v[64:79]
    s_mov_b64 exec, s[30:31]
    ds_read_b128 v[16:19], v80 offset:5120
    ds_read_b128 v[20:23], v84 offset:5120
    s_mov_b64 exec, -1
    s_add_u32 m0, m0, 8192
    s_add_u32 s46, s46, 8192
    buffer_load_dwordx4 v3, s[20:23], s46 offen sc1 lds
    v_exp_f32 v45, v45
    v_exp_f32 v46, v46
    v_exp_f32 v47, v47
    v_cvt_pk_bf16_f32 v28, v40, v41
    v_cvt_pk_bf16_f32 v29, v42, v43
    v_cvt_pk_bf16_f32 v30, v44, v45
    v_cvt_pk_bf16_f32 v31, v46, v47
    s_setprio 1
Ltile3:
    s_waitcnt lgkmcnt(3)
    v_mfma_f32_32x32x16_bf16 v[32:47], v[10:13], v[4:7], 0
    ds_read2st64_b64 v[10:13], v83 offset0:25 offset1:26
    v_exp_f32 v48, v48
    v_exp_f32 v49, v49
    v_exp_f32 v50, v50
    v_exp_f32 v51, v51
    v_exp_f32 v52, v52
    s_waitcnt lgkmcnt(1)
    v_mfma_f32_32x32x16_bf16 v[64:79], v[16:19], v[24:27], v[64:79]
    s_add_u32 m0, m0, 8192
    s_add_u32 s46, s46, 8192
    buffer_load_dwordx4 v3, s[20:23], s46 offen sc1 lds
    v_exp_f32 v53, v53
    v_exp_f32 v54, v54
    v_exp_f32 v55, v55
    v_cvt_pk_bf16_f32 v24, v48, v49
    v_cvt_pk_bf16_f32 v25, v50, v51
    v_cvt_pk_bf16_f32 v26, v52, v53
    v_cvt_pk_bf16_f32 v27, v54, v55
    v_mfma_f32_32x32x8bf16_1k v[32:47], v[14:15], v[8:9], v[32:47]
    ds_read_b64 v[14:15], v81 offset:12800
    v_exp_f32 v56, v56
    v_exp_f32 v57, v57
    v_exp_f32 v58, v58
    v_exp_f32 v59, v59
    v_exp_f32 v60, v60
    v_mfma_f32_32x32x16_bf16 v[64:79], v[20:23], v[28:31], v[64:79]
    s_mov_b64 exec, s[30:31]
    ds_read_b128 v[16:19], v80 offset:7680
    ds_read_b128 v[20:23], v84 offset:7680
    s_mov_b64 exec, -1
    s_add_u32 m0, m0, 8192
    s_add_u32 s46, s46, 8192
    buffer_load_dwordx4 v3, s[20:23], s46 offen sc1 lds
    v_exp_f32 v61, v61
    v_exp_f32 v62, v62
    v_exp_f32 v63, v63
    v_cvt_pk_bf16_f32 v28, v56, v57
    v_cvt_pk_bf16_f32 v29, v58, v59
    v_cvt_pk_bf16_f32 v30, v60, v61
    v_cvt_pk_bf16_f32 v31, v62, v63
    s_waitcnt vmcnt(6)
    s_barrier
    s_setprio 3
Ltile4:
    s_waitcnt lgkmcnt(3)
    v_mfma_f32_32x32x16_bf16 v[48:63], v[10:13], v[4:7], 0
    ds_read2st64_b64 v[10:13], v83 offset0:30 offset1:31
    v_exp_f32 v32, v32
    v_exp_f32 v33, v33
    v_exp_f32 v34, v34
    v_exp_f32 v35, v35
    v_exp_f32 v36, v36
    s_waitcnt lgkmcnt(1)
    v_mfma_f32_32x32x16_bf16 v[64:79], v[16:19], v[24:27], v[64:79]
    s_add_u32 m0, m0, 8192
    s_add_u32 s46, s46, 8192
    buffer_load_dwordx4 v3, s[20:23], s46 offen sc1 lds
    v_exp_f32 v37, v37
    v_exp_f32 v38, v38
    v_exp_f32 v39, v39
    v_cvt_pk_bf16_f32 v24, v32, v33
    v_cvt_pk_bf16_f32 v25, v34, v35
    v_cvt_pk_bf16_f32 v26, v36, v37
    v_cvt_pk_bf16_f32 v27, v38, v39
    v_mfma_f32_32x32x8bf16_1k v[48:63], v[14:15], v[8:9], v[48:63]
    ds_read_b64 v[14:15], v81 offset:15360
    v_exp_f32 v40, v40
    v_exp_f32 v41, v41
    v_exp_f32 v42, v42
    v_exp_f32 v43, v43
    v_exp_f32 v44, v44
    v_mfma_f32_32x32x16_bf16 v[64:79], v[20:23], v[28:31], v[64:79]
    s_mov_b64 exec, s[30:31]
    ds_read_b128 v[16:19], v80 offset:10240
    ds_read_b128 v[20:23], v84 offset:10240
    s_mov_b64 exec, -1
    s_add_u32 m0, m0, 8192
    s_add_u32 s46, s46, 8192
    buffer_load_dwordx4 v3, s[20:23], s46 offen sc1 lds
    v_exp_f32 v45, v45
    v_exp_f32 v46, v46
    v_exp_f32 v47, v47
    v_cvt_pk_bf16_f32 v28, v40, v41
    v_cvt_pk_bf16_f32 v29, v42, v43
    v_cvt_pk_bf16_f32 v30, v44, v45
    v_cvt_pk_bf16_f32 v31, v46, v47
Ltile5:
    s_waitcnt lgkmcnt(3)
    v_mfma_f32_32x32x16_bf16 v[32:47], v[10:13], v[4:7], 0
    ds_read2st64_b64 v[10:13], v83 offset0:35 offset1:36
    v_exp_f32 v48, v48
    v_exp_f32 v49, v49
    v_exp_f32 v50, v50
    v_exp_f32 v51, v51
    v_exp_f32 v52, v52
    s_waitcnt lgkmcnt(1)
    v_mfma_f32_32x32x16_bf16 v[64:79], v[16:19], v[24:27], v[64:79]
    s_add_u32 m0, m0, 8192
    s_add_u32 s46, s46, 8192
    buffer_load_dwordx4 v3, s[20:23], s46 offen sc1 lds
    v_exp_f32 v53, v53
    v_exp_f32 v54, v54
    v_exp_f32 v55, v55
    v_cvt_pk_bf16_f32 v24, v48, v49
    v_cvt_pk_bf16_f32 v25, v50, v51
    v_cvt_pk_bf16_f32 v26, v52, v53
    v_cvt_pk_bf16_f32 v27, v54, v55
    v_mfma_f32_32x32x8bf16_1k v[32:47], v[14:15], v[8:9], v[32:47]
    ds_read_b64 v[14:15], v81 offset:17920
    v_exp_f32 v56, v56
    v_exp_f32 v57, v57
    v_exp_f32 v58, v58
    v_exp_f32 v59, v59
    v_exp_f32 v60, v60
    v_mfma_f32_32x32x16_bf16 v[64:79], v[20:23], v[28:31], v[64:79]
    s_mov_b64 exec, s[30:31]
    ds_read_b128 v[16:19], v80 offset:12800
    ds_read_b128 v[20:23], v84 offset:12800
    s_mov_b64 exec, -1
    s_add_u32 m0, m0, 8192
    s_add_u32 s46, s46, 8192
    buffer_load_dwordx4 v3, s[20:23], s46 offen sc1 lds
    v_exp_f32 v61, v61
    v_exp_f32 v62, v62
    v_exp_f32 v63, v63
    v_cvt_pk_bf16_f32 v28, v56, v57
    v_cvt_pk_bf16_f32 v29, v58, v59
    v_cvt_pk_bf16_f32 v30, v60, v61
    v_cvt_pk_bf16_f32 v31, v62, v63
Ltile6:
    s_waitcnt lgkmcnt(3)
    v_mfma_f32_32x32x16_bf16 v[48:63], v[10:13], v[4:7], 0
    ds_read2st64_b64 v[10:13], v83 offset0:40 offset1:41
    v_exp_f32 v32, v32
    v_exp_f32 v33, v33
    v_exp_f32 v34, v34
    v_exp_f32 v35, v35
    v_exp_f32 v36, v36
    s_waitcnt lgkmcnt(1)
    v_mfma_f32_32x32x16_bf16 v[64:79], v[16:19], v[24:27], v[64:79]
    s_add_u32 m0, m0, 8192
    s_add_u32 s46, s46, 8192
    buffer_load_dwordx4 v3, s[20:23], s46 offen sc1 lds
    v_exp_f32 v37, v37
    v_exp_f32 v38, v38
    v_exp_f32 v39, v39
    v_cvt_pk_bf16_f32 v24, v32, v33
    v_cvt_pk_bf16_f32 v25, v34, v35
    v_cvt_pk_bf16_f32 v26, v36, v37
    v_cvt_pk_bf16_f32 v27, v38, v39
    v_mfma_f32_32x32x8bf16_1k v[48:63], v[14:15], v[8:9], v[48:63]
    ds_read_b64 v[14:15], v81 offset:20480
    v_exp_f32 v40, v40
    v_exp_f32 v41, v41
    v_exp_f32 v42, v42
    v_exp_f32 v43, v43
    v_exp_f32 v44, v44
    v_mfma_f32_32x32x16_bf16 v[64:79], v[20:23], v[28:31], v[64:79]
    s_mov_b64 exec, s[30:31]
    ds_read_b128 v[16:19], v80 offset:15360
    ds_read_b128 v[20:23], v84 offset:15360
    s_mov_b64 exec, -1
    s_add_u32 m0, m0, 8192
    s_add_u32 s46, s46, 8192
    buffer_load_dwordx4 v3, s[20:23], s46 offen sc1 lds
    v_exp_f32 v45, v45
    v_exp_f32 v46, v46
    v_exp_f32 v47, v47
    v_cvt_pk_bf16_f32 v28, v40, v41
    v_cvt_pk_bf16_f32 v29, v42, v43
    v_cvt_pk_bf16_f32 v30, v44, v45
    v_cvt_pk_bf16_f32 v31, v46, v47
Ltile7:
    s_waitcnt lgkmcnt(3)
    v_mfma_f32_32x32x16_bf16 v[32:47], v[10:13], v[4:7], 0
    ds_read2st64_b64 v[10:13], v83 offset0:45 offset1:46
    v_exp_f32 v48, v48
    v_exp_f32 v49, v49
    v_exp_f32 v50, v50
    v_exp_f32 v51, v51
    v_exp_f32 v52, v52
    s_waitcnt lgkmcnt(1)
    v_mfma_f32_32x32x16_bf16 v[64:79], v[16:19], v[24:27], v[64:79]
    s_add_u32 m0, m0, 8192
    s_add_u32 s46, s46, 8192
    buffer_load_dwordx4 v3, s[20:23], s46 offen sc1 lds
    v_exp_f32 v53, v53
    v_exp_f32 v54, v54
    v_exp_f32 v55, v55
    v_cvt_pk_bf16_f32 v24, v48, v49
    v_cvt_pk_bf16_f32 v25, v50, v51
    v_cvt_pk_bf16_f32 v26, v52, v53
    v_cvt_pk_bf16_f32 v27, v54, v55
    v_mfma_f32_32x32x8bf16_1k v[32:47], v[14:15], v[8:9], v[32:47]
    ds_read_b64 v[14:15], v81 offset:23040
    v_exp_f32 v56, v56
    v_exp_f32 v57, v57
    v_exp_f32 v58, v58
    v_exp_f32 v59, v59
    v_exp_f32 v60, v60
    v_mfma_f32_32x32x16_bf16 v[64:79], v[20:23], v[28:31], v[64:79]
    s_mov_b64 exec, s[30:31]
    ds_read_b128 v[16:19], v80 offset:17920
    ds_read_b128 v[20:23], v84 offset:17920
    s_mov_b64 exec, -1
    s_add_u32 m0, m0, 8192
    s_add_u32 s46, s46, 8192
    buffer_load_dwordx4 v3, s[20:23], s46 offen sc1 lds
    v_exp_f32 v61, v61
    v_exp_f32 v62, v62
    v_exp_f32 v63, v63
    v_cvt_pk_bf16_f32 v28, v56, v57
    v_cvt_pk_bf16_f32 v29, v58, v59
    v_cvt_pk_bf16_f32 v30, v60, v61
    v_cvt_pk_bf16_f32 v31, v62, v63
Ltile8:
    s_waitcnt lgkmcnt(3)
    v_mfma_f32_32x32x16_bf16 v[48:63], v[10:13], v[4:7], 0
    ds_read2st64_b64 v[10:13], v83 offset0:50 offset1:51
    v_exp_f32 v32, v32
    v_exp_f32 v33, v33
    v_exp_f32 v34, v34
    v_exp_f32 v35, v35
    v_exp_f32 v36, v36
    s_waitcnt lgkmcnt(1)
    v_mfma_f32_32x32x16_bf16 v[64:79], v[16:19], v[24:27], v[64:79]
    v_exp_f32 v37, v37
    v_exp_f32 v38, v38
    v_exp_f32 v39, v39
    v_cvt_pk_bf16_f32 v24, v32, v33
    v_cvt_pk_bf16_f32 v25, v34, v35
    v_cvt_pk_bf16_f32 v26, v36, v37
    v_cvt_pk_bf16_f32 v27, v38, v39
    v_mfma_f32_32x32x8bf16_1k v[48:63], v[14:15], v[8:9], v[48:63]
    ds_read_b64 v[14:15], v81 offset:25600
    v_exp_f32 v40, v40
    v_exp_f32 v41, v41
    v_exp_f32 v42, v42
    v_exp_f32 v43, v43
    v_exp_f32 v44, v44
    v_mfma_f32_32x32x16_bf16 v[64:79], v[20:23], v[28:31], v[64:79]
    s_mov_b64 exec, s[30:31]
    ds_read_b128 v[16:19], v80 offset:20480
    ds_read_b128 v[20:23], v84 offset:20480
    s_mov_b64 exec, -1
    v_exp_f32 v45, v45
    v_exp_f32 v46, v46
    v_exp_f32 v47, v47
    v_cvt_pk_bf16_f32 v28, v40, v41
    v_cvt_pk_bf16_f32 v29, v42, v43
    v_cvt_pk_bf16_f32 v30, v44, v45
    v_cvt_pk_bf16_f32 v31, v46, v47
Ltile9:
    s_waitcnt lgkmcnt(3)
    v_mfma_f32_32x32x16_bf16 v[32:47], v[10:13], v[4:7], 0
    ds_read2st64_b64 v[10:13], v83 offset0:55 offset1:56
    v_exp_f32 v48, v48
    v_exp_f32 v49, v49
    v_exp_f32 v50, v50
    v_exp_f32 v51, v51
    v_exp_f32 v52, v52
    s_waitcnt lgkmcnt(1)
    v_mfma_f32_32x32x16_bf16 v[64:79], v[16:19], v[24:27], v[64:79]
    v_exp_f32 v53, v53
    v_exp_f32 v54, v54
    v_exp_f32 v55, v55
    v_cvt_pk_bf16_f32 v24, v48, v49
    v_cvt_pk_bf16_f32 v25, v50, v51
    v_cvt_pk_bf16_f32 v26, v52, v53
    v_cvt_pk_bf16_f32 v27, v54, v55
    v_mfma_f32_32x32x8bf16_1k v[32:47], v[14:15], v[8:9], v[32:47]
    ds_read_b64 v[14:15], v81 offset:28160
    v_exp_f32 v56, v56
    v_exp_f32 v57, v57
    v_exp_f32 v58, v58
    v_exp_f32 v59, v59
    v_exp_f32 v60, v60
    v_mfma_f32_32x32x16_bf16 v[64:79], v[20:23], v[28:31], v[64:79]
    s_mov_b64 exec, s[30:31]
    ds_read_b128 v[16:19], v80 offset:23040
    ds_read_b128 v[20:23], v84 offset:23040
    s_mov_b64 exec, -1
    v_exp_f32 v61, v61
    v_exp_f32 v62, v62
    v_exp_f32 v63, v63
    v_cvt_pk_bf16_f32 v28, v56, v57
    v_cvt_pk_bf16_f32 v29, v58, v59
    v_cvt_pk_bf16_f32 v30, v60, v61
    v_cvt_pk_bf16_f32 v31, v62, v63
Ltile10:
    s_waitcnt lgkmcnt(3)
    v_mfma_f32_32x32x16_bf16 v[48:63], v[10:13], v[4:7], 0
    ds_read2st64_b64 v[10:13], v83 offset0:60 offset1:61
    v_exp_f32 v32, v32
    v_exp_f32 v33, v33
    v_exp_f32 v34, v34
    v_exp_f32 v35, v35
    v_exp_f32 v36, v36
    s_waitcnt lgkmcnt(1)
    v_mfma_f32_32x32x16_bf16 v[64:79], v[16:19], v[24:27], v[64:79]
    v_exp_f32 v37, v37
    v_exp_f32 v38, v38
    v_exp_f32 v39, v39
    v_cvt_pk_bf16_f32 v24, v32, v33
    v_cvt_pk_bf16_f32 v25, v34, v35
    v_cvt_pk_bf16_f32 v26, v36, v37
    v_cvt_pk_bf16_f32 v27, v38, v39
    v_mfma_f32_32x32x8bf16_1k v[48:63], v[14:15], v[8:9], v[48:63]
    ds_read_b64 v[14:15], v81 offset:30720
    v_exp_f32 v40, v40
    v_exp_f32 v41, v41
    v_exp_f32 v42, v42
    v_exp_f32 v43, v43
    v_exp_f32 v44, v44
    v_mfma_f32_32x32x16_bf16 v[64:79], v[20:23], v[28:31], v[64:79]
    s_mov_b64 exec, s[30:31]
    ds_read_b128 v[16:19], v80 offset:25600
    ds_read_b128 v[20:23], v84 offset:25600
    s_mov_b64 exec, -1
    v_exp_f32 v45, v45
    v_exp_f32 v46, v46
    v_exp_f32 v47, v47
    v_cvt_pk_bf16_f32 v28, v40, v41
    v_cvt_pk_bf16_f32 v29, v42, v43
    v_cvt_pk_bf16_f32 v30, v44, v45
    v_cvt_pk_bf16_f32 v31, v46, v47
    s_setprio 2
Ltile11:
    s_waitcnt lgkmcnt(3)
    v_mfma_f32_32x32x16_bf16 v[32:47], v[10:13], v[4:7], 0
    ds_read2st64_b64 v[10:13], v83 offset0:65 offset1:66
    v_exp_f32 v48, v48
    v_exp_f32 v49, v49
    v_exp_f32 v50, v50
    v_exp_f32 v51, v51
    v_exp_f32 v52, v52
    s_waitcnt lgkmcnt(1)
    v_mfma_f32_32x32x16_bf16 v[64:79], v[16:19], v[24:27], v[64:79]
    v_exp_f32 v53, v53
    v_exp_f32 v54, v54
    v_exp_f32 v55, v55
    v_cvt_pk_bf16_f32 v24, v48, v49
    v_cvt_pk_bf16_f32 v25, v50, v51
    v_cvt_pk_bf16_f32 v26, v52, v53
    v_cvt_pk_bf16_f32 v27, v54, v55
    v_mfma_f32_32x32x8bf16_1k v[32:47], v[14:15], v[8:9], v[32:47]
    ds_read_b64 v[14:15], v81 offset:33280
    v_exp_f32 v56, v56
    v_exp_f32 v57, v57
    v_exp_f32 v58, v58
    v_exp_f32 v59, v59
    v_exp_f32 v60, v60
    v_mfma_f32_32x32x16_bf16 v[64:79], v[20:23], v[28:31], v[64:79]
    s_mov_b64 exec, s[30:31]
    ds_read_b128 v[16:19], v80 offset:28160
    ds_read_b128 v[20:23], v84 offset:28160
    s_mov_b64 exec, -1
    v_exp_f32 v61, v61
    v_exp_f32 v62, v62
    v_exp_f32 v63, v63
    v_cvt_pk_bf16_f32 v28, v56, v57
    v_cvt_pk_bf16_f32 v29, v58, v59
    v_cvt_pk_bf16_f32 v30, v60, v61
    v_cvt_pk_bf16_f32 v31, v62, v63
Ltile12:
    s_waitcnt lgkmcnt(3)
    v_mfma_f32_32x32x16_bf16 v[48:63], v[10:13], v[4:7], 0
    ds_read2st64_b64 v[10:13], v83 offset0:70 offset1:71
    v_exp_f32 v32, v32
    v_exp_f32 v33, v33
    v_exp_f32 v34, v34
    v_exp_f32 v35, v35
    v_exp_f32 v36, v36
    s_waitcnt lgkmcnt(1)
    v_mfma_f32_32x32x16_bf16 v[64:79], v[16:19], v[24:27], v[64:79]
    v_exp_f32 v37, v37
    v_exp_f32 v38, v38
    v_exp_f32 v39, v39
    v_cvt_pk_bf16_f32 v24, v32, v33
    v_cvt_pk_bf16_f32 v25, v34, v35
    v_cvt_pk_bf16_f32 v26, v36, v37
    v_cvt_pk_bf16_f32 v27, v38, v39
    v_mfma_f32_32x32x8bf16_1k v[48:63], v[14:15], v[8:9], v[48:63]
    ds_read_b64 v[14:15], v81 offset:35840
    v_exp_f32 v40, v40
    v_exp_f32 v41, v41
    v_exp_f32 v42, v42
    v_exp_f32 v43, v43
    v_exp_f32 v44, v44
    v_mfma_f32_32x32x16_bf16 v[64:79], v[20:23], v[28:31], v[64:79]
    s_mov_b64 exec, s[30:31]
    ds_read_b128 v[16:19], v80 offset:30720
    ds_read_b128 v[20:23], v84 offset:30720
    s_mov_b64 exec, -1
    v_exp_f32 v45, v45
    v_exp_f32 v46, v46
    v_exp_f32 v47, v47
    v_cvt_pk_bf16_f32 v28, v40, v41
    v_cvt_pk_bf16_f32 v29, v42, v43
    v_cvt_pk_bf16_f32 v30, v44, v45
    v_cvt_pk_bf16_f32 v31, v46, v47
Ltile13:
    s_waitcnt lgkmcnt(3)
    v_mfma_f32_32x32x16_bf16 v[32:47], v[10:13], v[4:7], 0
    ds_read2st64_b64 v[10:13], v83 offset0:75 offset1:76
    v_exp_f32 v48, v48
    v_exp_f32 v49, v49
    v_exp_f32 v50, v50
    v_exp_f32 v51, v51
    v_exp_f32 v52, v52
    s_waitcnt lgkmcnt(1)
    v_mfma_f32_32x32x16_bf16 v[64:79], v[16:19], v[24:27], v[64:79]
    v_exp_f32 v53, v53
    v_exp_f32 v54, v54
    v_exp_f32 v55, v55
    v_cvt_pk_bf16_f32 v24, v48, v49
    v_cvt_pk_bf16_f32 v25, v50, v51
    v_cvt_pk_bf16_f32 v26, v52, v53
    v_cvt_pk_bf16_f32 v27, v54, v55
    v_mfma_f32_32x32x8bf16_1k v[32:47], v[14:15], v[8:9], v[32:47]
    ds_read_b64 v[14:15], v81 offset:38400
    v_exp_f32 v56, v56
    v_exp_f32 v57, v57
    v_exp_f32 v58, v58
    v_exp_f32 v59, v59
    v_exp_f32 v60, v60
    v_mfma_f32_32x32x16_bf16 v[64:79], v[20:23], v[28:31], v[64:79]
    s_mov_b64 exec, s[30:31]
    ds_read_b128 v[16:19], v80 offset:33280
    ds_read_b128 v[20:23], v84 offset:33280
    s_mov_b64 exec, -1
    v_exp_f32 v61, v61
    v_exp_f32 v62, v62
    v_exp_f32 v63, v63
    v_cvt_pk_bf16_f32 v28, v56, v57
    v_cvt_pk_bf16_f32 v29, v58, v59
    v_cvt_pk_bf16_f32 v30, v60, v61
    v_cvt_pk_bf16_f32 v31, v62, v63
    s_setprio 1
Ltile14:
    s_waitcnt lgkmcnt(3)
    v_mfma_f32_32x32x16_bf16 v[48:63], v[10:13], v[4:7], 0
    ds_read2st64_b64 v[10:13], v83 offset0:80 offset1:81
    v_exp_f32 v32, v32
    v_exp_f32 v33, v33
    v_exp_f32 v34, v34
    v_exp_f32 v35, v35
    v_exp_f32 v36, v36
    s_waitcnt lgkmcnt(1)
    v_mfma_f32_32x32x16_bf16 v[64:79], v[16:19], v[24:27], v[64:79]
    v_exp_f32 v37, v37
    v_exp_f32 v38, v38
    v_exp_f32 v39, v39
    v_cvt_pk_bf16_f32 v24, v32, v33
    v_cvt_pk_bf16_f32 v25, v34, v35
    v_cvt_pk_bf16_f32 v26, v36, v37
    v_cvt_pk_bf16_f32 v27, v38, v39
    v_mfma_f32_32x32x8bf16_1k v[48:63], v[14:15], v[8:9], v[48:63]
    ds_read_b64 v[14:15], v81 offset:40960
    v_exp_f32 v40, v40
    v_exp_f32 v41, v41
    v_exp_f32 v42, v42
    v_exp_f32 v43, v43
    v_exp_f32 v44, v44
    v_mfma_f32_32x32x16_bf16 v[64:79], v[20:23], v[28:31], v[64:79]
    s_mov_b64 exec, s[30:31]
    ds_read_b128 v[16:19], v80 offset:35840
    ds_read_b128 v[20:23], v84 offset:35840
    s_mov_b64 exec, -1
    v_exp_f32 v45, v45
    v_exp_f32 v46, v46
    v_exp_f32 v47, v47
    v_cvt_pk_bf16_f32 v28, v40, v41
    v_cvt_pk_bf16_f32 v29, v42, v43
    v_cvt_pk_bf16_f32 v30, v44, v45
    v_cvt_pk_bf16_f32 v31, v46, v47
Ltile15:
    s_waitcnt lgkmcnt(3)
    v_mfma_f32_32x32x16_bf16 v[32:47], v[10:13], v[4:7], 0
    ds_read2st64_b64 v[10:13], v83 offset0:85 offset1:86
    v_exp_f32 v48, v48
    v_exp_f32 v49, v49
    v_exp_f32 v50, v50
    v_exp_f32 v51, v51
    v_exp_f32 v52, v52
    s_waitcnt lgkmcnt(1)
    v_mfma_f32_32x32x16_bf16 v[64:79], v[16:19], v[24:27], v[64:79]
    v_exp_f32 v53, v53
    v_exp_f32 v54, v54
    v_exp_f32 v55, v55
    v_cvt_pk_bf16_f32 v24, v48, v49
    v_cvt_pk_bf16_f32 v25, v50, v51
    v_cvt_pk_bf16_f32 v26, v52, v53
    v_cvt_pk_bf16_f32 v27, v54, v55
    v_mfma_f32_32x32x8bf16_1k v[32:47], v[14:15], v[8:9], v[32:47]
    ds_read_b64 v[14:15], v81 offset:43520
    v_exp_f32 v56, v56
    v_exp_f32 v57, v57
    v_exp_f32 v58, v58
    v_exp_f32 v59, v59
    v_exp_f32 v60, v60
    v_mfma_f32_32x32x16_bf16 v[64:79], v[20:23], v[28:31], v[64:79]
    s_mov_b64 exec, s[30:31]
    ds_read_b128 v[16:19], v80 offset:38400
    ds_read_b128 v[20:23], v84 offset:38400
    s_mov_b64 exec, -1
    v_exp_f32 v61, v61
    v_exp_f32 v62, v62
    v_exp_f32 v63, v63
    v_cvt_pk_bf16_f32 v28, v56, v57
    v_cvt_pk_bf16_f32 v29, v58, v59
    v_cvt_pk_bf16_f32 v30, v60, v61
    v_cvt_pk_bf16_f32 v31, v62, v63
    s_cmp_lg_u32 s3, 4
    s_cbranch_scc1 Lalld_14d
    s_mov_b32 s48, 22257664
    s_mov_b32 s49, 0
Lalld_14:
    buffer_load_dwordx4 v[88:91], v3, s[20:23], s48 offen sc1
    s_add_u32 s49, s49, 1
    s_waitcnt vmcnt(0)
    v_xor_b32 v88, s77, v88
    v_xor_b32 v89, s77, v89
    v_xor_b32 v90, s77, v90
    v_xor_b32 v91, s77, v91
    v_or3_b32 v88, v88, v89, v90
    v_or_b32 v88, v88, v91
    v_cmp_ne_u32 vcc, 0, v88
    s_cmp_ge_u32 s49, 0x40000
    s_cbranch_scc1 Lalld_14d
    s_cbranch_vccz Lalld_14d
    s_sleep 2
    s_branch Lalld_14
Lalld_14d:
    s_waitcnt vmcnt(0)
    s_barrier
    buffer_load_dword v82, v82, s[20:23], s47 offen sc1
    s_setprio 3
Ltile16:
    s_waitcnt lgkmcnt(3)
    v_mfma_f32_32x32x16_bf16 v[48:63], v[10:13], v[4:7], 0
    ds_read2st64_b64 v[10:13], v83 offset0:90 offset1:91
    v_exp_f32 v32, v32
    v_exp_f32 v33, v33
    v_exp_f32 v34, v34
    v_exp_f32 v35, v35
    v_exp_f32 v36, v36
    s_waitcnt lgkmcnt(1)
    v_mfma_f32_32x32x16_bf16 v[64:79], v[16:19], v[24:27], v[64:79]
    v_exp_f32 v37, v37
    v_exp_f32 v38, v38
    v_exp_f32 v39, v39
    v_cvt_pk_bf16_f32 v24, v32, v33
    v_cvt_pk_bf16_f32 v25, v34, v35
    v_cvt_pk_bf16_f32 v26, v36, v37
    v_cvt_pk_bf16_f32 v27, v38, v39
    v_mfma_f32_32x32x8bf16_1k v[48:63], v[14:15], v[8:9], v[48:63]
    ds_read_b64 v[14:15], v81 offset:46080
    v_exp_f32 v40, v40
    v_exp_f32 v41, v41
    v_exp_f32 v42, v42
    v_exp_f32 v43, v43
    v_exp_f32 v44, v44
    v_mfma_f32_32x32x16_bf16 v[64:79], v[20:23], v[28:31], v[64:79]
    s_mov_b64 exec, s[30:31]
    ds_read_b128 v[16:19], v80 offset:40960
    ds_read_b128 v[20:23], v84 offset:40960
    s_mov_b64 exec, -1
    v_exp_f32 v45, v45
    v_exp_f32 v46, v46
    v_exp_f32 v47, v47
    v_cvt_pk_bf16_f32 v28, v40, v41
    v_cvt_pk_bf16_f32 v29, v42, v43
    v_cvt_pk_bf16_f32 v30, v44, v45
    v_cvt_pk_bf16_f32 v31, v46, v47
Ltile17:
    s_waitcnt lgkmcnt(3)
    v_mfma_f32_32x32x16_bf16 v[32:47], v[10:13], v[4:7], 0
    ds_read2st64_b64 v[10:13], v83 offset0:95 offset1:96
    v_exp_f32 v48, v48
    v_exp_f32 v49, v49
    v_exp_f32 v50, v50
    v_exp_f32 v51, v51
    v_exp_f32 v52, v52
    s_waitcnt lgkmcnt(1)
    v_mfma_f32_32x32x16_bf16 v[64:79], v[16:19], v[24:27], v[64:79]
    v_exp_f32 v53, v53
    v_exp_f32 v54, v54
    v_exp_f32 v55, v55
    v_cvt_pk_bf16_f32 v24, v48, v49
    v_cvt_pk_bf16_f32 v25, v50, v51
    v_cvt_pk_bf16_f32 v26, v52, v53
    v_cvt_pk_bf16_f32 v27, v54, v55
    v_mfma_f32_32x32x8bf16_1k v[32:47], v[14:15], v[8:9], v[32:47]
    ds_read_b64 v[14:15], v81 offset:48640
    v_exp_f32 v56, v56
    v_exp_f32 v57, v57
    v_exp_f32 v58, v58
    v_exp_f32 v59, v59
    v_exp_f32 v60, v60
    v_mfma_f32_32x32x16_bf16 v[64:79], v[20:23], v[28:31], v[64:79]
    s_mov_b64 exec, s[30:31]
    ds_read_b128 v[16:19], v80 offset:43520
    ds_read_b128 v[20:23], v84 offset:43520
    s_mov_b64 exec, -1
    v_exp_f32 v61, v61
    v_exp_f32 v62, v62
    v_exp_f32 v63, v63
    v_cvt_pk_bf16_f32 v28, v56, v57
    v_cvt_pk_bf16_f32 v29, v58, v59
    v_cvt_pk_bf16_f32 v30, v60, v61
    v_cvt_pk_bf16_f32 v31, v62, v63
Ltile18:
    s_waitcnt lgkmcnt(3)
    v_mfma_f32_32x32x16_bf16 v[48:63], v[10:13], v[4:7], 0
    ds_read2st64_b64 v[10:13], v83 offset0:100 offset1:101
    v_exp_f32 v32, v32
    v_exp_f32 v33, v33
    v_exp_f32 v34, v34
    v_exp_f32 v35, v35
    v_exp_f32 v36, v36
    s_waitcnt lgkmcnt(1)
    v_mfma_f32_32x32x16_bf16 v[64:79], v[16:19], v[24:27], v[64:79]
    v_exp_f32 v37, v37
    v_exp_f32 v38, v38
    v_exp_f32 v39, v39
    v_cvt_pk_bf16_f32 v24, v32, v33
    v_cvt_pk_bf16_f32 v25, v34, v35
    v_cvt_pk_bf16_f32 v26, v36, v37
    v_cvt_pk_bf16_f32 v27, v38, v39
    v_mfma_f32_32x32x8bf16_1k v[48:63], v[14:15], v[8:9], v[48:63]
    ds_read_b64 v[14:15], v81 offset:51200
    v_exp_f32 v40, v40
    v_exp_f32 v41, v41
    v_exp_f32 v42, v42
    v_exp_f32 v43, v43
    v_exp_f32 v44, v44
    v_mfma_f32_32x32x16_bf16 v[64:79], v[20:23], v[28:31], v[64:79]
    s_mov_b64 exec, s[30:31]
    ds_read_b128 v[16:19], v80 offset:46080
    ds_read_b128 v[20:23], v84 offset:46080
    s_mov_b64 exec, -1
    buffer_load_dwordx4 v[88:91], v3, s[20:23], s62 offen offset:0 sc1
    v_exp_f32 v45, v45
    v_exp_f32 v46, v46
    v_exp_f32 v47, v47
    v_cvt_pk_bf16_f32 v28, v40, v41
    v_cvt_pk_bf16_f32 v29, v42, v43
    v_cvt_pk_bf16_f32 v30, v44, v45
    v_cvt_pk_bf16_f32 v31, v46, v47
Ltile19:
    s_waitcnt lgkmcnt(3)
    v_mfma_f32_32x32x16_bf16 v[32:47], v[10:13], v[4:7], 0
    ds_read2st64_b64 v[10:13], v83 offset0:105 offset1:106
    v_exp_f32 v48, v48
    v_exp_f32 v49, v49
    v_exp_f32 v50, v50
    v_exp_f32 v51, v51
    v_exp_f32 v52, v52
    s_waitcnt lgkmcnt(1)
    v_mfma_f32_32x32x16_bf16 v[64:79], v[16:19], v[24:27], v[64:79]
    v_exp_f32 v53, v53
    v_exp_f32 v54, v54
    v_exp_f32 v55, v55
    v_cvt_pk_bf16_f32 v24, v48, v49
    v_cvt_pk_bf16_f32 v25, v50, v51
    v_cvt_pk_bf16_f32 v26, v52, v53
    v_cvt_pk_bf16_f32 v27, v54, v55
    v_mfma_f32_32x32x8bf16_1k v[32:47], v[14:15], v[8:9], v[32:47]
    ds_read_b64 v[14:15], v81 offset:53760
    v_exp_f32 v56, v56
    v_exp_f32 v57, v57
    v_exp_f32 v58, v58
    v_exp_f32 v59, v59
    v_exp_f32 v60, v60
    v_mfma_f32_32x32x16_bf16 v[64:79], v[20:23], v[28:31], v[64:79]
    s_mov_b64 exec, s[30:31]
    ds_read_b128 v[16:19], v80 offset:48640
    ds_read_b128 v[20:23], v84 offset:48640
    s_mov_b64 exec, -1
    buffer_load_dwordx4 v[92:95], v3, s[20:23], s63 offen offset:0 sc1
    v_exp_f32 v61, v61
    v_exp_f32 v62, v62
    v_exp_f32 v63, v63
    v_cvt_pk_bf16_f32 v28, v56, v57
    v_cvt_pk_bf16_f32 v29, v58, v59
    v_cvt_pk_bf16_f32 v30, v60, v61
    v_cvt_pk_bf16_f32 v31, v62, v63
Ltile20:
    s_waitcnt lgkmcnt(3)
    v_mfma_f32_32x32x16_bf16 v[48:63], v[10:13], v[4:7], 0
    ds_read2st64_b64 v[10:13], v83 offset0:110 offset1:111
    v_exp_f32 v32, v32
    v_exp_f32 v33, v33
    v_exp_f32 v34, v34
    v_exp_f32 v35, v35
    v_exp_f32 v36, v36
    s_waitcnt lgkmcnt(1)
    v_mfma_f32_32x32x16_bf16 v[64:79], v[16:19], v[24:27], v[64:79]
    v_exp_f32 v37, v37
    v_exp_f32 v38, v38
    v_exp_f32 v39, v39
    v_cvt_pk_bf16_f32 v24, v32, v33
    v_cvt_pk_bf16_f32 v25, v34, v35
    v_cvt_pk_bf16_f32 v26, v36, v37
    v_cvt_pk_bf16_f32 v27, v38, v39
    v_mfma_f32_32x32x8bf16_1k v[48:63], v[14:15], v[8:9], v[48:63]
    ds_read_b64 v[14:15], v81 offset:56320
    v_exp_f32 v40, v40
    v_exp_f32 v41, v41
    v_exp_f32 v42, v42
    v_exp_f32 v43, v43
    v_exp_f32 v44, v44
    v_mfma_f32_32x32x16_bf16 v[64:79], v[20:23], v[28:31], v[64:79]
    s_mov_b64 exec, s[30:31]
    ds_read_b128 v[16:19], v80 offset:51200
    ds_read_b128 v[20:23], v84 offset:51200
    s_mov_b64 exec, -1
    buffer_load_dwordx4 v[96:99], v3, s[20:23], s64 offen offset:0 sc1
    v_exp_f32 v45, v45
    v_exp_f32 v46, v46
    v_exp_f32 v47, v47
    v_cvt_pk_bf16_f32 v28, v40, v41
    v_cvt_pk_bf16_f32 v29, v42, v43
    v_cvt_pk_bf16_f32 v30, v44, v45
    v_cvt_pk_bf16_f32 v31, v46, v47
Ltile21:
    s_waitcnt lgkmcnt(3)
    v_mfma_f32_32x32x16_bf16 v[32:47], v[10:13], v[4:7], 0
    ds_read2st64_b64 v[10:13], v83 offset0:115 offset1:116
    v_exp_f32 v48, v48
    v_exp_f32 v49, v49
    v_exp_f32 v50, v50
    v_exp_f32 v51, v51
    v_exp_f32 v52, v52
    s_waitcnt lgkmcnt(1)
    v_mfma_f32_32x32x16_bf16 v[64:79], v[16:19], v[24:27], v[64:79]
    v_exp_f32 v53, v53
    v_exp_f32 v54, v54
    v_exp_f32 v55, v55
    v_cvt_pk_bf16_f32 v24, v48, v49
    v_cvt_pk_bf16_f32 v25, v50, v51
    v_cvt_pk_bf16_f32 v26, v52, v53
    v_cvt_pk_bf16_f32 v27, v54, v55
    v_mfma_f32_32x32x8bf16_1k v[32:47], v[14:15], v[8:9], v[32:47]
    ds_read_b64 v[14:15], v81 offset:58880
    v_exp_f32 v56, v56
    v_exp_f32 v57, v57
    v_exp_f32 v58, v58
    v_exp_f32 v59, v59
    v_exp_f32 v60, v60
    v_mfma_f32_32x32x16_bf16 v[64:79], v[20:23], v[28:31], v[64:79]
    s_mov_b64 exec, s[30:31]
    ds_read_b128 v[16:19], v80 offset:53760
    ds_read_b128 v[20:23], v84 offset:53760
    s_mov_b64 exec, -1
    buffer_load_dwordx4 v[100:103], v3, s[20:23], s65 offen offset:0 sc1
    v_exp_f32 v61, v61
    v_exp_f32 v62, v62
    v_exp_f32 v63, v63
    v_cvt_pk_bf16_f32 v28, v56, v57
    v_cvt_pk_bf16_f32 v29, v58, v59
    v_cvt_pk_bf16_f32 v30, v60, v61
    v_cvt_pk_bf16_f32 v31, v62, v63
Ltile22:
    s_waitcnt lgkmcnt(3)
    v_mfma_f32_32x32x16_bf16 v[48:63], v[10:13], v[4:7], 0
    ds_read2st64_b64 v[10:13], v83 offset0:120 offset1:121
    v_exp_f32 v32, v32
    v_exp_f32 v33, v33
    v_exp_f32 v34, v34
    v_exp_f32 v35, v35
    v_exp_f32 v36, v36
    s_waitcnt lgkmcnt(1)
    v_mfma_f32_32x32x16_bf16 v[64:79], v[16:19], v[24:27], v[64:79]
    v_exp_f32 v37, v37
    v_exp_f32 v38, v38
    v_exp_f32 v39, v39
    v_cvt_pk_bf16_f32 v24, v32, v33
    v_cvt_pk_bf16_f32 v25, v34, v35
    v_cvt_pk_bf16_f32 v26, v36, v37
    v_cvt_pk_bf16_f32 v27, v38, v39
    v_mfma_f32_32x32x8bf16_1k v[48:63], v[14:15], v[8:9], v[48:63]
    ds_read_b64 v[14:15], v81 offset:61440
    v_exp_f32 v40, v40
    v_exp_f32 v41, v41
    v_exp_f32 v42, v42
    v_exp_f32 v43, v43
    v_exp_f32 v44, v44
    v_mfma_f32_32x32x16_bf16 v[64:79], v[20:23], v[28:31], v[64:79]
    s_mov_b64 exec, s[30:31]
    ds_read_b128 v[16:19], v80 offset:56320
    ds_read_b128 v[20:23], v84 offset:56320
    s_mov_b64 exec, -1
    buffer_load_dwordx4 v[104:107], v3, s[20:23], s66 offen offset:0 sc1
    v_exp_f32 v45, v45
    v_exp_f32 v46, v46
    v_exp_f32 v47, v47
    v_cvt_pk_bf16_f32 v28, v40, v41
    v_cvt_pk_bf16_f32 v29, v42, v43
    v_cvt_pk_bf16_f32 v30, v44, v45
    v_cvt_pk_bf16_f32 v31, v46, v47
    v_add_u32 v80, 58880, v80
    v_add_u32 v81, 58880, v81
    v_add_u32 v83, 58880, v83
    v_add_u32 v84, 58880, v84
Ltile23:
    s_waitcnt lgkmcnt(3)
    v_mfma_f32_32x32x16_bf16 v[32:47], v[10:13], v[4:7], 0
    ds_read2st64_b64 v[10:13], v83 offset0:10 offset1:11
    v_exp_f32 v48, v48
    v_exp_f32 v49, v49
    v_exp_f32 v50, v50
    v_exp_f32 v51, v51
    v_exp_f32 v52, v52
    s_waitcnt lgkmcnt(1)
    v_mfma_f32_32x32x16_bf16 v[64:79], v[16:19], v[24:27], v[64:79]
    v_exp_f32 v53, v53
    v_exp_f32 v54, v54
    v_exp_f32 v55, v55
    v_cvt_pk_bf16_f32 v24, v48, v49
    v_cvt_pk_bf16_f32 v25, v50, v51
    v_cvt_pk_bf16_f32 v26, v52, v53
    v_cvt_pk_bf16_f32 v27, v54, v55
    v_mfma_f32_32x32x8bf16_1k v[32:47], v[14:15], v[8:9], v[32:47]
    ds_read_b64 v[14:15], v81 offset:5120
    v_exp_f32 v56, v56
    v_exp_f32 v57, v57
    v_exp_f32 v58, v58
    v_exp_f32 v59, v59
    v_exp_f32 v60, v60
    v_mfma_f32_32x32x16_bf16 v[64:79], v[20:23], v[28:31], v[64:79]
    s_mov_b64 exec, s[30:31]
    ds_read_b128 v[16:19], v80 offset:0
    ds_read_b128 v[20:23], v84 offset:0
    s_mov_b64 exec, -1
    buffer_load_dwordx4 v[108:111], v3, s[20:23], s67 offen offset:0 sc1
    v_exp_f32 v61, v61
    v_exp_f32 v62, v62
    v_exp_f32 v63, v63
    v_cvt_pk_bf16_f32 v28, v56, v57
    v_cvt_pk_bf16_f32 v29, v58, v59
    v_cvt_pk_bf16_f32 v30, v60, v61
    v_cvt_pk_bf16_f32 v31, v62, v63
Ltile24:
    s_waitcnt lgkmcnt(3)
    v_mfma_f32_32x32x16_bf16 v[48:63], v[10:13], v[4:7], 0
    ds_read2st64_b64 v[10:13], v83 offset0:15 offset1:16
    v_exp_f32 v32, v32
    v_exp_f32 v33, v33
    v_exp_f32 v34, v34
    v_exp_f32 v35, v35
    v_exp_f32 v36, v36
    s_waitcnt lgkmcnt(1)
    v_mfma_f32_32x32x16_bf16 v[64:79], v[16:19], v[24:27], v[64:79]
    v_exp_f32 v37, v37
    v_exp_f32 v38, v38
    v_exp_f32 v39, v39
    v_cvt_pk_bf16_f32 v24, v32, v33
    v_cvt_pk_bf16_f32 v25, v34, v35
    v_cvt_pk_bf16_f32 v26, v36, v37
    v_cvt_pk_bf16_f32 v27, v38, v39
    v_mfma_f32_32x32x8bf16_1k v[48:63], v[14:15], v[8:9], v[48:63]
    ds_read_b64 v[14:15], v81 offset:7680
    v_exp_f32 v40, v40
    v_exp_f32 v41, v41
    v_exp_f32 v42, v42
    v_exp_f32 v43, v43
    v_exp_f32 v44, v44
    v_mfma_f32_32x32x16_bf16 v[64:79], v[20:23], v[28:31], v[64:79]
    s_mov_b64 exec, s[30:31]
    ds_read_b128 v[16:19], v80 offset:2560
    ds_read_b128 v[20:23], v84 offset:2560
    s_mov_b64 exec, -1
    buffer_load_dwordx4 v[112:115], v3, s[20:23], s68 offen offset:0 sc1
    v_exp_f32 v45, v45
    v_exp_f32 v46, v46
    v_exp_f32 v47, v47
    v_cvt_pk_bf16_f32 v28, v40, v41
    v_cvt_pk_bf16_f32 v29, v42, v43
    v_cvt_pk_bf16_f32 v30, v44, v45
    v_cvt_pk_bf16_f32 v31, v46, v47
    s_cmp_lg_u32 s3, 0
    s_cbranch_scc1 Ltag2_15
    v_mov_b32 v85, 0
    global_load_dword v87, v85, s[6:7] sc1
Ltag2_15:
Ltile25:
    s_waitcnt lgkmcnt(3)
    v_mfma_f32_32x32x16_bf16 v[32:47], v[10:13], v[4:7], 0
    ds_read2st64_b64 v[10:13], v83 offset0:20 offset1:21
    v_exp_f32 v48, v48
    v_exp_f32 v49, v49
    v_exp_f32 v50, v50
    v_exp_f32 v51, v51
    v_exp_f32 v52, v52
    s_waitcnt lgkmcnt(1)
    v_mfma_f32_32x32x16_bf16 v[64:79], v[16:19], v[24:27], v[64:79]
    v_exp_f32 v53, v53
    v_exp_f32 v54, v54
    v_exp_f32 v55, v55
    v_cvt_pk_bf16_f32 v24, v48, v49
    v_cvt_pk_bf16_f32 v25, v50, v51
    v_cvt_pk_bf16_f32 v26, v52, v53
    v_cvt_pk_bf16_f32 v27, v54, v55
    v_mfma_f32_32x32x8bf16_1k v[32:47], v[14:15], v[8:9], v[32:47]
    ds_read_b64 v[14:15], v81 offset:10240
    v_exp_f32 v56, v56
    v_exp_f32 v57, v57
    v_exp_f32 v58, v58
    v_exp_f32 v59, v59
    v_exp_f32 v60, v60
    v_mfma_f32_32x32x16_bf16 v[64:79], v[20:23], v[28:31], v[64:79]
    s_mov_b64 exec, s[30:31]
    ds_read_b128 v[16:19], v80 offset:5120
    ds_read_b128 v[20:23], v84 offset:5120
    s_mov_b64 exec, -1
    buffer_load_dwordx4 v[116:119], v3, s[20:23], s69 offen offset:0 sc1
    v_exp_f32 v61, v61
    v_exp_f32 v62, v62
    v_exp_f32 v63, v63
    v_cvt_pk_bf16_f32 v28, v56, v57
    v_cvt_pk_bf16_f32 v29, v58, v59
    v_cvt_pk_bf16_f32 v30, v60, v61
    v_cvt_pk_bf16_f32 v31, v62, v63
Ltile26:
    s_waitcnt lgkmcnt(3)
    v_mfma_f32_32x32x16_bf16 v[48:63], v[10:13], v[4:7], 0
    ds_read2st64_b64 v[10:13], v83 offset0:25 offset1:26
    v_exp_f32 v32, v32
    v_exp_f32 v33, v33
    v_exp_f32 v34, v34
    v_exp_f32 v35, v35
    v_exp_f32 v36, v36
    s_waitcnt lgkmcnt(1)
    v_mfma_f32_32x32x16_bf16 v[64:79], v[16:19], v[24:27], v[64:79]
    v_exp_f32 v37, v37
    v_exp_f32 v38, v38
    v_exp_f32 v39, v39
    v_cvt_pk_bf16_f32 v24, v32, v33
    v_cvt_pk_bf16_f32 v25, v34, v35
    v_cvt_pk_bf16_f32 v26, v36, v37
    v_cvt_pk_bf16_f32 v27, v38, v39
    v_mfma_f32_32x32x8bf16_1k v[48:63], v[14:15], v[8:9], v[48:63]
    ds_read_b64 v[14:15], v81 offset:12800
    v_exp_f32 v40, v40
    v_exp_f32 v41, v41
    v_exp_f32 v42, v42
    v_exp_f32 v43, v43
    v_exp_f32 v44, v44
    v_mfma_f32_32x32x16_bf16 v[64:79], v[20:23], v[28:31], v[64:79]
    s_mov_b64 exec, s[30:31]
    ds_read_b128 v[16:19], v80 offset:7680
    ds_read_b128 v[20:23], v84 offset:7680
    s_mov_b64 exec, -1
    buffer_load_dwordx4 v[120:123], v3, s[20:23], s70 offen offset:0 sc1
    v_exp_f32 v45, v45
    v_exp_f32 v46, v46
    v_exp_f32 v47, v47
    v_cvt_pk_bf16_f32 v28, v40, v41
    v_cvt_pk_bf16_f32 v29, v42, v43
    v_cvt_pk_bf16_f32 v30, v44, v45
    v_cvt_pk_bf16_f32 v31, v46, v47
    s_cmp_lg_u32 s3, 1
    s_cbranch_scc1 Ltag2_16
    v_mov_b32 v85, 0
    global_load_dword v87, v85, s[6:7] sc1
Ltag2_16:
Ltile27:
    s_waitcnt lgkmcnt(3)
    v_mfma_f32_32x32x16_bf16 v[32:47], v[10:13], v[4:7], 0
    ds_read2st64_b64 v[10:13], v83 offset0:30 offset1:31
    v_exp_f32 v48, v48
    v_exp_f32 v49, v49
    v_exp_f32 v50, v50
    v_exp_f32 v51, v51
    v_exp_f32 v52, v52
    s_waitcnt lgkmcnt(1)
    v_mfma_f32_32x32x16_bf16 v[64:79], v[16:19], v[24:27], v[64:79]
    v_exp_f32 v53, v53
    v_exp_f32 v54, v54
    v_exp_f32 v55, v55
    v_cvt_pk_bf16_f32 v24, v48, v49
    v_cvt_pk_bf16_f32 v25, v50, v51
    v_cvt_pk_bf16_f32 v26, v52, v53
    v_cvt_pk_bf16_f32 v27, v54, v55
    v_mfma_f32_32x32x8bf16_1k v[32:47], v[14:15], v[8:9], v[32:47]
    ds_read_b64 v[14:15], v81 offset:15360
    v_exp_f32 v56, v56
    v_exp_f32 v57, v57
    v_exp_f32 v58, v58
    v_exp_f32 v59, v59
    v_exp_f32 v60, v60
    v_mfma_f32_32x32x16_bf16 v[64:79], v[20:23], v[28:31], v[64:79]
    s_mov_b64 exec, s[30:31]
    ds_read_b128 v[16:19], v80 offset:10240
    ds_read_b128 v[20:23], v84 offset:10240
    s_mov_b64 exec, -1
    buffer_load_dwordx4 v[124:127], v3, s[20:23], s62 offen offset:1024 sc1
    v_exp_f32 v61, v61
    v_exp_f32 v62, v62
    v_exp_f32 v63, v63
    v_cvt_pk_bf16_f32 v28, v56, v57
    v_cvt_pk_bf16_f32 v29, v58, v59
    v_cvt_pk_bf16_f32 v30, v60, v61
    v_cvt_pk_bf16_f32 v31, v62, v63
Ltile28:
    s_waitcnt lgkmcnt(3)
    v_mfma_f32_32x32x16_bf16 v[48:63], v[10:13], v[4:7], 0
    ds_read2st64_b64 v[10:13], v83 offset0:35 offset1:36
    v_exp_f32 v32, v32
    v_exp_f32 v33, v33
    v_exp_f32 v34, v34
    v_exp_f32 v35, v35
    v_exp_f32 v36, v36
    s_waitcnt lgkmcnt(1)
    v_mfma_f32_32x32x16_bf16 v[64:79], v[16:19], v[24:27], v[64:79]
    v_exp_f32 v37, v37
    v_exp_f32 v38, v38
    v_exp_f32 v39, v39
    v_cvt_pk_bf16_f32 v24, v32, v33
    v_cvt_pk_bf16_f32 v25, v34, v35
    v_cvt_pk_bf16_f32 v26, v36, v37
    v_cvt_pk_bf16_f32 v27, v38, v39
    v_mfma_f32_32x32x8bf16_1k v[48:63], v[14:15], v[8:9], v[48:63]
    ds_read_b64 v[14:15], v81 offset:17920
    v_exp_f32 v40, v40
    v_exp_f32 v41, v41
    v_exp_f32 v42, v42
    v_exp_f32 v43, v43
    v_exp_f32 v44, v44
    v_mfma_f32_32x32x16_bf16 v[64:79], v[20:23], v[28:31], v[64:79]
    s_mov_b64 exec, s[30:31]
    ds_read_b128 v[16:19], v80 offset:12800
    ds_read_b128 v[20:23], v84 offset:12800
    s_mov_b64 exec, -1
    buffer_load_dwordx4 v[128:131], v3, s[20:23], s63 offen offset:1024 sc1
    v_exp_f32 v45, v45
    v_exp_f32 v46, v46
    v_exp_f32 v47, v47
    v_cvt_pk_bf16_f32 v28, v40, v41
    v_cvt_pk_bf16_f32 v29, v42, v43
    v_cvt_pk_bf16_f32 v30, v44, v45
    v_cvt_pk_bf16_f32 v31, v46, v47
    s_cmp_lg_u32 s3, 2
    s_cbranch_scc1 Ltag2_17
    v_mov_b32 v85, 0
    global_load_dword v87, v85, s[6:7] sc1
Ltag2_17:
Ltile29:
    s_waitcnt lgkmcnt(3)
    v_mfma_f32_32x32x16_bf16 v[32:47], v[10:13], v[4:7], 0
    ds_read2st64_b64 v[10:13], v83 offset0:40 offset1:41
    v_exp_f32 v48, v48
    v_exp_f32 v49, v49
    v_exp_f32 v50, v50
    v_exp_f32 v51, v51
    v_exp_f32 v52, v52
    s_waitcnt lgkmcnt(1)
    v_mfma_f32_32x32x16_bf16 v[64:79], v[16:19], v[24:27], v[64:79]
    v_exp_f32 v53, v53
    v_exp_f32 v54, v54
    v_exp_f32 v55, v55
    v_cvt_pk_bf16_f32 v24, v48, v49
    v_cvt_pk_bf16_f32 v25, v50, v51
    v_cvt_pk_bf16_f32 v26, v52, v53
    v_cvt_pk_bf16_f32 v27, v54, v55
    v_mfma_f32_32x32x8bf16_1k v[32:47], v[14:15], v[8:9], v[32:47]
    ds_read_b64 v[14:15], v81 offset:20480
    v_exp_f32 v56, v56
    v_exp_f32 v57, v57
    v_exp_f32 v58, v58
    v_exp_f32 v59, v59
    v_exp_f32 v60, v60
    v_mfma_f32_32x32x16_bf16 v[64:79], v[20:23], v[28:31], v[64:79]
    s_mov_b64 exec, s[30:31]
    ds_read_b128 v[16:19], v80 offset:15360
    ds_read_b128 v[20:23], v84 offset:15360
    s_mov_b64 exec, -1
    buffer_load_dwordx4 v[132:135], v3, s[20:23], s64 offen offset:1024 sc1
    v_exp_f32 v61, v61
    v_exp_f32 v62, v62
    v_exp_f32 v63, v63
    v_cvt_pk_bf16_f32 v28, v56, v57
    v_cvt_pk_bf16_f32 v29, v58, v59
    v_cvt_pk_bf16_f32 v30, v60, v61
    v_cvt_pk_bf16_f32 v31, v62, v63
Ltile30:
    s_waitcnt lgkmcnt(3)
    v_mfma_f32_32x32x16_bf16 v[48:63], v[10:13], v[4:7], 0
    ds_read2st64_b64 v[10:13], v83 offset0:45 offset1:46
    v_exp_f32 v32, v32
    v_exp_f32 v33, v33
    v_exp_f32 v34, v34
    v_exp_f32 v35, v35
    v_exp_f32 v36, v36
    s_waitcnt lgkmcnt(1)
    v_mfma_f32_32x32x16_bf16 v[64:79], v[16:19], v[24:27], v[64:79]
    v_exp_f32 v37, v37
    v_exp_f32 v38, v38
    v_exp_f32 v39, v39
    v_cvt_pk_bf16_f32 v24, v32, v33
    v_cvt_pk_bf16_f32 v25, v34, v35
    v_cvt_pk_bf16_f32 v26, v36, v37
    v_cvt_pk_bf16_f32 v27, v38, v39
    v_mfma_f32_32x32x8bf16_1k v[48:63], v[14:15], v[8:9], v[48:63]
    ds_read_b64 v[14:15], v81 offset:23040
    v_exp_f32 v40, v40
    v_exp_f32 v41, v41
    v_exp_f32 v42, v42
    v_exp_f32 v43, v43
    v_exp_f32 v44, v44
    v_mfma_f32_32x32x16_bf16 v[64:79], v[20:23], v[28:31], v[64:79]
    s_mov_b64 exec, s[30:31]
    ds_read_b128 v[16:19], v80 offset:17920
    ds_read_b128 v[20:23], v84 offset:17920
    s_mov_b64 exec, -1
    buffer_load_dwordx4 v[136:139], v3, s[20:23], s65 offen offset:1024 sc1
    v_exp_f32 v45, v45
    v_exp_f32 v46, v46
    v_exp_f32 v47, v47
    v_cvt_pk_bf16_f32 v28, v40, v41
    v_cvt_pk_bf16_f32 v29, v42, v43
    v_cvt_pk_bf16_f32 v30, v44, v45
    v_cvt_pk_bf16_f32 v31, v46, v47
    s_cmp_lg_u32 s3, 3
    s_cbranch_scc1 Ltag2_18
    v_mov_b32 v85, 0
    global_load_dword v87, v85, s[6:7] sc1
Ltag2_18:
Ltile31:
    s_waitcnt lgkmcnt(3)
    v_mfma_f32_32x32x16_bf16 v[32:47], v[10:13], v[4:7], 0
    ds_read2st64_b64 v[10:13], v83 offset0:50 offset1:51
    v_exp_f32 v48, v48
    v_exp_f32 v49, v49
    v_exp_f32 v50, v50
    v_exp_f32 v51, v51
    v_exp_f32 v52, v52
    s_waitcnt lgkmcnt(1)
    v_mfma_f32_32x32x16_bf16 v[64:79], v[16:19], v[24:27], v[64:79]
    v_exp_f32 v53, v53
    v_exp_f32 v54, v54
    v_exp_f32 v55, v55
    v_cvt_pk_bf16_f32 v24, v48, v49
    v_cvt_pk_bf16_f32 v25, v50, v51
    v_cvt_pk_bf16_f32 v26, v52, v53
    v_cvt_pk_bf16_f32 v27, v54, v55
    v_mfma_f32_32x32x8bf16_1k v[32:47], v[14:15], v[8:9], v[32:47]
    ds_read_b64 v[14:15], v81 offset:25600
    v_exp_f32 v56, v56
    v_exp_f32 v57, v57
    v_exp_f32 v58, v58
    v_exp_f32 v59, v59
    v_exp_f32 v60, v60
    v_mfma_f32_32x32x16_bf16 v[64:79], v[20:23], v[28:31], v[64:79]
    s_mov_b64 exec, s[30:31]
    ds_read_b128 v[16:19], v80 offset:20480
    ds_read_b128 v[20:23], v84 offset:20480
    s_mov_b64 exec, -1
    buffer_load_dwordx4 v[140:143], v3, s[20:23], s66 offen offset:1024 sc1
    v_exp_f32 v61, v61
    v_exp_f32 v62, v62
    v_exp_f32 v63, v63
    v_cvt_pk_bf16_f32 v28, v56, v57
    v_cvt_pk_bf16_f32 v29, v58, v59
    v_cvt_pk_bf16_f32 v30, v60, v61
    v_cvt_pk_bf16_f32 v31, v62, v63
Ltile32:
    s_waitcnt lgkmcnt(3)
    v_mfma_f32_32x32x16_bf16 v[48:63], v[10:13], v[4:7], 0
    ds_read2st64_b64 v[10:13], v83 offset0:55 offset1:56
    v_exp_f32 v32, v32
    v_exp_f32 v33, v33
    v_exp_f32 v34, v34
    v_exp_f32 v35, v35
    v_exp_f32 v36, v36
    s_waitcnt lgkmcnt(1)
    v_mfma_f32_32x32x16_bf16 v[64:79], v[16:19], v[24:27], v[64:79]
    v_exp_f32 v37, v37
    v_exp_f32 v38, v38
    v_exp_f32 v39, v39
    v_cvt_pk_bf16_f32 v24, v32, v33
    v_cvt_pk_bf16_f32 v25, v34, v35
    v_cvt_pk_bf16_f32 v26, v36, v37
    v_cvt_pk_bf16_f32 v27, v38, v39
    v_mfma_f32_32x32x8bf16_1k v[48:63], v[14:15], v[8:9], v[48:63]
    ds_read_b64 v[14:15], v81 offset:28160
    v_exp_f32 v40, v40
    v_exp_f32 v41, v41
    v_exp_f32 v42, v42
    v_exp_f32 v43, v43
    v_exp_f32 v44, v44
    v_mfma_f32_32x32x16_bf16 v[64:79], v[20:23], v[28:31], v[64:79]
    s_mov_b64 exec, s[30:31]
    ds_read_b128 v[16:19], v80 offset:23040
    ds_read_b128 v[20:23], v84 offset:23040
    s_mov_b64 exec, -1
    buffer_load_dwordx4 v[144:147], v3, s[20:23], s67 offen offset:1024 sc1
    v_exp_f32 v45, v45
    v_exp_f32 v46, v46
    v_exp_f32 v47, v47
    v_cvt_pk_bf16_f32 v28, v40, v41
    v_cvt_pk_bf16_f32 v29, v42, v43
    v_cvt_pk_bf16_f32 v30, v44, v45
    v_cvt_pk_bf16_f32 v31, v46, v47
    s_cmp_lg_u32 s3, 4
    s_cbranch_scc1 Ltag2_19
    v_mov_b32 v85, 0
    global_load_dword v87, v85, s[6:7] sc1
Ltag2_19:
Ltile33:
    s_waitcnt lgkmcnt(3)
    v_mfma_f32_32x32x16_bf16 v[32:47], v[10:13], v[4:7], 0
    ds_read2st64_b64 v[10:13], v83 offset0:60 offset1:61
    v_exp_f32 v48, v48
    v_exp_f32 v49, v49
    v_exp_f32 v50, v50
    v_exp_f32 v51, v51
    v_exp_f32 v52, v52
    s_waitcnt lgkmcnt(1)
    v_mfma_f32_32x32x16_bf16 v[64:79], v[16:19], v[24:27], v[64:79]
    v_exp_f32 v53, v53
    v_exp_f32 v54, v54
    v_exp_f32 v55, v55
    v_cvt_pk_bf16_f32 v24, v48, v49
    v_cvt_pk_bf16_f32 v25, v50, v51
    v_cvt_pk_bf16_f32 v26, v52, v53
    v_cvt_pk_bf16_f32 v27, v54, v55
    v_mfma_f32_32x32x8bf16_1k v[32:47], v[14:15], v[8:9], v[32:47]
    ds_read_b64 v[14:15], v81 offset:30720
    v_exp_f32 v56, v56
    v_exp_f32 v57, v57
    v_exp_f32 v58, v58
    v_exp_f32 v59, v59
    v_exp_f32 v60, v60
    v_mfma_f32_32x32x16_bf16 v[64:79], v[20:23], v[28:31], v[64:79]
    s_mov_b64 exec, s[30:31]
    ds_read_b128 v[16:19], v80 offset:25600
    ds_read_b128 v[20:23], v84 offset:25600
    s_mov_b64 exec, -1
    buffer_load_dwordx4 v[148:151], v3, s[20:23], s68 offen offset:1024 sc1
    v_exp_f32 v61, v61
    v_exp_f32 v62, v62
    v_exp_f32 v63, v63
    v_cvt_pk_bf16_f32 v28, v56, v57
    v_cvt_pk_bf16_f32 v29, v58, v59
    v_cvt_pk_bf16_f32 v30, v60, v61
    v_cvt_pk_bf16_f32 v31, v62, v63
Ltile34:
    s_waitcnt lgkmcnt(3)
    v_mfma_f32_32x32x16_bf16 v[48:63], v[10:13], v[4:7], 0
    ds_read2st64_b64 v[10:13], v83 offset0:65 offset1:66
    v_exp_f32 v32, v32
    v_exp_f32 v33, v33
    v_exp_f32 v34, v34
    v_exp_f32 v35, v35
    v_exp_f32 v36, v36
    s_waitcnt lgkmcnt(1)
    v_mfma_f32_32x32x16_bf16 v[64:79], v[16:19], v[24:27], v[64:79]
    v_exp_f32 v37, v37
    v_exp_f32 v38, v38
    v_exp_f32 v39, v39
    v_cvt_pk_bf16_f32 v24, v32, v33
    v_cvt_pk_bf16_f32 v25, v34, v35
    v_cvt_pk_bf16_f32 v26, v36, v37
    v_cvt_pk_bf16_f32 v27, v38, v39
    v_mfma_f32_32x32x8bf16_1k v[48:63], v[14:15], v[8:9], v[48:63]
    ds_read_b64 v[14:15], v81 offset:33280
    v_exp_f32 v40, v40
    v_exp_f32 v41, v41
    v_exp_f32 v42, v42
    v_exp_f32 v43, v43
    v_exp_f32 v44, v44
    v_mfma_f32_32x32x16_bf16 v[64:79], v[20:23], v[28:31], v[64:79]
    s_mov_b64 exec, s[30:31]
    ds_read_b128 v[16:19], v80 offset:28160
    ds_read_b128 v[20:23], v84 offset:28160
    s_mov_b64 exec, -1
    buffer_load_dwordx4 v[152:155], v3, s[20:23], s69 offen offset:1024 sc1
    v_exp_f32 v45, v45
    v_exp_f32 v46, v46
    v_exp_f32 v47, v47
    v_cvt_pk_bf16_f32 v28, v40, v41
    v_cvt_pk_bf16_f32 v29, v42, v43
    v_cvt_pk_bf16_f32 v30, v44, v45
    v_cvt_pk_bf16_f32 v31, v46, v47
    s_cmp_lg_u32 s3, 5
    s_cbranch_scc1 Ltag2_20
    v_mov_b32 v85, 0
    global_load_dword v87, v85, s[6:7] sc1
Ltag2_20:
    s_setprio 2
Ltile35:
    s_waitcnt lgkmcnt(3)
    v_mfma_f32_32x32x16_bf16 v[32:47], v[10:13], v[4:7], 0
    ds_read2st64_b64 v[10:13], v83 offset0:70 offset1:71
    v_exp_f32 v48, v48
    v_exp_f32 v49, v49
    v_exp_f32 v50, v50
    v_exp_f32 v51, v51
    v_exp_f32 v52, v52
    s_waitcnt lgkmcnt(1)
    v_mfma_f32_32x32x16_bf16 v[64:79], v[16:19], v[24:27], v[64:79]
    v_exp_f32 v53, v53
    v_exp_f32 v54, v54
    v_exp_f32 v55, v55
    v_cvt_pk_bf16_f32 v24, v48, v49
    v_cvt_pk_bf16_f32 v25, v50, v51
    v_cvt_pk_bf16_f32 v26, v52, v53
    v_cvt_pk_bf16_f32 v27, v54, v55
    v_mfma_f32_32x32x8bf16_1k v[32:47], v[14:15], v[8:9], v[32:47]
    ds_read_b64 v[14:15], v81 offset:35840
    v_exp_f32 v56, v56
    v_exp_f32 v57, v57
    v_exp_f32 v58, v58
    v_exp_f32 v59, v59
    v_exp_f32 v60, v60
    v_mfma_f32_32x32x16_bf16 v[64:79], v[20:23], v[28:31], v[64:79]
    s_mov_b64 exec, s[30:31]
    ds_read_b128 v[16:19], v80 offset:30720
    ds_read_b128 v[20:23], v84 offset:30720
    s_mov_b64 exec, -1
    buffer_load_dwordx4 v[156:159], v3, s[20:23], s70 offen offset:1024 sc1
    v_exp_f32 v61, v61
    v_exp_f32 v62, v62
    v_exp_f32 v63, v63
    v_cvt_pk_bf16_f32 v28, v56, v57
    v_cvt_pk_bf16_f32 v29, v58, v59
    v_cvt_pk_bf16_f32 v30, v60, v61
    v_cvt_pk_bf16_f32 v31, v62, v63
Ltile36:
    s_waitcnt lgkmcnt(3)
    v_mfma_f32_32x32x16_bf16 v[48:63], v[10:13], v[4:7], 0
    ds_read2st64_b64 v[10:13], v83 offset0:75 offset1:76
    v_exp_f32 v32, v32
    v_exp_f32 v33, v33
    v_exp_f32 v34, v34
    v_exp_f32 v35, v35
    v_exp_f32 v36, v36
    s_waitcnt lgkmcnt(1)
    v_mfma_f32_32x32x16_bf16 v[64:79], v[16:19], v[24:27], v[64:79]
    v_exp_f32 v37, v37
    v_exp_f32 v38, v38
    v_exp_f32 v39, v39
    v_cvt_pk_bf16_f32 v24, v32, v33
    v_cvt_pk_bf16_f32 v25, v34, v35
    v_cvt_pk_bf16_f32 v26, v36, v37
    v_cvt_pk_bf16_f32 v27, v38, v39
    v_mfma_f32_32x32x8bf16_1k v[48:63], v[14:15], v[8:9], v[48:63]
    ds_read_b64 v[14:15], v81 offset:38400
    v_exp_f32 v40, v40
    v_exp_f32 v41, v41
    v_exp_f32 v42, v42
    v_exp_f32 v43, v43
    v_exp_f32 v44, v44
    v_mfma_f32_32x32x16_bf16 v[64:79], v[20:23], v[28:31], v[64:79]
    s_mov_b64 exec, s[30:31]
    ds_read_b128 v[16:19], v80 offset:33280
    ds_read_b128 v[20:23], v84 offset:33280
    s_mov_b64 exec, -1
    buffer_load_dwordx4 v[160:163], v3, s[20:23], s62 offen offset:2048 sc1
    v_exp_f32 v45, v45
    v_exp_f32 v46, v46
    v_exp_f32 v47, v47
    v_cvt_pk_bf16_f32 v28, v40, v41
    v_cvt_pk_bf16_f32 v29, v42, v43
    v_cvt_pk_bf16_f32 v30, v44, v45
    v_cvt_pk_bf16_f32 v31, v46, v47
    s_cmp_lg_u32 s3, 6
    s_cbranch_scc1 Ltag2_21
    v_mov_b32 v85, 0
    global_load_dword v87, v85, s[6:7] sc1
Ltag2_21:
Ltile37:
    s_waitcnt lgkmcnt(3)
    v_mfma_f32_32x32x16_bf16 v[32:47], v[10:13], v[4:7], 0
    ds_read2st64_b64 v[10:13], v83 offset0:80 offset1:81
    v_exp_f32 v48, v48
    v_exp_f32 v49, v49
    v_exp_f32 v50, v50
    v_exp_f32 v51, v51
    v_exp_f32 v52, v52
    s_waitcnt lgkmcnt(1)
    v_mfma_f32_32x32x16_bf16 v[64:79], v[16:19], v[24:27], v[64:79]
    v_exp_f32 v53, v53
    v_exp_f32 v54, v54
    v_exp_f32 v55, v55
    v_cvt_pk_bf16_f32 v24, v48, v49
    v_cvt_pk_bf16_f32 v25, v50, v51
    v_cvt_pk_bf16_f32 v26, v52, v53
    v_cvt_pk_bf16_f32 v27, v54, v55
    v_mfma_f32_32x32x8bf16_1k v[32:47], v[14:15], v[8:9], v[32:47]
    ds_read_b64 v[14:15], v81 offset:40960
    v_exp_f32 v56, v56
    v_exp_f32 v57, v57
    v_exp_f32 v58, v58
    v_exp_f32 v59, v59
    v_exp_f32 v60, v60
    v_mfma_f32_32x32x16_bf16 v[64:79], v[20:23], v[28:31], v[64:79]
    s_mov_b64 exec, s[30:31]
    ds_read_b128 v[16:19], v80 offset:35840
    ds_read_b128 v[20:23], v84 offset:35840
    s_mov_b64 exec, -1
    buffer_load_dwordx4 v[164:167], v3, s[20:23], s63 offen offset:2048 sc1
    v_exp_f32 v61, v61
    v_exp_f32 v62, v62
    v_exp_f32 v63, v63
    v_cvt_pk_bf16_f32 v28, v56, v57
    v_cvt_pk_bf16_f32 v29, v58, v59
    v_cvt_pk_bf16_f32 v30, v60, v61
    v_cvt_pk_bf16_f32 v31, v62, v63
Ltile38:
    s_waitcnt lgkmcnt(3)
    v_mfma_f32_32x32x16_bf16 v[48:63], v[10:13], v[4:7], 0
    ds_read2st64_b64 v[10:13], v83 offset0:85 offset1:86
    v_exp_f32 v32, v32
    v_exp_f32 v33, v33
    v_exp_f32 v34, v34
    v_exp_f32 v35, v35
    v_exp_f32 v36, v36
    s_waitcnt lgkmcnt(1)
    v_mfma_f32_32x32x16_bf16 v[64:79], v[16:19], v[24:27], v[64:79]
    v_exp_f32 v37, v37
    v_exp_f32 v38, v38
    v_exp_f32 v39, v39
    v_cvt_pk_bf16_f32 v24, v32, v33
    v_cvt_pk_bf16_f32 v25, v34, v35
    v_cvt_pk_bf16_f32 v26, v36, v37
    v_cvt_pk_bf16_f32 v27, v38, v39
    v_mfma_f32_32x32x8bf16_1k v[48:63], v[14:15], v[8:9], v[48:63]
    ds_read_b64 v[14:15], v81 offset:43520
    v_exp_f32 v40, v40
    v_exp_f32 v41, v41
    v_exp_f32 v42, v42
    v_exp_f32 v43, v43
    v_exp_f32 v44, v44
    v_mfma_f32_32x32x16_bf16 v[64:79], v[20:23], v[28:31], v[64:79]
    s_mov_b64 exec, s[30:31]
    ds_read_b128 v[16:19], v80 offset:38400
    ds_read_b128 v[20:23], v84 offset:38400
    s_mov_b64 exec, -1
    buffer_load_dwordx4 v[168:171], v3, s[20:23], s64 offen offset:2048 sc1
    v_exp_f32 v45, v45
    v_exp_f32 v46, v46
    v_exp_f32 v47, v47
    v_cvt_pk_bf16_f32 v28, v40, v41
    v_cvt_pk_bf16_f32 v29, v42, v43
    v_cvt_pk_bf16_f32 v30, v44, v45
    v_cvt_pk_bf16_f32 v31, v46, v47
    s_cmp_lg_u32 s3, 7
    s_cbranch_scc1 Ltag2_22
    v_mov_b32 v85, 0
    global_load_dword v87, v85, s[6:7] sc1
Ltag2_22:
Ltile39:
    s_waitcnt lgkmcnt(3)
    v_mfma_f32_32x32x16_bf16 v[32:47], v[10:13], v[4:7], 0
    ds_read2st64_b64 v[10:13], v83 offset0:90 offset1:91
    v_exp_f32 v48, v48
    v_exp_f32 v49, v49
    v_exp_f32 v50, v50
    v_exp_f32 v51, v51
    v_exp_f32 v52, v52
    s_waitcnt lgkmcnt(1)
    v_mfma_f32_32x32x16_bf16 v[64:79], v[16:19], v[24:27], v[64:79]
    v_exp_f32 v53, v53
    v_exp_f32 v54, v54
    v_exp_f32 v55, v55
    v_cvt_pk_bf16_f32 v24, v48, v49
    v_cvt_pk_bf16_f32 v25, v50, v51
    v_cvt_pk_bf16_f32 v26, v52, v53
    v_cvt_pk_bf16_f32 v27, v54, v55
    v_mfma_f32_32x32x8bf16_1k v[32:47], v[14:15], v[8:9], v[32:47]
    ds_read_b64 v[14:15], v81 offset:46080
    v_exp_f32 v56, v56
    v_exp_f32 v57, v57
    v_exp_f32 v58, v58
    v_exp_f32 v59, v59
    v_exp_f32 v60, v60
    v_mfma_f32_32x32x16_bf16 v[64:79], v[20:23], v[28:31], v[64:79]
    s_mov_b64 exec, s[30:31]
    ds_read_b128 v[16:19], v80 offset:40960
    ds_read_b128 v[20:23], v84 offset:40960
    s_mov_b64 exec, -1
    buffer_load_dwordx4 v[172:175], v3, s[20:23], s65 offen offset:2048 sc1
    v_exp_f32 v61, v61
    v_exp_f32 v62, v62
    v_exp_f32 v63, v63
    v_cvt_pk_bf16_f32 v28, v56, v57
    v_cvt_pk_bf16_f32 v29, v58, v59
    v_cvt_pk_bf16_f32 v30, v60, v61
    v_cvt_pk_bf16_f32 v31, v62, v63
    s_setprio 1
Ltile40:
    s_waitcnt lgkmcnt(3)
    v_mfma_f32_32x32x16_bf16 v[48:63], v[10:13], v[4:7], 0
    ds_read2st64_b64 v[10:13], v83 offset0:95 offset1:96
    v_exp_f32 v32, v32
    v_exp_f32 v33, v33
    v_exp_f32 v34, v34
    v_exp_f32 v35, v35
    v_exp_f32 v36, v36
    s_waitcnt lgkmcnt(1)
    v_mfma_f32_32x32x16_bf16 v[64:79], v[16:19], v[24:27], v[64:79]
    v_exp_f32 v37, v37
    v_exp_f32 v38, v38
    v_exp_f32 v39, v39
    v_cvt_pk_bf16_f32 v24, v32, v33
    v_cvt_pk_bf16_f32 v25, v34, v35
    v_cvt_pk_bf16_f32 v26, v36, v37
    v_cvt_pk_bf16_f32 v27, v38, v39
    v_mfma_f32_32x32x8bf16_1k v[48:63], v[14:15], v[8:9], v[48:63]
    ds_read_b64 v[14:15], v81 offset:48640
    v_exp_f32 v40, v40
    v_exp_f32 v41, v41
    v_exp_f32 v42, v42
    v_exp_f32 v43, v43
    v_exp_f32 v44, v44
    v_mfma_f32_32x32x16_bf16 v[64:79], v[20:23], v[28:31], v[64:79]
    s_mov_b64 exec, s[30:31]
    ds_read_b128 v[16:19], v80 offset:43520
    ds_read_b128 v[20:23], v84 offset:43520
    s_mov_b64 exec, -1
    buffer_load_dwordx4 v[176:179], v3, s[20:23], s66 offen offset:2048 sc1
    v_exp_f32 v45, v45
    v_exp_f32 v46, v46
    v_exp_f32 v47, v47
    v_cvt_pk_bf16_f32 v28, v40, v41
    v_cvt_pk_bf16_f32 v29, v42, v43
    v_cvt_pk_bf16_f32 v30, v44, v45
    v_cvt_pk_bf16_f32 v31, v46, v47
Ltile41:
    s_waitcnt lgkmcnt(3)
    v_mfma_f32_32x32x16_bf16 v[32:47], v[10:13], v[4:7], 0
    ds_read2st64_b64 v[10:13], v83 offset0:100 offset1:101
    v_exp_f32 v48, v48
    v_exp_f32 v49, v49
    v_exp_f32 v50, v50
    v_exp_f32 v51, v51
    v_exp_f32 v52, v52
    s_waitcnt lgkmcnt(1)
    v_mfma_f32_32x32x16_bf16 v[64:79], v[16:19], v[24:27], v[64:79]
    v_exp_f32 v53, v53
    v_exp_f32 v54, v54
    v_exp_f32 v55, v55
    v_cvt_pk_bf16_f32 v24, v48, v49
    v_cvt_pk_bf16_f32 v25, v50, v51
    v_cvt_pk_bf16_f32 v26, v52, v53
    v_cvt_pk_bf16_f32 v27, v54, v55
    v_mfma_f32_32x32x8bf16_1k v[32:47], v[14:15], v[8:9], v[32:47]
    ds_read_b64 v[14:15], v81 offset:51200
    v_exp_f32 v56, v56
    v_exp_f32 v57, v57
    v_exp_f32 v58, v58
    v_exp_f32 v59, v59
    v_exp_f32 v60, v60
    v_mfma_f32_32x32x16_bf16 v[64:79], v[20:23], v[28:31], v[64:79]
    s_mov_b64 exec, s[30:31]
    ds_read_b128 v[16:19], v80 offset:46080
    ds_read_b128 v[20:23], v84 offset:46080
    s_mov_b64 exec, -1
    buffer_load_dwordx4 v[180:183], v3, s[20:23], s67 offen offset:2048 sc1
    v_exp_f32 v61, v61
    v_exp_f32 v62, v62
    v_exp_f32 v63, v63
    v_cvt_pk_bf16_f32 v28, v56, v57
    v_cvt_pk_bf16_f32 v29, v58, v59
    v_cvt_pk_bf16_f32 v30, v60, v61
    v_cvt_pk_bf16_f32 v31, v62, v63
    s_setprio 0
Ltile42:
    s_waitcnt lgkmcnt(3)
    v_mfma_f32_32x32x16_bf16 v[48:63], v[10:13], v[4:7], 0
    ds_read2st64_b64 v[10:13], v83 offset0:105 offset1:106
    v_exp_f32 v32, v32
    v_exp_f32 v33, v33
    v_exp_f32 v34, v34
    v_exp_f32 v35, v35
    v_exp_f32 v36, v36
    s_waitcnt lgkmcnt(1)
    v_mfma_f32_32x32x16_bf16 v[64:79], v[16:19], v[24:27], v[64:79]
    v_exp_f32 v37, v37
    v_exp_f32 v38, v38
    v_exp_f32 v39, v39
    v_cvt_pk_bf16_f32 v24, v32, v33
    v_cvt_pk_bf16_f32 v25, v34, v35
    v_cvt_pk_bf16_f32 v26, v36, v37
    v_cvt_pk_bf16_f32 v27, v38, v39
    v_mfma_f32_32x32x8bf16_1k v[48:63], v[14:15], v[8:9], v[48:63]
    ds_read_b64 v[14:15], v81 offset:53760
    v_exp_f32 v40, v40
    v_exp_f32 v41, v41
    v_exp_f32 v42, v42
    v_exp_f32 v43, v43
    v_exp_f32 v44, v44
    v_mfma_f32_32x32x16_bf16 v[64:79], v[20:23], v[28:31], v[64:79]
    s_mov_b64 exec, s[30:31]
    ds_read_b128 v[16:19], v80 offset:48640
    ds_read_b128 v[20:23], v84 offset:48640
    s_mov_b64 exec, -1
    buffer_load_dwordx4 v[184:187], v3, s[20:23], s68 offen offset:2048 sc1
    v_exp_f32 v45, v45
    v_exp_f32 v46, v46
    v_exp_f32 v47, v47
    v_cvt_pk_bf16_f32 v28, v40, v41
    v_cvt_pk_bf16_f32 v29, v42, v43
    v_cvt_pk_bf16_f32 v30, v44, v45
    v_cvt_pk_bf16_f32 v31, v46, v47
    s_barrier
    v_mov_b32 v85, 106496
    v_mov_b32 v86, 0
    ds_write_b32 v85, v86
    ds_write_b32 v85, v86 offset:4
    s_setprio 3
Ltile43:
    s_waitcnt lgkmcnt(3)
    v_mfma_f32_32x32x16_bf16 v[32:47], v[10:13], v[4:7], 0
    ds_read2st64_b64 v[10:13], v83 offset0:110 offset1:111
    v_exp_f32 v48, v48
    v_exp_f32 v49, v49
    v_exp_f32 v50, v50
    v_exp_f32 v51, v51
    v_exp_f32 v52, v52
    s_waitcnt lgkmcnt(1)
    v_mfma_f32_32x32x16_bf16 v[64:79], v[16:19], v[24:27], v[64:79]
    s_add_u32 m0, s76, 0
    s_add_u32 s73, s67, 4096
    buffer_load_dwordx4 v3, s[20:23], s73 offen sc1 lds
    v_exp_f32 v53, v53
    v_exp_f32 v54, v54
    v_exp_f32 v55, v55
    v_cvt_pk_bf16_f32 v24, v48, v49
    v_cvt_pk_bf16_f32 v25, v50, v51
    v_cvt_pk_bf16_f32 v26, v52, v53
    v_cvt_pk_bf16_f32 v27, v54, v55
    v_mfma_f32_32x32x8bf16_1k v[32:47], v[14:15], v[8:9], v[32:47]
    ds_read_b64 v[14:15], v81 offset:56320
    v_exp_f32 v56, v56
    v_exp_f32 v57, v57
    v_exp_f32 v58, v58
    v_exp_f32 v59, v59
    v_exp_f32 v60, v60
    v_mfma_f32_32x32x16_bf16 v[64:79], v[20:23], v[28:31], v[64:79]
    s_mov_b64 exec, s[30:31]
    ds_read_b128 v[16:19], v80 offset:51200
    ds_read_b128 v[20:23], v84 offset:51200
    s_mov_b64 exec, -1
    buffer_load_dwordx4 v[188:191], v3, s[20:23], s69 offen offset:2048 sc1
    v_exp_f32 v61, v61
    v_exp_f32 v62, v62
    v_exp_f32 v63, v63
    v_cvt_pk_bf16_f32 v28, v56, v57
    v_cvt_pk_bf16_f32 v29, v58, v59
    v_cvt_pk_bf16_f32 v30, v60, v61
    v_cvt_pk_bf16_f32 v31, v62, v63
Ltile44:
    s_waitcnt lgkmcnt(3)
    v_mfma_f32_32x32x16_bf16 v[48:63], v[10:13], v[4:7], 0
    ds_read2st64_b64 v[10:13], v83 offset0:115 offset1:116
    v_exp_f32 v32, v32
    v_exp_f32 v33, v33
    v_exp_f32 v34, v34
    v_exp_f32 v35, v35
    v_exp_f32 v36, v36
    s_waitcnt lgkmcnt(1)
    v_mfma_f32_32x32x16_bf16 v[64:79], v[16:19], v[24:27], v[64:79]
    s_add_u32 m0, s76, 1024
    s_add_u32 s73, s68, 4096
    buffer_load_dwordx4 v3, s[20:23], s73 offen sc1 lds
    v_exp_f32 v37, v37
    v_exp_f32 v38, v38
    v_exp_f32 v39, v39
    v_cvt_pk_bf16_f32 v24, v32, v33
    v_cvt_pk_bf16_f32 v25, v34, v35
    v_cvt_pk_bf16_f32 v26, v36, v37
    v_cvt_pk_bf16_f32 v27, v38, v39
    v_mfma_f32_32x32x8bf16_1k v[48:63], v[14:15], v[8:9], v[48:63]
    ds_read_b64 v[14:15], v81 offset:58880
    v_exp_f32 v40, v40
    v_exp_f32 v41, v41
    v_exp_f32 v42, v42
    v_exp_f32 v43, v43
    v_exp_f32 v44, v44
    v_mfma_f32_32x32x16_bf16 v[64:79], v[20:23], v[28:31], v[64:79]
    s_mov_b64 exec, s[30:31]
    ds_read_b128 v[16:19], v80 offset:53760
    ds_read_b128 v[20:23], v84 offset:53760
    s_mov_b64 exec, -1
    buffer_load_dwordx4 v[192:195], v3, s[20:23], s70 offen offset:2048 sc1
    v_exp_f32 v45, v45
    v_exp_f32 v46, v46
    v_exp_f32 v47, v47
    v_cvt_pk_bf16_f32 v28, v40, v41
    v_cvt_pk_bf16_f32 v29, v42, v43
    v_cvt_pk_bf16_f32 v30, v44, v45
    v_cvt_pk_bf16_f32 v31, v46, v47
Ltile45:
    s_waitcnt lgkmcnt(3)
    v_mfma_f32_32x32x16_bf16 v[32:47], v[10:13], v[4:7], 0
    ds_read2st64_b64 v[10:13], v83 offset0:120 offset1:121
    v_exp_f32 v48, v48
    v_exp_f32 v49, v49
    v_exp_f32 v50, v50
    v_exp_f32 v51, v51
    v_exp_f32 v52, v52
    s_waitcnt lgkmcnt(1)
    v_mfma_f32_32x32x16_bf16 v[64:79], v[16:19], v[24:27], v[64:79]
    s_add_u32 m0, s76, 2048
    s_add_u32 s73, s69, 4096
    buffer_load_dwordx4 v3, s[20:23], s73 offen sc1 lds
    v_exp_f32 v53, v53
    v_exp_f32 v54, v54
    v_exp_f32 v55, v55
    v_cvt_pk_bf16_f32 v24, v48, v49
    v_cvt_pk_bf16_f32 v25, v50, v51
    v_cvt_pk_bf16_f32 v26, v52, v53
    v_cvt_pk_bf16_f32 v27, v54, v55
    v_mfma_f32_32x32x8bf16_1k v[32:47], v[14:15], v[8:9], v[32:47]
    ds_read_b64 v[14:15], v81 offset:61440
    v_exp_f32 v56, v56
    v_exp_f32 v57, v57
    v_exp_f32 v58, v58
    v_exp_f32 v59, v59
    v_exp_f32 v60, v60
    v_mfma_f32_32x32x16_bf16 v[64:79], v[20:23], v[28:31], v[64:79]
    s_mov_b64 exec, s[30:31]
    ds_read_b128 v[16:19], v80 offset:56320
    ds_read_b128 v[20:23], v84 offset:56320
    s_mov_b64 exec, -1
    buffer_load_dwordx4 v[196:199], v3, s[20:23], s62 offen offset:3072 sc1
    v_exp_f32 v61, v61
    v_exp_f32 v62, v62
    v_exp_f32 v63, v63
    v_cvt_pk_bf16_f32 v28, v56, v57
    v_cvt_pk_bf16_f32 v29, v58, v59
    v_cvt_pk_bf16_f32 v30, v60, v61
    v_cvt_pk_bf16_f32 v31, v62, v63
    v_add_u32 v80, 58880, v80
    v_add_u32 v81, 58880, v81
    v_add_u32 v83, 58880, v83
    v_add_u32 v84, 58880, v84
Ltile46:
    s_waitcnt lgkmcnt(3)
    v_mfma_f32_32x32x16_bf16 v[48:63], v[10:13], v[4:7], 0
    ds_read2st64_b64 v[10:13], v83 offset0:10 offset1:11
    v_exp_f32 v32, v32
    v_exp_f32 v33, v33
    v_exp_f32 v34, v34
    v_exp_f32 v35, v35
    v_exp_f32 v36, v36
    s_waitcnt lgkmcnt(1)
    v_mfma_f32_32x32x16_bf16 v[64:79], v[16:19], v[24:27], v[64:79]
    s_add_u32 m0, s76, 3072
    s_add_u32 s73, s70, 4096
    buffer_load_dwordx4 v3, s[20:23], s73 offen sc1 lds
    v_exp_f32 v37, v37
    v_exp_f32 v38, v38
    v_exp_f32 v39, v39
    v_cvt_pk_bf16_f32 v24, v32, v33
    v_cvt_pk_bf16_f32 v25, v34, v35
    v_cvt_pk_bf16_f32 v26, v36, v37
    v_cvt_pk_bf16_f32 v27, v38, v39
    v_mfma_f32_32x32x8bf16_1k v[48:63], v[14:15], v[8:9], v[48:63]
    ds_read_b64 v[14:15], v81 offset:5120
    v_exp_f32 v40, v40
    v_exp_f32 v41, v41
    v_exp_f32 v42, v42
    v_exp_f32 v43, v43
    v_exp_f32 v44, v44
    v_mfma_f32_32x32x16_bf16 v[64:79], v[20:23], v[28:31], v[64:79]
    s_mov_b64 exec, s[30:31]
    ds_read_b128 v[16:19], v80 offset:0
    ds_read_b128 v[20:23], v84 offset:0
    s_mov_b64 exec, -1
    buffer_load_dwordx4 v[200:203], v3, s[20:23], s63 offen offset:3072 sc1
    v_exp_f32 v45, v45
    v_exp_f32 v46, v46
    v_exp_f32 v47, v47
    v_cvt_pk_bf16_f32 v28, v40, v41
    v_cvt_pk_bf16_f32 v29, v42, v43
    v_cvt_pk_bf16_f32 v30, v44, v45
    v_cvt_pk_bf16_f32 v31, v46, v47
Ltile47:
    s_waitcnt lgkmcnt(3)
    v_mfma_f32_32x32x16_bf16 v[32:47], v[10:13], v[4:7], 0
    ds_read2st64_b64 v[10:13], v83 offset0:15 offset1:16
    v_exp_f32 v48, v48
    v_exp_f32 v49, v49
    v_exp_f32 v50, v50
    v_exp_f32 v51, v51
    v_exp_f32 v52, v52
    s_waitcnt lgkmcnt(1)
    v_mfma_f32_32x32x16_bf16 v[64:79], v[16:19], v[24:27], v[64:79]
    s_add_u32 m0, s76, 4096
    s_add_u32 s73, s62, 5120
    buffer_load_dwordx4 v3, s[20:23], s73 offen sc1 lds
    v_exp_f32 v53, v53
    v_exp_f32 v54, v54
    v_exp_f32 v55, v55
    v_cvt_pk_bf16_f32 v24, v48, v49
    v_cvt_pk_bf16_f32 v25, v50, v51
    v_cvt_pk_bf16_f32 v26, v52, v53
    v_cvt_pk_bf16_f32 v27, v54, v55
    v_mfma_f32_32x32x8bf16_1k v[32:47], v[14:15], v[8:9], v[32:47]
    ds_read_b64 v[14:15], v81 offset:7680
    v_exp_f32 v56, v56
    v_exp_f32 v57, v57
    v_exp_f32 v58, v58
    v_exp_f32 v59, v59
    v_exp_f32 v60, v60
    v_mfma_f32_32x32x16_bf16 v[64:79], v[20:23], v[28:31], v[64:79]
    s_mov_b64 exec, s[30:31]
    ds_read_b128 v[16:19], v80 offset:2560
    ds_read_b128 v[20:23], v84 offset:2560
    s_mov_b64 exec, -1
    buffer_load_dwordx4 v[204:207], v3, s[20:23], s64 offen offset:3072 sc1
    v_exp_f32 v61, v61
    v_exp_f32 v62, v62
    v_exp_f32 v63, v63
    v_cvt_pk_bf16_f32 v28, v56, v57
    v_cvt_pk_bf16_f32 v29, v58, v59
    v_cvt_pk_bf16_f32 v30, v60, v61
    v_cvt_pk_bf16_f32 v31, v62, v63
Ltile48:
    s_waitcnt lgkmcnt(3)
    v_mfma_f32_32x32x16_bf16 v[48:63], v[10:13], v[4:7], 0
    ds_read2st64_b64 v[10:13], v83 offset0:20 offset1:21
    v_exp_f32 v32, v32
    v_exp_f32 v33, v33
    v_exp_f32 v34, v34
    v_exp_f32 v35, v35
    v_exp_f32 v36, v36
    s_waitcnt lgkmcnt(1)
    v_mfma_f32_32x32x16_bf16 v[64:79], v[16:19], v[24:27], v[64:79]
    s_add_u32 m0, s76, 5120
    s_add_u32 s73, s63, 5120
    buffer_load_dwordx4 v3, s[20:23], s73 offen sc1 lds
    v_exp_f32 v37, v37
    v_exp_f32 v38, v38
    v_exp_f32 v39, v39
    v_cvt_pk_bf16_f32 v24, v32, v33
    v_cvt_pk_bf16_f32 v25, v34, v35
    v_cvt_pk_bf16_f32 v26, v36, v37
    v_cvt_pk_bf16_f32 v27, v38, v39
    v_mfma_f32_32x32x8bf16_1k v[48:63], v[14:15], v[8:9], v[48:63]
    ds_read_b64 v[14:15], v81 offset:10240
    v_exp_f32 v40, v40
    v_exp_f32 v41, v41
    v_exp_f32 v42, v42
    v_exp_f32 v43, v43
    v_exp_f32 v44, v44
    v_mfma_f32_32x32x16_bf16 v[64:79], v[20:23], v[28:31], v[64:79]
    s_mov_b64 exec, s[30:31]
    ds_read_b128 v[16:19], v80 offset:5120
    ds_read_b128 v[20:23], v84 offset:5120
    s_mov_b64 exec, -1
    buffer_load_dwordx4 v[208:211], v3, s[20:23], s65 offen offset:3072 sc1
    v_exp_f32 v45, v45
    v_exp_f32 v46, v46
    v_exp_f32 v47, v47
    v_cvt_pk_bf16_f32 v28, v40, v41
    v_cvt_pk_bf16_f32 v29, v42, v43
    v_cvt_pk_bf16_f32 v30, v44, v45
    v_cvt_pk_bf16_f32 v31, v46, v47
Ltile49:
    s_waitcnt lgkmcnt(3)
    v_mfma_f32_32x32x16_bf16 v[32:47], v[10:13], v[4:7], 0
    ds_read2st64_b64 v[10:13], v83 offset0:25 offset1:26
    v_exp_f32 v48, v48
    v_exp_f32 v49, v49
    v_exp_f32 v50, v50
    v_exp_f32 v51, v51
    v_exp_f32 v52, v52
    s_waitcnt lgkmcnt(1)
    v_mfma_f32_32x32x16_bf16 v[64:79], v[16:19], v[24:27], v[64:79]
    s_add_u32 m0, s76, 6144
    s_add_u32 s73, s64, 5120
    buffer_load_dwordx4 v3, s[20:23], s73 offen sc1 lds
    v_exp_f32 v53, v53
    v_exp_f32 v54, v54
    v_exp_f32 v55, v55
    v_cvt_pk_bf16_f32 v24, v48, v49
    v_cvt_pk_bf16_f32 v25, v50, v51
    v_cvt_pk_bf16_f32 v26, v52, v53
    v_cvt_pk_bf16_f32 v27, v54, v55
    v_mfma_f32_32x32x8bf16_1k v[32:47], v[14:15], v[8:9], v[32:47]
    ds_read_b64 v[14:15], v81 offset:12800
    v_exp_f32 v56, v56
    v_exp_f32 v57, v57
    v_exp_f32 v58, v58
    v_exp_f32 v59, v59
    v_exp_f32 v60, v60
    v_mfma_f32_32x32x16_bf16 v[64:79], v[20:23], v[28:31], v[64:79]
    s_mov_b64 exec, s[30:31]
    ds_read_b128 v[16:19], v80 offset:7680
    ds_read_b128 v[20:23], v84 offset:7680
    s_mov_b64 exec, -1
    buffer_load_dwordx4 v[212:215], v3, s[20:23], s66 offen offset:3072 sc1
    v_exp_f32 v61, v61
    v_exp_f32 v62, v62
    v_exp_f32 v63, v63
    v_cvt_pk_bf16_f32 v28, v56, v57
    v_cvt_pk_bf16_f32 v29, v58, v59
    v_cvt_pk_bf16_f32 v30, v60, v61
    v_cvt_pk_bf16_f32 v31, v62, v63
Ltile50:
    s_waitcnt lgkmcnt(3)
    v_mfma_f32_32x32x16_bf16 v[48:63], v[10:13], v[4:7], 0
    ds_read2st64_b64 v[10:13], v83 offset0:30 offset1:31
    v_exp_f32 v32, v32
    v_exp_f32 v33, v33
    v_exp_f32 v34, v34
    v_exp_f32 v35, v35
    v_exp_f32 v36, v36
    s_waitcnt lgkmcnt(1)
    v_mfma_f32_32x32x16_bf16 v[64:79], v[16:19], v[24:27], v[64:79]
    s_add_u32 m0, s76, 7168
    s_add_u32 s73, s65, 5120
    buffer_load_dwordx4 v3, s[20:23], s73 offen sc1 lds
    v_exp_f32 v37, v37
    v_exp_f32 v38, v38
    v_exp_f32 v39, v39
    v_cvt_pk_bf16_f32 v24, v32, v33
    v_cvt_pk_bf16_f32 v25, v34, v35
    v_cvt_pk_bf16_f32 v26, v36, v37
    v_cvt_pk_bf16_f32 v27, v38, v39
    v_mfma_f32_32x32x8bf16_1k v[48:63], v[14:15], v[8:9], v[48:63]
    ds_read_b64 v[14:15], v81 offset:15360
    v_exp_f32 v40, v40
    v_exp_f32 v41, v41
    v_exp_f32 v42, v42
    v_exp_f32 v43, v43
    v_exp_f32 v44, v44
    v_mfma_f32_32x32x16_bf16 v[64:79], v[20:23], v[28:31], v[64:79]
    s_mov_b64 exec, s[30:31]
    ds_read_b128 v[16:19], v80 offset:10240
    ds_read_b128 v[20:23], v84 offset:10240
    s_mov_b64 exec, -1
    buffer_load_dwordx4 v[216:219], v3, s[20:23], s67 offen offset:3072 sc1
    v_exp_f32 v45, v45
    v_exp_f32 v46, v46
    v_exp_f32 v47, v47
    v_cvt_pk_bf16_f32 v28, v40, v41
    v_cvt_pk_bf16_f32 v29, v42, v43
    v_cvt_pk_bf16_f32 v30, v44, v45
    v_cvt_pk_bf16_f32 v31, v46, v47
Ltile51:
    s_waitcnt lgkmcnt(3)
    v_mfma_f32_32x32x16_bf16 v[32:47], v[10:13], v[4:7], 0
    ds_read2st64_b64 v[10:13], v83 offset0:35 offset1:36
    v_exp_f32 v48, v48
    v_exp_f32 v49, v49
    v_exp_f32 v50, v50
    v_exp_f32 v51, v51
    v_exp_f32 v52, v52
    s_waitcnt lgkmcnt(1)
    v_mfma_f32_32x32x16_bf16 v[64:79], v[16:19], v[24:27], v[64:79]
    s_add_u32 m0, s76, 8192
    s_add_u32 s73, s66, 5120
    buffer_load_dwordx4 v3, s[20:23], s73 offen sc1 lds
    v_exp_f32 v53, v53
    v_exp_f32 v54, v54
    v_exp_f32 v55, v55
    v_cvt_pk_bf16_f32 v24, v48, v49
    v_cvt_pk_bf16_f32 v25, v50, v51
    v_cvt_pk_bf16_f32 v26, v52, v53
    v_cvt_pk_bf16_f32 v27, v54, v55
    v_mfma_f32_32x32x8bf16_1k v[32:47], v[14:15], v[8:9], v[32:47]
    ds_read_b64 v[14:15], v81 offset:17920
    v_exp_f32 v56, v56
    v_exp_f32 v57, v57
    v_exp_f32 v58, v58
    v_exp_f32 v59, v59
    v_exp_f32 v60, v60
    v_mfma_f32_32x32x16_bf16 v[64:79], v[20:23], v[28:31], v[64:79]
    s_mov_b64 exec, s[30:31]
    ds_read_b128 v[16:19], v80 offset:12800
    ds_read_b128 v[20:23], v84 offset:12800
    s_mov_b64 exec, -1
    buffer_load_dwordx4 v[220:223], v3, s[20:23], s68 offen offset:3072 sc1
    v_exp_f32 v61, v61
    v_exp_f32 v62, v62
    v_exp_f32 v63, v63
    v_cvt_pk_bf16_f32 v28, v56, v57
    v_cvt_pk_bf16_f32 v29, v58, v59
    v_cvt_pk_bf16_f32 v30, v60, v61
    v_cvt_pk_bf16_f32 v31, v62, v63
Ltile52:
    s_waitcnt lgkmcnt(3)
    v_mfma_f32_32x32x16_bf16 v[48:63], v[10:13], v[4:7], 0
    ds_read2st64_b64 v[10:13], v83 offset0:40 offset1:41
    v_exp_f32 v32, v32
    v_exp_f32 v33, v33
    v_exp_f32 v34, v34
    v_exp_f32 v35, v35
    v_exp_f32 v36, v36
    s_waitcnt lgkmcnt(1)
    v_mfma_f32_32x32x16_bf16 v[64:79], v[16:19], v[24:27], v[64:79]
    s_add_u32 m0, s76, 9216
    s_add_u32 s73, s67, 5120
    buffer_load_dwordx4 v3, s[20:23], s73 offen sc1 lds
    v_exp_f32 v37, v37
    v_exp_f32 v38, v38
    v_exp_f32 v39, v39
    v_cvt_pk_bf16_f32 v24, v32, v33
    v_cvt_pk_bf16_f32 v25, v34, v35
    v_cvt_pk_bf16_f32 v26, v36, v37
    v_cvt_pk_bf16_f32 v27, v38, v39
    v_mfma_f32_32x32x8bf16_1k v[48:63], v[14:15], v[8:9], v[48:63]
    ds_read_b64 v[14:15], v81 offset:20480
    v_exp_f32 v40, v40
    v_exp_f32 v41, v41
    v_exp_f32 v42, v42
    v_exp_f32 v43, v43
    v_exp_f32 v44, v44
    v_mfma_f32_32x32x16_bf16 v[64:79], v[20:23], v[28:31], v[64:79]
    s_mov_b64 exec, s[30:31]
    ds_read_b128 v[16:19], v80 offset:15360
    ds_read_b128 v[20:23], v84 offset:15360
    s_mov_b64 exec, -1
    buffer_load_dwordx4 v[224:227], v3, s[20:23], s69 offen offset:3072 sc1
    v_exp_f32 v45, v45
    v_exp_f32 v46, v46
    v_exp_f32 v47, v47
    v_cvt_pk_bf16_f32 v28, v40, v41
    v_cvt_pk_bf16_f32 v29, v42, v43
    v_cvt_pk_bf16_f32 v30, v44, v45
    v_cvt_pk_bf16_f32 v31, v46, v47
Ltile53:
    s_waitcnt lgkmcnt(3)
    v_mfma_f32_32x32x16_bf16 v[32:47], v[10:13], v[4:7], 0
    ds_read2st64_b64 v[10:13], v83 offset0:45 offset1:46
    v_exp_f32 v48, v48
    v_exp_f32 v49, v49
    v_exp_f32 v50, v50
    v_exp_f32 v51, v51
    v_exp_f32 v52, v52
    s_waitcnt lgkmcnt(1)
    v_mfma_f32_32x32x16_bf16 v[64:79], v[16:19], v[24:27], v[64:79]
    s_add_u32 m0, s76, 10240
    s_add_u32 s73, s68, 5120
    buffer_load_dwordx4 v3, s[20:23], s73 offen sc1 lds
    v_exp_f32 v53, v53
    v_exp_f32 v54, v54
    v_exp_f32 v55, v55
    v_cvt_pk_bf16_f32 v24, v48, v49
    v_cvt_pk_bf16_f32 v25, v50, v51
    v_cvt_pk_bf16_f32 v26, v52, v53
    v_cvt_pk_bf16_f32 v27, v54, v55
    v_mfma_f32_32x32x8bf16_1k v[32:47], v[14:15], v[8:9], v[32:47]
    ds_read_b64 v[14:15], v81 offset:23040
    v_exp_f32 v56, v56
    v_exp_f32 v57, v57
    v_exp_f32 v58, v58
    v_exp_f32 v59, v59
    v_exp_f32 v60, v60
    v_mfma_f32_32x32x16_bf16 v[64:79], v[20:23], v[28:31], v[64:79]
    s_mov_b64 exec, s[30:31]
    ds_read_b128 v[16:19], v80 offset:17920
    ds_read_b128 v[20:23], v84 offset:17920
    s_mov_b64 exec, -1
    buffer_load_dwordx4 v[228:231], v3, s[20:23], s70 offen offset:3072 sc1
    v_exp_f32 v61, v61
    v_exp_f32 v62, v62
    v_exp_f32 v63, v63
    v_cvt_pk_bf16_f32 v28, v56, v57
    v_cvt_pk_bf16_f32 v29, v58, v59
    v_cvt_pk_bf16_f32 v30, v60, v61
    v_cvt_pk_bf16_f32 v31, v62, v63
Ltile54:
    s_waitcnt lgkmcnt(3)
    v_mfma_f32_32x32x16_bf16 v[48:63], v[10:13], v[4:7], 0
    ds_read2st64_b64 v[10:13], v83 offset0:50 offset1:51
    v_exp_f32 v32, v32
    v_exp_f32 v33, v33
    v_exp_f32 v34, v34
    v_exp_f32 v35, v35
    v_exp_f32 v36, v36
    s_waitcnt lgkmcnt(1)
    v_mfma_f32_32x32x16_bf16 v[64:79], v[16:19], v[24:27], v[64:79]
    s_add_u32 m0, s76, 11264
    s_add_u32 s73, s69, 5120
    buffer_load_dwordx4 v3, s[20:23], s73 offen sc1 lds
    v_exp_f32 v37, v37
    v_exp_f32 v38, v38
    v_exp_f32 v39, v39
    v_cvt_pk_bf16_f32 v24, v32, v33
    v_cvt_pk_bf16_f32 v25, v34, v35
    v_cvt_pk_bf16_f32 v26, v36, v37
    v_cvt_pk_bf16_f32 v27, v38, v39
    v_mfma_f32_32x32x8bf16_1k v[48:63], v[14:15], v[8:9], v[48:63]
    ds_read_b64 v[14:15], v81 offset:25600
    v_exp_f32 v40, v40
    v_exp_f32 v41, v41
    v_exp_f32 v42, v42
    v_exp_f32 v43, v43
    v_exp_f32 v44, v44
    v_mfma_f32_32x32x16_bf16 v[64:79], v[20:23], v[28:31], v[64:79]
    s_mov_b64 exec, s[30:31]
    ds_read_b128 v[16:19], v80 offset:20480
    ds_read_b128 v[20:23], v84 offset:20480
    s_mov_b64 exec, -1
    s_add_u32 s73, s62, 4096
    buffer_load_dwordx4 v[232:235], v3, s[20:23], s73 offen sc1
    v_exp_f32 v45, v45
    v_exp_f32 v46, v46
    v_exp_f32 v47, v47
    v_cvt_pk_bf16_f32 v28, v40, v41
    v_cvt_pk_bf16_f32 v29, v42, v43
    v_cvt_pk_bf16_f32 v30, v44, v45
    v_cvt_pk_bf16_f32 v31, v46, v47
Ltile55:
    s_waitcnt lgkmcnt(3)
    v_mfma_f32_32x32x16_bf16 v[32:47], v[10:13], v[4:7], 0
    ds_read2st64_b64 v[10:13], v83 offset0:55 offset1:56
    v_exp_f32 v48, v48
    v_exp_f32 v49, v49
    v_exp_f32 v50, v50
    v_exp_f32 v51, v51
    v_exp_f32 v52, v52
    s_waitcnt lgkmcnt(1)
    v_mfma_f32_32x32x16_bf16 v[64:79], v[16:19], v[24:27], v[64:79]
    s_add_u32 m0, s76, 12288
    s_add_u32 s73, s70, 5120
    buffer_load_dwordx4 v3, s[20:23], s73 offen sc1 lds
    v_exp_f32 v53, v53
    v_exp_f32 v54, v54
    v_exp_f32 v55, v55
    v_cvt_pk_bf16_f32 v24, v48, v49
    v_cvt_pk_bf16_f32 v25, v50, v51
    v_cvt_pk_bf16_f32 v26, v52, v53
    v_cvt_pk_bf16_f32 v27, v54, v55
    v_mfma_f32_32x32x8bf16_1k v[32:47], v[14:15], v[8:9], v[32:47]
    ds_read_b64 v[14:15], v81 offset:28160
    v_exp_f32 v56, v56
    v_exp_f32 v57, v57
    v_exp_f32 v58, v58
    v_exp_f32 v59, v59
    v_exp_f32 v60, v60
    v_mfma_f32_32x32x16_bf16 v[64:79], v[20:23], v[28:31], v[64:79]
    s_mov_b64 exec, s[30:31]
    ds_read_b128 v[16:19], v80 offset:23040
    ds_read_b128 v[20:23], v84 offset:23040
    s_mov_b64 exec, -1
    s_add_u32 s73, s63, 4096
    buffer_load_dwordx4 v[236:239], v3, s[20:23], s73 offen sc1
    v_exp_f32 v61, v61
    v_exp_f32 v62, v62
    v_exp_f32 v63, v63
    v_cvt_pk_bf16_f32 v28, v56, v57
    v_cvt_pk_bf16_f32 v29, v58, v59
    v_cvt_pk_bf16_f32 v30, v60, v61
    v_cvt_pk_bf16_f32 v31, v62, v63
    s_setprio 2
Ltile56:
    s_waitcnt lgkmcnt(3)
    v_mfma_f32_32x32x16_bf16 v[48:63], v[10:13], v[4:7], 0
    ds_read2st64_b64 v[10:13], v83 offset0:60 offset1:61
    v_exp_f32 v32, v32
    v_exp_f32 v33, v33
    v_exp_f32 v34, v34
    v_exp_f32 v35, v35
    v_exp_f32 v36, v36
    s_waitcnt lgkmcnt(1)
    v_mfma_f32_32x32x16_bf16 v[64:79], v[16:19], v[24:27], v[64:79]
    v_exp_f32 v37, v37
    v_exp_f32 v38, v38
    v_exp_f32 v39, v39
    v_cvt_pk_bf16_f32 v24, v32, v33
    v_cvt_pk_bf16_f32 v25, v34, v35
    v_cvt_pk_bf16_f32 v26, v36, v37
    v_cvt_pk_bf16_f32 v27, v38, v39
    v_mfma_f32_32x32x8bf16_1k v[48:63], v[14:15], v[8:9], v[48:63]
    ds_read_b64 v[14:15], v81 offset:30720
    v_exp_f32 v40, v40
    v_exp_f32 v41, v41
    v_exp_f32 v42, v42
    v_exp_f32 v43, v43
    v_exp_f32 v44, v44
    v_mfma_f32_32x32x16_bf16 v[64:79], v[20:23], v[28:31], v[64:79]
    s_mov_b64 exec, s[30:31]
    ds_read_b128 v[16:19], v80 offset:25600
    ds_read_b128 v[20:23], v84 offset:25600
    s_mov_b64 exec, -1
    s_add_u32 s73, s64, 4096
    buffer_load_dwordx4 v[240:243], v3, s[20:23], s73 offen sc1
    v_exp_f32 v45, v45
    v_exp_f32 v46, v46
    v_exp_f32 v47, v47
    v_cvt_pk_bf16_f32 v28, v40, v41
    v_cvt_pk_bf16_f32 v29, v42, v43
    v_cvt_pk_bf16_f32 v30, v44, v45
    v_cvt_pk_bf16_f32 v31, v46, v47
Ltile57:
    s_waitcnt lgkmcnt(3)
    v_mfma_f32_32x32x16_bf16 v[32:47], v[10:13], v[4:7], 0
    ds_read2st64_b64 v[10:13], v83 offset0:65 offset1:66
    v_exp_f32 v48, v48
    v_exp_f32 v49, v49
    v_exp_f32 v50, v50
    v_exp_f32 v51, v51
    v_exp_f32 v52, v52
    s_waitcnt lgkmcnt(1)
    v_mfma_f32_32x32x16_bf16 v[64:79], v[16:19], v[24:27], v[64:79]
    v_exp_f32 v53, v53
    v_exp_f32 v54, v54
    v_exp_f32 v55, v55
    v_cvt_pk_bf16_f32 v24, v48, v49
    v_cvt_pk_bf16_f32 v25, v50, v51
    v_cvt_pk_bf16_f32 v26, v52, v53
    v_cvt_pk_bf16_f32 v27, v54, v55
    v_mfma_f32_32x32x8bf16_1k v[32:47], v[14:15], v[8:9], v[32:47]
    ds_read_b64 v[14:15], v81 offset:33280
    v_exp_f32 v56, v56
    v_exp_f32 v57, v57
    v_exp_f32 v58, v58
    v_exp_f32 v59, v59
    v_exp_f32 v60, v60
    v_mfma_f32_32x32x16_bf16 v[64:79], v[20:23], v[28:31], v[64:79]
    s_mov_b64 exec, s[30:31]
    ds_read_b128 v[16:19], v80 offset:28160
    ds_read_b128 v[20:23], v84 offset:28160
    s_mov_b64 exec, -1
    s_add_u32 s73, s65, 4096
    buffer_load_dwordx4 v[244:247], v3, s[20:23], s73 offen sc1
    v_exp_f32 v61, v61
    v_exp_f32 v62, v62
    v_exp_f32 v63, v63
    v_cvt_pk_bf16_f32 v28, v56, v57
    v_cvt_pk_bf16_f32 v29, v58, v59
    v_cvt_pk_bf16_f32 v30, v60, v61
    v_cvt_pk_bf16_f32 v31, v62, v63
Ltile58:
    s_waitcnt lgkmcnt(3)
    v_mfma_f32_32x32x16_bf16 v[48:63], v[10:13], v[4:7], 0
    ds_read2st64_b64 v[10:13], v83 offset0:70 offset1:71
    v_exp_f32 v32, v32
    v_exp_f32 v33, v33
    v_exp_f32 v34, v34
    v_exp_f32 v35, v35
    v_exp_f32 v36, v36
    s_waitcnt lgkmcnt(1)
    v_mfma_f32_32x32x16_bf16 v[64:79], v[16:19], v[24:27], v[64:79]
    v_exp_f32 v37, v37
    v_exp_f32 v38, v38
    v_exp_f32 v39, v39
    v_cvt_pk_bf16_f32 v24, v32, v33
    v_cvt_pk_bf16_f32 v25, v34, v35
    v_cvt_pk_bf16_f32 v26, v36, v37
    v_cvt_pk_bf16_f32 v27, v38, v39
    v_mfma_f32_32x32x8bf16_1k v[48:63], v[14:15], v[8:9], v[48:63]
    ds_read_b64 v[14:15], v81 offset:35840
    v_exp_f32 v40, v40
    v_exp_f32 v41, v41
    v_exp_f32 v42, v42
    v_exp_f32 v43, v43
    v_exp_f32 v44, v44
    v_mfma_f32_32x32x16_bf16 v[64:79], v[20:23], v[28:31], v[64:79]
    s_mov_b64 exec, s[30:31]
    ds_read_b128 v[16:19], v80 offset:30720
    ds_read_b128 v[20:23], v84 offset:30720
    s_mov_b64 exec, -1
    s_add_u32 s73, s66, 4096
    buffer_load_dwordx4 v[248:251], v3, s[20:23], s73 offen sc1
    v_exp_f32 v45, v45
    v_exp_f32 v46, v46
    v_exp_f32 v47, v47
    v_cvt_pk_bf16_f32 v28, v40, v41
    v_cvt_pk_bf16_f32 v29, v42, v43
    v_cvt_pk_bf16_f32 v30, v44, v45
    v_cvt_pk_bf16_f32 v31, v46, v47
Ltile59:
    s_waitcnt lgkmcnt(3)
    v_mfma_f32_32x32x16_bf16 v[32:47], v[10:13], v[4:7], 0
    ds_read2st64_b64 v[10:13], v83 offset0:75 offset1:76
    v_exp_f32 v48, v48
    v_exp_f32 v49, v49
    v_exp_f32 v50, v50
    v_exp_f32 v51, v51
    v_exp_f32 v52, v52
    s_waitcnt lgkmcnt(1)
    v_mfma_f32_32x32x16_bf16 v[64:79], v[16:19], v[24:27], v[64:79]
    v_exp_f32 v53, v53
    v_exp_f32 v54, v54
    v_exp_f32 v55, v55
    v_cvt_pk_bf16_f32 v24, v48, v49
    v_cvt_pk_bf16_f32 v25, v50, v51
    v_cvt_pk_bf16_f32 v26, v52, v53
    v_cvt_pk_bf16_f32 v27, v54, v55
    v_mfma_f32_32x32x8bf16_1k v[32:47], v[14:15], v[8:9], v[32:47]
    ds_read_b64 v[14:15], v81 offset:38400
    v_exp_f32 v56, v56
    v_exp_f32 v57, v57
    v_exp_f32 v58, v58
    v_exp_f32 v59, v59
    v_exp_f32 v60, v60
    v_mfma_f32_32x32x16_bf16 v[64:79], v[20:23], v[28:31], v[64:79]
    s_mov_b64 exec, s[30:31]
    ds_read_b128 v[16:19], v80 offset:33280
    ds_read_b128 v[20:23], v84 offset:33280
    s_mov_b64 exec, -1
    v_exp_f32 v61, v61
    v_exp_f32 v62, v62
    v_exp_f32 v63, v63
    v_cvt_pk_bf16_f32 v28, v56, v57
    v_cvt_pk_bf16_f32 v29, v58, v59
    v_cvt_pk_bf16_f32 v30, v60, v61
    v_cvt_pk_bf16_f32 v31, v62, v63
Ltile60:
    s_waitcnt lgkmcnt(3)
    v_mfma_f32_32x32x16_bf16 v[48:63], v[10:13], v[4:7], 0
    ds_read2st64_b64 v[10:13], v83 offset0:80 offset1:81
    v_exp_f32 v32, v32
    v_exp_f32 v33, v33
    v_exp_f32 v34, v34
    v_exp_f32 v35, v35
    v_exp_f32 v36, v36
    s_waitcnt lgkmcnt(1)
    v_mfma_f32_32x32x16_bf16 v[64:79], v[16:19], v[24:27], v[64:79]
    v_exp_f32 v37, v37
    v_exp_f32 v38, v38
    v_exp_f32 v39, v39
    v_cvt_pk_bf16_f32 v24, v32, v33
    v_cvt_pk_bf16_f32 v25, v34, v35
    v_cvt_pk_bf16_f32 v26, v36, v37
    v_cvt_pk_bf16_f32 v27, v38, v39
    v_mfma_f32_32x32x8bf16_1k v[48:63], v[14:15], v[8:9], v[48:63]
    ds_read_b64 v[14:15], v81 offset:40960
    v_exp_f32 v40, v40
    v_exp_f32 v41, v41
    v_exp_f32 v42, v42
    v_exp_f32 v43, v43
    v_exp_f32 v44, v44
    v_mfma_f32_32x32x16_bf16 v[64:79], v[20:23], v[28:31], v[64:79]
    s_mov_b64 exec, s[30:31]
    ds_read_b128 v[16:19], v80 offset:35840
    ds_read_b128 v[20:23], v84 offset:35840
    s_mov_b64 exec, -1
    v_exp_f32 v45, v45
    v_exp_f32 v46, v46
    v_exp_f32 v47, v47
    v_cvt_pk_bf16_f32 v28, v40, v41
    v_cvt_pk_bf16_f32 v29, v42, v43
    v_cvt_pk_bf16_f32 v30, v44, v45
    v_cvt_pk_bf16_f32 v31, v46, v47
    s_setprio 1
Ltile61:
    s_waitcnt lgkmcnt(3)
    v_mfma_f32_32x32x16_bf16 v[32:47], v[10:13], v[4:7], 0
    ds_read2st64_b64 v[10:13], v83 offset0:85 offset1:86
    v_exp_f32 v48, v48
    v_exp_f32 v49, v49
    v_exp_f32 v50, v50
    v_exp_f32 v51, v51
    v_exp_f32 v52, v52
    s_waitcnt lgkmcnt(1)
    v_mfma_f32_32x32x16_bf16 v[64:79], v[16:19], v[24:27], v[64:79]
    v_exp_f32 v53, v53
    v_exp_f32 v54, v54
    v_exp_f32 v55, v55
    v_cvt_pk_bf16_f32 v24, v48, v49
    v_cvt_pk_bf16_f32 v25, v50, v51
    v_cvt_pk_bf16_f32 v26, v52, v53
    v_cvt_pk_bf16_f32 v27, v54, v55
    v_mfma_f32_32x32x8bf16_1k v[32:47], v[14:15], v[8:9], v[32:47]
    ds_read_b64 v[14:15], v81 offset:43520
    v_exp_f32 v56, v56
    v_exp_f32 v57, v57
    v_exp_f32 v58, v58
    v_exp_f32 v59, v59
    v_exp_f32 v60, v60
    v_mfma_f32_32x32x16_bf16 v[64:79], v[20:23], v[28:31], v[64:79]
    s_mov_b64 exec, s[30:31]
    ds_read_b128 v[16:19], v80 offset:38400
    ds_read_b128 v[20:23], v84 offset:38400
    s_mov_b64 exec, -1
    v_exp_f32 v61, v61
    v_exp_f32 v62, v62
    v_exp_f32 v63, v63
    v_cvt_pk_bf16_f32 v28, v56, v57
    v_cvt_pk_bf16_f32 v29, v58, v59
    v_cvt_pk_bf16_f32 v30, v60, v61
    v_cvt_pk_bf16_f32 v31, v62, v63
Ltile62:
    s_waitcnt lgkmcnt(2)
    v_mfma_f32_32x32x16_bf16 v[48:63], v[10:13], v[4:7], 0
    v_exp_f32 v32, v32
    v_exp_f32 v33, v33
    v_exp_f32 v34, v34
    v_exp_f32 v35, v35
    v_exp_f32 v36, v36
    s_waitcnt lgkmcnt(0)
    v_mfma_f32_32x32x16_bf16 v[64:79], v[16:19], v[24:27], v[64:79]
    v_exp_f32 v37, v37
    v_exp_f32 v38, v38
    v_exp_f32 v39, v39
    v_cvt_pk_bf16_f32 v24, v32, v33
    v_cvt_pk_bf16_f32 v25, v34, v35
    v_cvt_pk_bf16_f32 v26, v36, v37
    v_cvt_pk_bf16_f32 v27, v38, v39
    v_mfma_f32_32x32x8bf16_1k v[48:63], v[14:15], v[8:9], v[48:63]
    v_exp_f32 v40, v40
    v_exp_f32 v41, v41
    v_exp_f32 v42, v42
    v_exp_f32 v43, v43
    v_exp_f32 v44, v44
    v_mfma_f32_32x32x16_bf16 v[64:79], v[20:23], v[28:31], v[64:79]
    s_mov_b64 exec, s[30:31]
    ds_read_b128 v[16:19], v80 offset:40960
    ds_read_b128 v[20:23], v84 offset:40960
    s_mov_b64 exec, -1
    v_exp_f32 v45, v45
    v_exp_f32 v46, v46
    v_exp_f32 v47, v47
    v_cvt_pk_bf16_f32 v28, v40, v41
    v_cvt_pk_bf16_f32 v29, v42, v43
    v_cvt_pk_bf16_f32 v30, v44, v45
    v_cvt_pk_bf16_f32 v31, v46, v47
    s_setprio 0
Ltile63:
    v_exp_f32 v48, v48
    v_exp_f32 v49, v49
    v_exp_f32 v50, v50
    v_exp_f32 v51, v51
    v_exp_f32 v52, v52
    s_waitcnt lgkmcnt(0)
    v_mfma_f32_32x32x16_bf16 v[64:79], v[16:19], v[24:27], v[64:79]
    v_exp_f32 v53, v53
    v_exp_f32 v54, v54
    v_exp_f32 v55, v55
    v_cvt_pk_bf16_f32 v24, v48, v49
    v_cvt_pk_bf16_f32 v25, v50, v51
    v_cvt_pk_bf16_f32 v26, v52, v53
    v_cvt_pk_bf16_f32 v27, v54, v55
    v_exp_f32 v56, v56
    v_exp_f32 v57, v57
    v_exp_f32 v58, v58
    v_exp_f32 v59, v59
    v_exp_f32 v60, v60
    v_mfma_f32_32x32x16_bf16 v[64:79], v[20:23], v[28:31], v[64:79]
    s_mov_b64 exec, s[30:31]
    ds_read_b128 v[16:19], v80 offset:43520
    ds_read_b128 v[20:23], v84 offset:43520
    s_mov_b64 exec, -1
    v_exp_f32 v61, v61
    v_exp_f32 v62, v62
    v_exp_f32 v63, v63
    v_cvt_pk_bf16_f32 v28, v56, v57
    v_cvt_pk_bf16_f32 v29, v58, v59
    v_cvt_pk_bf16_f32 v30, v60, v61
    v_cvt_pk_bf16_f32 v31, v62, v63
    s_waitcnt lgkmcnt(0)
    v_mfma_f32_32x32x16_bf16 v[64:79], v[16:19], v[24:27], v[64:79]
    v_mfma_f32_32x32x16_bf16 v[64:79], v[20:23], v[28:31], v[64:79]
Lattend:
    s_mul_i32 s48, s19, 139264
    s_add_u32 s48, s48, 10485760
    s_lshl_b32 s50, s18, 9
    s_add_u32 s50, s50, s48
    s_lshl_b32 s49, s18, 7
    s_add_u32 s49, s49, s48
    s_add_u32 s49, s49, 16384
    v_lshrrev_b32 v36, 4, v1
    v_mul_u32_u24 v36, 69632, v36
    v_and_b32 v37, 15, v1
    v_lshl_add_u32 v38, v37, 3, v36
    v_lshl_add_u32 v36, v37, 4, v36
    v_lshl_add_u32 v39, v2, 8, v36
    s_lshr_b32 s51, s19, 3
    s_lshl_b32 s51, s51, 12
    s_lshl_b32 s48, s18, 2
    s_add_u32 s51, s51, s48
    s_add_u32 s51, s51, 22192128
    s_mov_b32 s54, 0x71800000
    s_mov_b32 s55, 0x2b800000
    s_nop 3
    v_mov_b32 v32, v72
    v_mov_b32 v33, v72
    s_nop 1
    v_permlane32_swap_b32 v32, v33
    v_add_f32 v34, abs(v64), abs(v65)
    v_add_f32 v35, abs(v66), v33
    v_add_f32 v35, abs(v67), v35
    v_add_f32 v34, abs(v68), v34
    v_add_f32 v35, abs(v69), v35
    v_add_f32 v34, abs(v70), v34
    v_add_f32 v35, abs(v71), v35
    v_add_f32 v34, abs(v72), v34
    v_add_f32 v35, abs(v73), v35
    v_add_f32 v34, abs(v74), v34
    v_add_f32 v35, abs(v75), v35
    v_add_f32 v34, v34, v35
    v_cmp_nge_f32 s[56:57], v33, s55
    v_cmp_nle_f32 vcc, v34, s54
    s_or_b64 vcc, vcc, s[56:57]
    s_cbranch_vccnz Lk2fb_24
Lk2fin_23:
    v_rcp_f32 v33, v33
    s_nop 0
    v_mul_f32 v33, v82, v33
    v_mul_f32 v64, v33, v64
    v_mul_f32 v65, v33, v65
    v_mul_f32 v66, v33, v66
    v_mul_f32 v67, v33, v67
    v_mul_f32 v68, v33, v68
    v_mul_f32 v69, v33, v69
    v_mul_f32 v70, v33, v70
    v_mul_f32 v71, v33, v71
    v_mul_f32 v72, v33, v72
    v_mul_f32 v73, v33, v73
    v_mul_f32 v74, v33, v74
    v_mul_f32 v75, v33, v75
    v_cvt_pk_bf16_f32 v40, v64, v65
    v_cvt_pk_bf16_f32 v41, v66, v67
    v_cvt_pk_bf16_f32 v42, v68, v69
    v_cvt_pk_bf16_f32 v43, v70, v71
    v_cvt_pk_bf16_f32 v44, v72, v73
    v_cvt_pk_bf16_f32 v45, v74, v75
    buffer_store_dwordx4 v[40:43], v39, s[20:23], s50 offen sc1
    s_mov_b32 exec_hi, 0
    buffer_store_dwordx2 v[44:45], v38, s[20:23], s49 offen sc1
    s_mov_b32 exec_hi, -1
    s_setprio 0
    v_and_b32 v1, 15, v0
    v_lshlrev_b32 v1, 2, v1
    s_lshl_b32 s48, s60, 8
    s_add_u32 s48, s48, 22183936
    buffer_load_dword v4, v1, s[20:23], s48 offen offset:0 sc1
    buffer_load_dword v5, v1, s[20:23], s48 offen offset:64 sc1
    buffer_load_dword v6, v1, s[20:23], s48 offen offset:128 sc1
    buffer_load_dword v7, v1, s[20:23], s48 offen offset:192 sc1
    s_waitcnt vmcnt(6)
    v_readfirstlane_b32 s77, v87
    s_nop 1
    v_lshlrev_b32 v2, 2, v0
    v_mov_b32 v1, s77
    s_lshr_b32 s48, s60, 2
    s_lshl_b32 s48, s48, 12
    s_add_u32 s48, s48, 22192128
    v_mfma_f32_16x16x32_bf16 v[8:11], v[104:107], v[88:91], 0
    v_mfma_f32_16x16x32_bf16 v[12:15], v[108:111], v[88:91], 0
    v_mfma_f32_16x16x32_bf16 v[16:19], v[112:115], v[88:91], 0
    v_mfma_f32_16x16x32_bf16 v[20:23], v[116:119], v[88:91], 0
    v_mfma_f32_16x16x32_bf16 v[24:27], v[120:123], v[88:91], 0
    v_mfma_f32_16x16x32_bf16 v[28:31], v[104:107], v[92:95], 0
    v_mfma_f32_16x16x32_bf16 v[32:35], v[108:111], v[92:95], 0
    v_mfma_f32_16x16x32_bf16 v[36:39], v[112:115], v[92:95], 0
    v_mfma_f32_16x16x32_bf16 v[40:43], v[116:119], v[92:95], 0
    v_mfma_f32_16x16x32_bf16 v[44:47], v[120:123], v[92:95], 0
    v_mfma_f32_16x16x32_bf16 v[48:51], v[104:107], v[96:99], 0
    v_mfma_f32_16x16x32_bf16 v[52:55], v[108:111], v[96:99], 0
    v_mfma_f32_16x16x32_bf16 v[56:59], v[112:115], v[96:99], 0
    v_mfma_f32_16x16x32_bf16 v[60:63], v[116:119], v[96:99], 0
    v_mfma_f32_16x16x32_bf16 v[64:67], v[120:123], v[96:99], 0
    v_mfma_f32_16x16x32_bf16 v[68:71], v[104:107], v[100:103], 0
    v_mfma_f32_16x16x32_bf16 v[72:75], v[108:111], v[100:103], 0
    v_mfma_f32_16x16x32_bf16 v[76:79], v[112:115], v[100:103], 0
    v_mfma_f32_16x16x32_bf16 v[80:83], v[116:119], v[100:103], 0
    v_mfma_f32_16x16x32_bf16 v[84:87], v[120:123], v[100:103], 0
    v_add_u32 v254, s76, v3
    v_lshlrev_b32 v255, 3, v0
    ds_read_b128 v[88:91], v254 offset:0
    ds_read_b128 v[92:95], v254 offset:1024
    ds_read_b128 v[96:99], v254 offset:2048
    ds_read_b128 v[100:103], v254 offset:3072
    ds_read_b128 v[104:107], v254 offset:4096
    ds_read_b128 v[108:111], v254 offset:5120
    ds_read_b128 v[112:115], v254 offset:6144
    ds_read_b128 v[116:119], v254 offset:7168
    ds_read_b128 v[120:123], v254 offset:8192
    s_cmp_lt_u32 s3, 4
    s_cbranch_scc1 Lk2np_27
    s_setprio 0
    s_waitcnt vmcnt(4)
    s_mov_b64 exec, 1
    v_mov_b32 v252, 106496
    v_mov_b32 v253, 1
    ds_add_rtn_u32 v253, v252, v253 offset:4
    s_waitcnt lgkmcnt(0)
    v_readfirstlane_b32 s54, v253
    s_cmp_lg_u32 s54, 7
    s_cbranch_scc1 Lk2np_27y
    buffer_store_dword v1, v2, s[20:23], s51 offen sc1
Lk2np_27y:
    s_mov_b64 exec, -1
Lk2np_27:
    v_mfma_f32_16x16x32_bf16 v[8:11], v[140:143], v[124:127], v[8:11]
    v_mfma_f32_16x16x32_bf16 v[12:15], v[144:147], v[124:127], v[12:15]
    v_mfma_f32_16x16x32_bf16 v[16:19], v[148:151], v[124:127], v[16:19]
    v_mfma_f32_16x16x32_bf16 v[20:23], v[152:155], v[124:127], v[20:23]
    v_mfma_f32_16x16x32_bf16 v[24:27], v[156:159], v[124:127], v[24:27]
    v_mfma_f32_16x16x32_bf16 v[28:31], v[140:143], v[128:131], v[28:31]
    v_mfma_f32_16x16x32_bf16 v[32:35], v[144:147], v[128:131], v[32:35]
    v_mfma_f32_16x16x32_bf16 v[36:39], v[148:151], v[128:131], v[36:39]
    v_mfma_f32_16x16x32_bf16 v[40:43], v[152:155], v[128:131], v[40:43]
    v_mfma_f32_16x16x32_bf16 v[44:47], v[156:159], v[128:131], v[44:47]
    v_mfma_f32_16x16x32_bf16 v[48:51], v[140:143], v[132:135], v[48:51]
    v_mfma_f32_16x16x32_bf16 v[52:55], v[144:147], v[132:135], v[52:55]
    v_mfma_f32_16x16x32_bf16 v[56:59], v[148:151], v[132:135], v[56:59]
    v_mfma_f32_16x16x32_bf16 v[60:63], v[152:155], v[132:135], v[60:63]
    v_mfma_f32_16x16x32_bf16 v[64:67], v[156:159], v[132:135], v[64:67]
    v_mfma_f32_16x16x32_bf16 v[68:71], v[140:143], v[136:139], v[68:71]
    v_mfma_f32_16x16x32_bf16 v[72:75], v[144:147], v[136:139], v[72:75]
    v_mfma_f32_16x16x32_bf16 v[76:79], v[148:151], v[136:139], v[76:79]
    v_mfma_f32_16x16x32_bf16 v[80:83], v[152:155], v[136:139], v[80:83]
    v_mfma_f32_16x16x32_bf16 v[84:87], v[156:159], v[136:139], v[84:87]
    ds_read_b128 v[124:127], v254 offset:9216
    ds_read_b128 v[128:131], v254 offset:10240
    ds_read_b128 v[132:135], v254 offset:11264
    ds_read_b128 v[136:139], v254 offset:12288
    v_mfma_f32_16x16x32_bf16 v[8:11], v[176:179], v[160:163], v[8:11]
    v_mfma_f32_16x16x32_bf16 v[12:15], v[180:183], v[160:163], v[12:15]
    v_mfma_f32_16x16x32_bf16 v[16:19], v[184:187], v[160:163], v[16:19]
    v_mfma_f32_16x16x32_bf16 v[20:23], v[188:191], v[160:163], v[20:23]
    v_mfma_f32_16x16x32_bf16 v[24:27], v[192:195], v[160:163], v[24:27]
    v_mfma_f32_16x16x32_bf16 v[28:31], v[176:179], v[164:167], v[28:31]
    v_mfma_f32_16x16x32_bf16 v[32:35], v[180:183], v[164:167], v[32:35]
    v_mfma_f32_16x16x32_bf16 v[36:39], v[184:187], v[164:167], v[36:39]
    v_mfma_f32_16x16x32_bf16 v[40:43], v[188:191], v[164:167], v[40:43]
    v_mfma_f32_16x16x32_bf16 v[44:47], v[192:195], v[164:167], v[44:47]
    v_mfma_f32_16x16x32_bf16 v[48:51], v[176:179], v[168:171], v[48:51]
    v_mfma_f32_16x16x32_bf16 v[52:55], v[180:183], v[168:171], v[52:55]
    v_mfma_f32_16x16x32_bf16 v[56:59], v[184:187], v[168:171], v[56:59]
    v_mfma_f32_16x16x32_bf16 v[60:63], v[188:191], v[168:171], v[60:63]
    v_mfma_f32_16x16x32_bf16 v[64:67], v[192:195], v[168:171], v[64:67]
    v_mfma_f32_16x16x32_bf16 v[68:71], v[176:179], v[172:175], v[68:71]
    v_mfma_f32_16x16x32_bf16 v[72:75], v[180:183], v[172:175], v[72:75]
    v_mfma_f32_16x16x32_bf16 v[76:79], v[184:187], v[172:175], v[76:79]
    v_mfma_f32_16x16x32_bf16 v[80:83], v[188:191], v[172:175], v[80:83]
    v_mfma_f32_16x16x32_bf16 v[84:87], v[192:195], v[172:175], v[84:87]
    s_cmp_lt_u32 s3, 4
    s_cbranch_scc0 Lk2np_28
    s_setprio 0
    s_waitcnt vmcnt(4)
    s_mov_b64 exec, 1
    v_mov_b32 v252, 106496
    v_mov_b32 v253, 1
    ds_add_rtn_u32 v253, v252, v253 offset:4
    s_waitcnt lgkmcnt(0)
    v_readfirstlane_b32 s54, v253
    s_cmp_lg_u32 s54, 7
    s_cbranch_scc1 Lk2np_28y
    buffer_store_dword v1, v2, s[20:23], s51 offen sc1
Lk2np_28y:
    s_mov_b64 exec, -1
Lk2np_28:
    v_mfma_f32_16x16x32_bf16 v[8:11], v[212:215], v[196:199], v[8:11]
    v_mfma_f32_16x16x32_bf16 v[12:15], v[216:219], v[196:199], v[12:15]
    s_lshl_b32 s73, s75, 11
    s_add_u32 s73, s73, s72
    buffer_load_dwordx4 v[140:143], v3, s[20:23], s73 offen offset:0 sc1
    v_mfma_f32_16x16x32_bf16 v[16:19], v[220:223], v[196:199], v[16:19]
    v_mfma_f32_16x16x32_bf16 v[20:23], v[224:227], v[196:199], v[20:23]
    buffer_load_dwordx4 v[144:147], v3, s[20:23], s73 offen offset:1024 sc1
    v_mfma_f32_16x16x32_bf16 v[24:27], v[228:231], v[196:199], v[24:27]
    v_mfma_f32_16x16x32_bf16 v[28:31], v[212:215], v[200:203], v[28:31]
    s_add_u32 s73, s73, 69632
    buffer_load_dwordx4 v[148:151], v3, s[20:23], s73 offen offset:0 sc1
    v_mfma_f32_16x16x32_bf16 v[32:35], v[216:219], v[200:203], v[32:35]
    v_mfma_f32_16x16x32_bf16 v[36:39], v[220:223], v[200:203], v[36:39]
    buffer_load_dwordx4 v[152:155], v3, s[20:23], s73 offen offset:1024 sc1
    v_mfma_f32_16x16x32_bf16 v[40:43], v[224:227], v[200:203], v[40:43]
    v_mfma_f32_16x16x32_bf16 v[44:47], v[228:231], v[200:203], v[44:47]
    s_add_u32 s73, s73, 69632
    buffer_load_dwordx4 v[156:159], v3, s[20:23], s73 offen offset:0 sc1
    v_mfma_f32_16x16x32_bf16 v[48:51], v[212:215], v[204:207], v[48:51]
    v_mfma_f32_16x16x32_bf16 v[52:55], v[216:219], v[204:207], v[52:55]
    buffer_load_dwordx4 v[160:163], v3, s[20:23], s73 offen offset:1024 sc1
    v_mfma_f32_16x16x32_bf16 v[56:59], v[220:223], v[204:207], v[56:59]
    v_mfma_f32_16x16x32_bf16 v[60:63], v[224:227], v[204:207], v[60:63]
    s_add_u32 s73, s73, 69632
    buffer_load_dwordx4 v[164:167], v3, s[20:23], s73 offen offset:0 sc1
    v_mfma_f32_16x16x32_bf16 v[64:67], v[228:231], v[204:207], v[64:67]
    v_mfma_f32_16x16x32_bf16 v[68:71], v[212:215], v[208:211], v[68:71]
    buffer_load_dwordx4 v[168:171], v3, s[20:23], s73 offen offset:1024 sc1
    v_mfma_f32_16x16x32_bf16 v[72:75], v[216:219], v[208:211], v[72:75]
    v_mfma_f32_16x16x32_bf16 v[76:79], v[220:223], v[208:211], v[76:79]
    s_add_u32 s73, s73, 69632
    buffer_load_dwordx4 v[172:175], v3, s[20:23], s73 offen offset:0 sc1
    v_mfma_f32_16x16x32_bf16 v[80:83], v[224:227], v[208:211], v[80:83]
    v_mfma_f32_16x16x32_bf16 v[84:87], v[228:231], v[208:211], v[84:87]
    buffer_load_dwordx4 v[176:179], v3, s[20:23], s73 offen offset:1024 sc1
    s_waitcnt lgkmcnt(0)
    v_mfma_f32_16x16x32_bf16 v[8:11], v[248:251], v[232:235], v[8:11]
    v_mfma_f32_16x16x32_bf16 v[12:15], v[88:91], v[232:235], v[12:15]
    s_lshl_b32 s73, s75, 9
    s_add_u32 s73, s73, s72
    s_add_u32 s73, s73, 16384
    buffer_load_dwordx2 v[180:181], v255, s[20:23], s73 offen sc1
    v_mfma_f32_16x16x32_bf16 v[16:19], v[92:95], v[232:235], v[16:19]
    v_mfma_f32_16x16x32_bf16 v[20:23], v[96:99], v[232:235], v[20:23]
    s_add_u32 s73, s73, 69632
    buffer_load_dwordx2 v[182:183], v255, s[20:23], s73 offen sc1
    v_mfma_f32_16x16x32_bf16 v[24:27], v[100:103], v[232:235], v[24:27]
    v_mfma_f32_16x16x32_bf16 v[28:31], v[248:251], v[236:239], v[28:31]
    s_add_u32 s73, s73, 69632
    buffer_load_dwordx2 v[184:185], v255, s[20:23], s73 offen sc1
    v_mfma_f32_16x16x32_bf16 v[32:35], v[88:91], v[236:239], v[32:35]
    v_mfma_f32_16x16x32_bf16 v[36:39], v[92:95], v[236:239], v[36:39]
    s_add_u32 s73, s73, 69632
    buffer_load_dwordx2 v[186:187], v255, s[20:23], s73 offen sc1
    v_mfma_f32_16x16x32_bf16 v[40:43], v[96:99], v[236:239], v[40:43]
    v_mfma_f32_16x16x32_bf16 v[44:47], v[100:103], v[236:239], v[44:47]
    s_add_u32 s73, s73, 69632
    buffer_load_dwordx2 v[188:189], v255, s[20:23], s73 offen sc1
    v_mfma_f32_16x16x32_bf16 v[48:51], v[248:251], v[240:243], v[48:51]
    v_mfma_f32_16x16x32_bf16 v[52:55], v[88:91], v[240:243], v[52:55]
    v_mfma_f32_16x16x32_bf16 v[56:59], v[92:95], v[240:243], v[56:59]
    v_mfma_f32_16x16x32_bf16 v[60:63], v[96:99], v[240:243], v[60:63]
    v_mfma_f32_16x16x32_bf16 v[64:67], v[100:103], v[240:243], v[64:67]
    v_mfma_f32_16x16x32_bf16 v[68:71], v[248:251], v[244:247], v[68:71]
    v_mfma_f32_16x16x32_bf16 v[72:75], v[88:91], v[244:247], v[72:75]
    v_mfma_f32_16x16x32_bf16 v[76:79], v[92:95], v[244:247], v[76:79]
    v_mfma_f32_16x16x32_bf16 v[80:83], v[96:99], v[244:247], v[80:83]
    v_mfma_f32_16x16x32_bf16 v[84:87], v[100:103], v[244:247], v[84:87]
    v_mfma_f32_16x16x32_bf16 v[8:11], v[120:123], v[104:107], v[8:11]
    v_mfma_f32_16x16x32_bf16 v[12:15], v[124:127], v[104:107], v[12:15]
    v_mfma_f32_16x16x32_bf16 v[16:19], v[128:131], v[104:107], v[16:19]
    v_mfma_f32_16x16x32_bf16 v[20:23], v[132:135], v[104:107], v[20:23]
    v_mfma_f32_16x16x32_bf16 v[24:27], v[136:139], v[104:107], v[24:27]
    v_mfma_f32_16x16x32_bf16 v[28:31], v[120:123], v[108:111], v[28:31]
    v_mfma_f32_16x16x32_bf16 v[32:35], v[124:127], v[108:111], v[32:35]
    v_mfma_f32_16x16x32_bf16 v[36:39], v[128:131], v[108:111], v[36:39]
    v_mfma_f32_16x16x32_bf16 v[40:43], v[132:135], v[108:111], v[40:43]
    v_mfma_f32_16x16x32_bf16 v[44:47], v[136:139], v[108:111], v[44:47]
    v_mfma_f32_16x16x32_bf16 v[48:51], v[120:123], v[112:115], v[48:51]
    v_mfma_f32_16x16x32_bf16 v[52:55], v[124:127], v[112:115], v[52:55]
    v_mfma_f32_16x16x32_bf16 v[56:59], v[128:131], v[112:115], v[56:59]
    v_mfma_f32_16x16x32_bf16 v[60:63], v[132:135], v[112:115], v[60:63]
    v_mfma_f32_16x16x32_bf16 v[64:67], v[136:139], v[112:115], v[64:67]
    v_mfma_f32_16x16x32_bf16 v[68:71], v[120:123], v[116:119], v[68:71]
    v_mfma_f32_16x16x32_bf16 v[72:75], v[124:127], v[116:119], v[72:75]
    v_mfma_f32_16x16x32_bf16 v[76:79], v[128:131], v[116:119], v[76:79]
    v_mfma_f32_16x16x32_bf16 v[80:83], v[132:135], v[116:119], v[80:83]
    v_mfma_f32_16x16x32_bf16 v[84:87], v[136:139], v[116:119], v[84:87]
    s_waitcnt vmcnt(15)
    s_nop 4
    v_sub_f32 v252, 1.0, v4
    v_mov_b32 v253, v252
    v_pk_mul_f32 v[8:9], v[8:9], v[252:253]
    v_pk_mul_f32 v[10:11], v[10:11], v[252:253]
    v_pk_mul_f32 v[12:13], v[12:13], v[252:253]
    v_pk_mul_f32 v[14:15], v[14:15], v[252:253]
    v_pk_mul_f32 v[16:17], v[16:17], v[252:253]
    v_pk_mul_f32 v[18:19], v[18:19], v[252:253]
    v_pk_mul_f32 v[20:21], v[20:21], v[252:253]
    v_pk_mul_f32 v[22:23], v[22:23], v[252:253]
    v_pk_mul_f32 v[24:25], v[24:25], v[252:253]
    v_pk_mul_f32 v[26:27], v[26:27], v[252:253]
    v_sub_f32 v252, 1.0, v5
    v_mov_b32 v253, v252
    v_pk_mul_f32 v[28:29], v[28:29], v[252:253]
    v_pk_mul_f32 v[30:31], v[30:31], v[252:253]
    v_pk_mul_f32 v[32:33], v[32:33], v[252:253]
    v_pk_mul_f32 v[34:35], v[34:35], v[252:253]
    v_pk_mul_f32 v[36:37], v[36:37], v[252:253]
    v_pk_mul_f32 v[38:39], v[38:39], v[252:253]
    v_pk_mul_f32 v[40:41], v[40:41], v[252:253]
    v_pk_mul_f32 v[42:43], v[42:43], v[252:253]
    v_pk_mul_f32 v[44:45], v[44:45], v[252:253]
    v_pk_mul_f32 v[46:47], v[46:47], v[252:253]
    v_sub_f32 v252, 1.0, v6
    v_mov_b32 v253, v252
    v_pk_mul_f32 v[48:49], v[48:49], v[252:253]
    v_pk_mul_f32 v[50:51], v[50:51], v[252:253]
    v_pk_mul_f32 v[52:53], v[52:53], v[252:253]
    v_pk_mul_f32 v[54:55], v[54:55], v[252:253]
    v_pk_mul_f32 v[56:57], v[56:57], v[252:253]
    v_pk_mul_f32 v[58:59], v[58:59], v[252:253]
    v_pk_mul_f32 v[60:61], v[60:61], v[252:253]
    v_pk_mul_f32 v[62:63], v[62:63], v[252:253]
    v_pk_mul_f32 v[64:65], v[64:65], v[252:253]
    v_pk_mul_f32 v[66:67], v[66:67], v[252:253]
    v_sub_f32 v252, 1.0, v7
    v_mov_b32 v253, v252
    v_pk_mul_f32 v[68:69], v[68:69], v[252:253]
    v_pk_mul_f32 v[70:71], v[70:71], v[252:253]
    v_pk_mul_f32 v[72:73], v[72:73], v[252:253]
    v_pk_mul_f32 v[74:75], v[74:75], v[252:253]
    v_pk_mul_f32 v[76:77], v[76:77], v[252:253]
    v_pk_mul_f32 v[78:79], v[78:79], v[252:253]
    v_pk_mul_f32 v[80:81], v[80:81], v[252:253]
    v_pk_mul_f32 v[82:83], v[82:83], v[252:253]
    v_pk_mul_f32 v[84:85], v[84:85], v[252:253]
    v_pk_mul_f32 v[86:87], v[86:87], v[252:253]
    s_lshl_b32 s52, s75, 11
    s_add_u32 s52, s52, s71
    s_lshl_b32 s49, s75, 9
    s_add_u32 s49, s49, s71
    s_add_u32 s49, s49, 16384
    s_lshl_b32 s53, s75, 2
    s_lshl_b32 s53, 15, s53
    v_mov_b32 v252, 106496
    s_mov_b32 s55, 0
    s_cmp_lg_u32 s3, 0
    s_cbranch_scc1 Lk2polld_26
    s_mov_b32 exec_hi, 0
Lk2poll_25:
    buffer_load_dword v1, v2, s[20:23], s48 offen sc1
    s_waitcnt vmcnt(0)
    v_cmp_eq_u32 vcc, s77, v1
    s_add_u32 s55, s55, 1
    s_cmp_ge_u32 s55, 262144
    s_cselect_b32 s54, -1, vcc_lo
    v_mov_b32 v253, s54
    ds_write_b32 v252, v253
    s_and_b32 s56, s54, s53
    s_cmp_lg_u32 s56, s53
    s_cbranch_scc1 Lk2poll_25
    s_mov_b32 exec_hi, -1
    s_branch Lk2polld_26x
Lk2polld_26:
    ds_read_b32 v1, v252
    s_add_u32 s55, s55, 1
    s_waitcnt lgkmcnt(0)
    v_readfirstlane_b32 s54, v1
    s_cmp_ge_u32 s55, 0x400000
    s_cselect_b32 s54, -1, s54
    s_and_b32 s54, s54, s53
    s_cmp_eq_u32 s54, s53
    s_cbranch_scc1 Lk2polld_26x
    s_sleep 1
    s_branch Lk2polld_26
Lk2polld_26x:
    buffer_load_dwordx4 v[192:195], v3, s[20:23], s52 offen offset:0 sc1
    buffer_load_dwordx4 v[208:211], v3, s[20:23], s52 offen offset:1024 sc1
    buffer_load_dwordx2 v[224:225], v255, s[20:23], s49 offen sc1
    s_add_u32 s52, s52, 69632
    s_add_u32 s49, s49, 69632
    buffer_load_dwordx4 v[196:199], v3, s[20:23], s52 offen offset:0 sc1
    buffer_load_dwordx4 v[212:215], v3, s[20:23], s52 offen offset:1024 sc1
    buffer_load_dwordx2 v[226:227], v255, s[20:23], s49 offen sc1
    s_add_u32 s52, s52, 69632
    s_add_u32 s49, s49, 69632
    buffer_load_dwordx4 v[200:203], v3, s[20:23], s52 offen offset:0 sc1
    buffer_load_dwordx4 v[216:219], v3, s[20:23], s52 offen offset:1024 sc1
    buffer_load_dwordx2 v[228:229], v255, s[20:23], s49 offen sc1
    s_add_u32 s52, s52, 69632
    s_add_u32 s49, s49, 69632
    buffer_load_dwordx4 v[204:207], v3, s[20:23], s52 offen offset:0 sc1
    buffer_load_dwordx4 v[220:223], v3, s[20:23], s52 offen offset:1024 sc1
    buffer_load_dwordx2 v[230:231], v255, s[20:23], s49 offen sc1
    s_cmp_lg_u32 s3, 0
    s_cbranch_scc1 Lk2rest_29x
    s_cmp_eq_u32 s54, -1
    s_cbranch_scc1 Lk2rest_29x
    s_mov_b32 exec_hi, 0
Lk2rest_29:
    buffer_load_dword v1, v2, s[20:23], s48 offen sc1
    s_waitcnt vmcnt(0)
    v_cmp_eq_u32 vcc, s77, v1
    s_add_u32 s55, s55, 1
    s_cmp_ge_u32 s55, 262144
    s_cselect_b32 s54, -1, vcc_lo
    v_mov_b32 v253, s54
    ds_write_b32 v252, v253
    s_and_b32 s56, s54, -1
    s_cmp_lg_u32 s56, -1
    s_cbranch_scc1 Lk2rest_29
    s_mov_b32 exec_hi, -1
Lk2rest_29x:
    s_and_b32 s57, s3, 3
    s_lshl_b32 s57, s57, 6
    s_add_u32 s57, s57, s76
    v_lshlrev_b32 v4, 3, v0
    v_add_u32 v4, s57, v4
    v_bfe_u32 v5, v0, 2, 2
    v_mul_u32_u24 v5, 13376, v5
    v_lshrrev_b32 v6, 4, v0
    v_lshl_add_u32 v5, v6, 5, v5
    v_and_b32 v7, 3, v0
    v_lshl_add_u32 v5, v7, 3, v5
    s_lshl_b32 s57, s3, 9
    v_add_u32 v5, s57, v5
    v_and_b32 v7, 15, v0
    v_sub_u32 v6, v7, v6
    v_mov_b32 v1, 0x3f803f80
    v_cmp_eq_u32 vcc, 0, v6
    s_nop 1
    v_cndmask_b32 v232, 0, v1, vcc
    v_mov_b32 v233, v232
    v_mov_b32 v234, v232
    v_mov_b32 v235, v232
    v_cmp_eq_u32 vcc, 4, v6
    s_nop 1
    v_cndmask_b32 v236, 0, v1, vcc
    v_mov_b32 v237, v236
    v_mov_b32 v238, v236
    v_mov_b32 v239, v236
    v_cmp_eq_u32 vcc, 8, v6
    s_nop 1
    v_cndmask_b32 v240, 0, v1, vcc
    v_mov_b32 v241, v240
    v_mov_b32 v242, v240
    v_mov_b32 v243, v240
    v_cmp_eq_u32 vcc, 12, v6
    s_nop 1
    v_cndmask_b32 v244, 0, v1, vcc
    v_mov_b32 v245, v244
    v_mov_b32 v246, v244
    v_mov_b32 v247, v244
    s_waitcnt vmcnt(11) lgkmcnt(0)
    v_mfma_f32_16x16x32_bf16 v[8:11], v[140:143], v[192:195], v[8:11]
    v_mfma_f32_16x16x32_bf16 v[12:15], v[148:151], v[192:195], v[12:15]
    v_mfma_f32_16x16x32_bf16 v[16:19], v[156:159], v[192:195], v[16:19]
    v_mfma_f32_16x16x32_bf16 v[20:23], v[164:167], v[192:195], v[20:23]
    v_mfma_f32_16x16x32_bf16 v[24:27], v[172:175], v[192:195], v[24:27]
    s_waitcnt vmcnt(10)
    v_mfma_f32_16x16x32_bf16 v[8:11], v[144:147], v[208:211], v[8:11]
    v_mfma_f32_16x16x32_bf16 v[12:15], v[152:155], v[208:211], v[12:15]
    v_mfma_f32_16x16x32_bf16 v[16:19], v[160:163], v[208:211], v[16:19]
    v_mfma_f32_16x16x32_bf16 v[20:23], v[168:171], v[208:211], v[20:23]
    v_mfma_f32_16x16x32_bf16 v[24:27], v[176:179], v[208:211], v[24:27]
    s_waitcnt vmcnt(9)
    v_mfma_f32_16x16x16bf16_1k v[8:11], v[180:181], v[224:225], v[8:11]
    v_mfma_f32_16x16x16bf16_1k v[12:15], v[182:183], v[224:225], v[12:15]
    v_mfma_f32_16x16x16bf16_1k v[16:19], v[184:185], v[224:225], v[16:19]
    v_mfma_f32_16x16x16bf16_1k v[20:23], v[186:187], v[224:225], v[20:23]
    v_mfma_f32_16x16x16bf16_1k v[24:27], v[188:189], v[224:225], v[24:27]
    s_waitcnt vmcnt(8)
    v_mfma_f32_16x16x32_bf16 v[28:31], v[140:143], v[196:199], v[28:31]
    v_mfma_f32_16x16x32_bf16 v[32:35], v[148:151], v[196:199], v[32:35]
    v_mfma_f32_16x16x32_bf16 v[36:39], v[156:159], v[196:199], v[36:39]
    v_mfma_f32_16x16x32_bf16 v[40:43], v[164:167], v[196:199], v[40:43]
    v_mfma_f32_16x16x32_bf16 v[44:47], v[172:175], v[196:199], v[44:47]
    s_waitcnt vmcnt(7)
    v_mfma_f32_16x16x32_bf16 v[28:31], v[144:147], v[212:215], v[28:31]
    v_cvt_pk_bf16_f32 v8, v8, v9
    v_cvt_pk_bf16_f32 v9, v10, v11
    ds_write_b64 v4, v[8:9] offset:0
    v_mfma_f32_16x16x32_bf16 v[32:35], v[152:155], v[212:215], v[32:35]
    v_cvt_pk_bf16_f32 v12, v12, v13
    v_cvt_pk_bf16_f32 v13, v14, v15
    ds_write_b64 v4, v[12:13] offset:512
    v_mfma_f32_16x16x32_bf16 v[36:39], v[160:163], v[212:215], v[36:39]
    v_cvt_pk_bf16_f32 v16, v16, v17
    v_cvt_pk_bf16_f32 v17, v18, v19
    ds_write_b64 v4, v[16:17] offset:1024
    v_mfma_f32_16x16x32_bf16 v[40:43], v[168:171], v[212:215], v[40:43]
    v_cvt_pk_bf16_f32 v20, v20, v21
    v_cvt_pk_bf16_f32 v21, v22, v23
    ds_write_b64 v4, v[20:21] offset:1536
    v_mfma_f32_16x16x32_bf16 v[44:47], v[176:179], v[212:215], v[44:47]
    v_cvt_pk_bf16_f32 v24, v24, v25
    v_cvt_pk_bf16_f32 v25, v26, v27
    ds_write_b64 v4, v[24:25] offset:2048
    s_waitcnt vmcnt(6)
    v_mfma_f32_16x16x16bf16_1k v[28:31], v[180:181], v[226:227], v[28:31]
    v_mfma_f32_16x16x16bf16_1k v[32:35], v[182:183], v[226:227], v[32:35]
    v_mfma_f32_16x16x16bf16_1k v[36:39], v[184:185], v[226:227], v[36:39]
    v_mfma_f32_16x16x16bf16_1k v[40:43], v[186:187], v[226:227], v[40:43]
    v_mfma_f32_16x16x16bf16_1k v[44:47], v[188:189], v[226:227], v[44:47]
    s_waitcnt vmcnt(5)
    v_mfma_f32_16x16x32_bf16 v[48:51], v[140:143], v[200:203], v[48:51]
    v_mfma_f32_16x16x32_bf16 v[52:55], v[148:151], v[200:203], v[52:55]
    v_mfma_f32_16x16x32_bf16 v[56:59], v[156:159], v[200:203], v[56:59]
    v_mfma_f32_16x16x32_bf16 v[60:63], v[164:167], v[200:203], v[60:63]
    v_mfma_f32_16x16x32_bf16 v[64:67], v[172:175], v[200:203], v[64:67]
    s_waitcnt vmcnt(4)
    v_mfma_f32_16x16x32_bf16 v[48:51], v[144:147], v[216:219], v[48:51]
    v_cvt_pk_bf16_f32 v28, v28, v29
    v_cvt_pk_bf16_f32 v29, v30, v31
    ds_write_b64 v4, v[28:29] offset:2560
    v_mfma_f32_16x16x32_bf16 v[52:55], v[152:155], v[216:219], v[52:55]
    v_cvt_pk_bf16_f32 v32, v32, v33
    v_cvt_pk_bf16_f32 v33, v34, v35
    ds_write_b64 v4, v[32:33] offset:3072
    v_mfma_f32_16x16x32_bf16 v[56:59], v[160:163], v[216:219], v[56:59]
    v_cvt_pk_bf16_f32 v36, v36, v37
    v_cvt_pk_bf16_f32 v37, v38, v39
    ds_write_b64 v4, v[36:37] offset:3584
    v_mfma_f32_16x16x32_bf16 v[60:63], v[168:171], v[216:219], v[60:63]
    v_cvt_pk_bf16_f32 v40, v40, v41
    v_cvt_pk_bf16_f32 v41, v42, v43
    ds_write_b64 v4, v[40:41] offset:4096
    v_mfma_f32_16x16x32_bf16 v[64:67], v[176:179], v[216:219], v[64:67]
    v_cvt_pk_bf16_f32 v44, v44, v45
    v_cvt_pk_bf16_f32 v45, v46, v47
    ds_write_b64 v4, v[44:45] offset:4608
    s_waitcnt vmcnt(3)
    v_mfma_f32_16x16x16bf16_1k v[48:51], v[180:181], v[228:229], v[48:51]
    v_mfma_f32_16x16x16bf16_1k v[52:55], v[182:183], v[228:229], v[52:55]
    v_mfma_f32_16x16x16bf16_1k v[56:59], v[184:185], v[228:229], v[56:59]
    v_mfma_f32_16x16x16bf16_1k v[60:63], v[186:187], v[228:229], v[60:63]
    v_mfma_f32_16x16x16bf16_1k v[64:67], v[188:189], v[228:229], v[64:67]
    s_waitcnt vmcnt(2)
    v_mfma_f32_16x16x32_bf16 v[68:71], v[140:143], v[204:207], v[68:71]
    v_mfma_f32_16x16x32_bf16 v[72:75], v[148:151], v[204:207], v[72:75]
    v_mfma_f32_16x16x32_bf16 v[76:79], v[156:159], v[204:207], v[76:79]
    v_mfma_f32_16x16x32_bf16 v[80:83], v[164:167], v[204:207], v[80:83]
    v_mfma_f32_16x16x32_bf16 v[84:87], v[172:175], v[204:207], v[84:87]
    s_waitcnt vmcnt(1)
    v_mfma_f32_16x16x32_bf16 v[68:71], v[144:147], v[220:223], v[68:71]
    v_cvt_pk_bf16_f32 v48, v48, v49
    v_cvt_pk_bf16_f32 v49, v50, v51
    ds_write_b64 v4, v[48:49] offset:5120
    v_mfma_f32_16x16x32_bf16 v[72:75], v[152:155], v[220:223], v[72:75]
    v_cvt_pk_bf16_f32 v52, v52, v53
    v_cvt_pk_bf16_f32 v53, v54, v55
    ds_write_b64 v4, v[52:53] offset:5632
    v_mfma_f32_16x16x32_bf16 v[76:79], v[160:163], v[220:223], v[76:79]
    v_cvt_pk_bf16_f32 v56, v56, v57
    v_cvt_pk_bf16_f32 v57, v58, v59
    ds_write_b64 v4, v[56:57] offset:6144
    v_mfma_f32_16x16x32_bf16 v[80:83], v[168:171], v[220:223], v[80:83]
    v_cvt_pk_bf16_f32 v60, v60, v61
    v_cvt_pk_bf16_f32 v61, v62, v63
    ds_write_b64 v4, v[60:61] offset:6656
    v_mfma_f32_16x16x32_bf16 v[84:87], v[176:179], v[220:223], v[84:87]
    v_cvt_pk_bf16_f32 v64, v64, v65
    v_cvt_pk_bf16_f32 v65, v66, v67
    ds_write_b64 v4, v[64:65] offset:7168
    s_waitcnt vmcnt(0)
    v_mfma_f32_16x16x16bf16_1k v[68:71], v[180:181], v[230:231], v[68:71]
    v_mfma_f32_16x16x16bf16_1k v[72:75], v[182:183], v[230:231], v[72:75]
    v_mfma_f32_16x16x16bf16_1k v[76:79], v[184:185], v[230:231], v[76:79]
    v_mfma_f32_16x16x16bf16_1k v[80:83], v[186:187], v[230:231], v[80:83]
    v_mfma_f32_16x16x16bf16_1k v[84:87], v[188:189], v[230:231], v[84:87]
    s_nop 3
    v_cvt_pk_bf16_f32 v68, v68, v69
    v_cvt_pk_bf16_f32 v69, v70, v71
    ds_write_b64 v4, v[68:69] offset:7680
    v_cvt_pk_bf16_f32 v72, v72, v73
    v_cvt_pk_bf16_f32 v73, v74, v75
    ds_write_b64 v4, v[72:73] offset:8192
    v_cvt_pk_bf16_f32 v76, v76, v77
    v_cvt_pk_bf16_f32 v77, v78, v79
    ds_write_b64 v4, v[76:77] offset:8704
    v_cvt_pk_bf16_f32 v80, v80, v81
    v_cvt_pk_bf16_f32 v81, v82, v83
    ds_write_b64 v4, v[80:81] offset:9216
    v_cvt_pk_bf16_f32 v84, v84, v85
    v_cvt_pk_bf16_f32 v85, v86, v87
    ds_write_b64 v4, v[84:85] offset:9728
    v_lshrrev_b32 v1, 4, v0
    v_lshl_add_u32 v1, v7, 2, v1
    v_and_b32 v2, 15, v1
    v_mul_u32_u24 v2, 1280, v2
    v_lshrrev_b32 v1, 4, v1
    v_lshl_add_u32 v7, v1, 3, v2
    s_mul_i32 s48, s60, 81920
    s_mul_i32 s49, s61, 160
    s_add_u32 s48, s48, s49
    s_add_u32 s49, s3, 0
    s_mul_i32 s50, s49, 205
    s_lshr_b32 s50, s50, 10
    s_mul_i32 s52, s50, 20320
    s_lshl_b32 s49, s49, 5
    s_add_u32 s52, s52, s49
    s_add_u32 s52, s52, s48
    s_add_u32 s49, s3, 8
    s_mul_i32 s50, s49, 205
    s_lshr_b32 s50, s50, 10
    s_mul_i32 s53, s50, 20320
    s_lshl_b32 s49, s49, 5
    s_add_u32 s53, s53, s49
    s_add_u32 s53, s53, s48
    s_add_u32 s49, s3, 16
    s_mul_i32 s50, s49, 205
    s_lshr_b32 s50, s50, 10
    s_mul_i32 s54, s50, 20320
    s_lshl_b32 s49, s49, 5
    s_add_u32 s54, s54, s49
    s_add_u32 s54, s54, s48
    s_waitcnt lgkmcnt(0)
    s_barrier
Lfinal:
    ds_read_b64_tr_b16 v[248:249], v5 offset:0
    ds_read_b64_tr_b16 v[250:251], v5 offset:53248
    ds_read_b64_tr_b16 v[88:89], v5 offset:128
    ds_read_b64_tr_b16 v[90:91], v5 offset:53376
    ds_read_b64_tr_b16 v[92:93], v5 offset:256
    ds_read_b64_tr_b16 v[94:95], v5 offset:53504
    ds_read_b64_tr_b16 v[96:97], v5 offset:384
    ds_read_b64_tr_b16 v[98:99], v5 offset:53632
    ds_read_b64_tr_b16 v[100:101], v5 offset:4096
    ds_read_b64_tr_b16 v[102:103], v5 offset:57344
    ds_read_b64_tr_b16 v[104:105], v5 offset:4224
    ds_read_b64_tr_b16 v[106:107], v5 offset:57472
    ds_read_b64_tr_b16 v[108:109], v5 offset:4352
    ds_read_b64_tr_b16 v[110:111], v5 offset:57600
    ds_read_b64_tr_b16 v[112:113], v5 offset:4480
    ds_read_b64_tr_b16 v[114:115], v5 offset:57728
    s_waitcnt lgkmcnt(14)
    v_mfma_f32_16x16x32_bf16 v[8:11], v[248:251], v[232:235], 0
    s_waitcnt lgkmcnt(12)
    v_mfma_f32_16x16x32_bf16 v[8:11], v[88:91], v[236:239], v[8:11]
    s_waitcnt lgkmcnt(10)
    v_mfma_f32_16x16x32_bf16 v[8:11], v[92:95], v[240:243], v[8:11]
    s_waitcnt lgkmcnt(8)
    v_mfma_f32_16x16x32_bf16 v[8:11], v[96:99], v[244:247], v[8:11]
    s_cmp_ge_u32 s3, 4
    s_cbranch_scc1 Lk2o_30
    ds_read_b64_tr_b16 v[116:117], v5 offset:8192
    ds_read_b64_tr_b16 v[118:119], v5 offset:61440
    ds_read_b64_tr_b16 v[120:121], v5 offset:8320
    ds_read_b64_tr_b16 v[122:123], v5 offset:61568
    ds_read_b64_tr_b16 v[124:125], v5 offset:8448
    ds_read_b64_tr_b16 v[126:127], v5 offset:61696
    ds_read_b64_tr_b16 v[128:129], v5 offset:8576
    ds_read_b64_tr_b16 v[130:131], v5 offset:61824
    s_waitcnt lgkmcnt(14)
    v_mfma_f32_16x16x32_bf16 v[12:15], v[100:103], v[232:235], 0
    s_waitcnt lgkmcnt(12)
    v_mfma_f32_16x16x32_bf16 v[12:15], v[104:107], v[236:239], v[12:15]
    s_waitcnt lgkmcnt(10)
    v_mfma_f32_16x16x32_bf16 v[12:15], v[108:111], v[240:243], v[12:15]
    s_waitcnt lgkmcnt(8)
    v_mfma_f32_16x16x32_bf16 v[12:15], v[112:115], v[244:247], v[12:15]
    s_nop 1
    v_cvt_pk_bf16_f32 v8, v8, v9
    v_cvt_pk_bf16_f32 v9, v10, v11
    buffer_store_dwordx2 v[8:9], v7, s[24:27], s52 offen
    s_waitcnt lgkmcnt(6)
    v_mfma_f32_16x16x32_bf16 v[16:19], v[116:119], v[232:235], 0
    s_waitcnt lgkmcnt(4)
    v_mfma_f32_16x16x32_bf16 v[16:19], v[120:123], v[236:239], v[16:19]
    s_waitcnt lgkmcnt(2)
    v_mfma_f32_16x16x32_bf16 v[16:19], v[124:127], v[240:243], v[16:19]
    s_waitcnt lgkmcnt(0)
    v_mfma_f32_16x16x32_bf16 v[16:19], v[128:131], v[244:247], v[16:19]
    v_cvt_pk_bf16_f32 v12, v12, v13
    v_cvt_pk_bf16_f32 v13, v14, v15
    buffer_store_dwordx2 v[12:13], v7, s[24:27], s53 offen
    s_nop 4
    v_cvt_pk_bf16_f32 v16, v16, v17
    v_cvt_pk_bf16_f32 v17, v18, v19
    buffer_store_dwordx2 v[16:17], v7, s[24:27], s54 offen
    s_endpgm
Lk2o_30:
    s_waitcnt lgkmcnt(6)
    v_mfma_f32_16x16x32_bf16 v[12:15], v[100:103], v[232:235], 0
    s_waitcnt lgkmcnt(4)
    v_mfma_f32_16x16x32_bf16 v[12:15], v[104:107], v[236:239], v[12:15]
    s_waitcnt lgkmcnt(2)
    v_mfma_f32_16x16x32_bf16 v[12:15], v[108:111], v[240:243], v[12:15]
    s_waitcnt lgkmcnt(0)
    v_mfma_f32_16x16x32_bf16 v[12:15], v[112:115], v[244:247], v[12:15]
    v_cvt_pk_bf16_f32 v8, v8, v9
    v_cvt_pk_bf16_f32 v9, v10, v11
    buffer_store_dwordx2 v[8:9], v7, s[24:27], s52 offen
    s_nop 4
    v_cvt_pk_bf16_f32 v12, v12, v13
    v_cvt_pk_bf16_f32 v13, v14, v15
    buffer_store_dwordx2 v[12:13], v7, s[24:27], s53 offen
    s_endpgm
Lk2fb_24:
    v_bfe_u32 v85, v1, 2, 2
    v_xor_b32 v85, v85, v2
    v_lshlrev_b32 v85, 4, v85
    v_lshl_add_u32 v80, v1, 6, v85
    v_add_u32 v80, 1280, v80
    v_xor_b32 v84, 32, v80
    v_and_b32 v81, 7, v1
    v_lshlrev_b32 v81, 4, v81
    v_and_b32 v85, 8, v1
    v_add_u32 v81, v85, v81
    v_and_b32 v85, 16, v1
    v_lshl_add_u32 v81, v85, 3, v81
    v_lshl_add_u32 v83, v2, 8, v81
    v_add_u32 v81, 1024, v81
    s_add_u32 s46, s43, 5242880
    s_mov_b32 s37, 0
    v_mov_b32 v85, 0xff7fffff
Lk2p1_31:
    buffer_load_dwordx2 v[10:11], v83, s[20:23], s46 offen sc1
    buffer_load_dwordx2 v[12:13], v83, s[20:23], s46 offen offset:512 sc1
    buffer_load_dwordx2 v[14:15], v81, s[20:23], s46 offen sc1
    s_waitcnt vmcnt(0)
    v_mfma_f32_32x32x16_bf16 v[32:47], v[10:13], v[4:7], 0
    v_mfma_f32_32x32x8bf16_1k v[32:47], v[14:15], v[8:9], v[32:47]
    s_nop 7
    s_nop 7
    v_max3_f32 v85, v85, v32, v33
    v_max3_f32 v85, v85, v34, v35
    v_max3_f32 v85, v85, v36, v37
    v_max3_f32 v85, v85, v38, v39
    v_max3_f32 v85, v85, v40, v41
    v_max3_f32 v85, v85, v42, v43
    v_max3_f32 v85, v85, v44, v45
    v_max3_f32 v85, v85, v46, v47
    s_add_u32 s46, s46, 2560
    s_add_u32 s37, s37, 1
    s_cmp_lt_u32 s37, 64
    s_cbranch_scc1 Lk2p1_31
    v_mov_b32 v86, v85
    s_nop 1
    v_permlane32_swap_b32 v85, v86
    s_nop 1
    v_max_f32 v85, v85, v86
    v_sub_f32 v48, 0, v85
    v_mov_b32 v64, 0
    v_sub_f32 v49, 0, v85
    v_mov_b32 v65, 0
    v_sub_f32 v50, 0, v85
    v_mov_b32 v66, 0
    v_sub_f32 v51, 0, v85
    v_mov_b32 v67, 0
    v_sub_f32 v52, 0, v85
    v_mov_b32 v68, 0
    v_sub_f32 v53, 0, v85
    v_mov_b32 v69, 0
    v_sub_f32 v54, 0, v85
    v_mov_b32 v70, 0
    v_sub_f32 v55, 0, v85
    v_mov_b32 v71, 0
    v_sub_f32 v56, 0, v85
    v_mov_b32 v72, 0
    v_sub_f32 v57, 0, v85
    v_mov_b32 v73, 0
    v_sub_f32 v58, 0, v85
    v_mov_b32 v74, 0
    v_sub_f32 v59, 0, v85
    v_mov_b32 v75, 0
    v_sub_f32 v60, 0, v85
    v_mov_b32 v76, 0
    v_sub_f32 v61, 0, v85
    v_mov_b32 v77, 0
    v_sub_f32 v62, 0, v85
    v_mov_b32 v78, 0
    v_sub_f32 v63, 0, v85
    v_mov_b32 v79, 0
    s_add_u32 s46, s43, 5242880
    s_mov_b32 s37, 0
Lk2p2_32:
    buffer_load_dwordx2 v[10:11], v83, s[20:23], s46 offen sc1
    buffer_load_dwordx2 v[12:13], v83, s[20:23], s46 offen offset:512 sc1
    buffer_load_dwordx2 v[14:15], v81, s[20:23], s46 offen sc1
    s_mov_b64 exec, s[30:31]
    buffer_load_dwordx4 v[16:19], v80, s[20:23], s46 offen sc1
    buffer_load_dwordx4 v[20:23], v84, s[20:23], s46 offen sc1
    s_mov_b64 exec, -1
    s_waitcnt vmcnt(0)
    v_mfma_f32_32x32x16_bf16 v[32:47], v[10:13], v[4:7], v[48:63]
    v_mfma_f32_32x32x8bf16_1k v[32:47], v[14:15], v[8:9], v[32:47]
    s_nop 7
    s_nop 7
    v_exp_f32 v32, v32
    v_exp_f32 v33, v33
    v_exp_f32 v34, v34
    v_exp_f32 v35, v35
    v_exp_f32 v36, v36
    v_exp_f32 v37, v37
    v_exp_f32 v38, v38
    v_exp_f32 v39, v39
    v_exp_f32 v40, v40
    v_exp_f32 v41, v41
    v_exp_f32 v42, v42
    v_exp_f32 v43, v43
    v_exp_f32 v44, v44
    v_exp_f32 v45, v45
    v_exp_f32 v46, v46
    v_exp_f32 v47, v47
    s_nop 0
    v_cvt_pk_bf16_f32 v24, v32, v33
    v_cvt_pk_bf16_f32 v25, v34, v35
    v_cvt_pk_bf16_f32 v26, v36, v37
    v_cvt_pk_bf16_f32 v27, v38, v39
    v_cvt_pk_bf16_f32 v28, v40, v41
    v_cvt_pk_bf16_f32 v29, v42, v43
    v_cvt_pk_bf16_f32 v30, v44, v45
    v_cvt_pk_bf16_f32 v31, v46, v47
    s_nop 1
    v_mfma_f32_32x32x16_bf16 v[64:79], v[16:19], v[24:27], v[64:79]
    v_mfma_f32_32x32x16_bf16 v[64:79], v[20:23], v[28:31], v[64:79]
    s_add_u32 s46, s46, 2560
    s_add_u32 s37, s37, 1
    s_cmp_lt_u32 s37, 64
    s_cbranch_scc1 Lk2p2_32
    s_nop 7
    s_nop 7
    v_mov_b32 v32, v72
    v_mov_b32 v33, v72
    v_lshrrev_b32 v36, 4, v1
    v_mul_u32_u24 v36, 69632, v36
    v_and_b32 v37, 15, v1
    v_lshl_add_u32 v38, v37, 3, v36
    v_lshl_add_u32 v36, v37, 4, v36
    v_lshl_add_u32 v39, v2, 8, v36
    v_permlane32_swap_b32 v32, v33
    s_nop 1
    s_branch Lk2fin_23
gated_mix__softmax_full_mha__glu_gated_geglu__prompt_kernel_end:
    s_endpgm
code_end:
.section .rodata,"a"
.p2align 6
.amdhsa_kernel gated_mix__softmax_full_mha__glu_gated_geglu__prompt_kernel
.amdhsa_next_free_vgpr 256
.amdhsa_next_free_sgpr 96
.amdhsa_accum_offset 256
.amdhsa_group_segment_fixed_size 0
.amdhsa_kernarg_size 88
.amdhsa_user_sgpr_count 2
.amdhsa_user_sgpr_kernarg_segment_ptr 1
.amdhsa_system_sgpr_workgroup_id_x 1
.end_amdhsa_kernel
```
